```python
import torch

def _softmax(x, axis=-1):
    return torch.softmax(x, dim=axis)
def _gelu(x):
    return torch.nn.functional.gelu(x, approximate="tanh")
def _silu(x):
    return torch.nn.functional.silu(x)
def _sigmoid(x):
    return torch.sigmoid(x)
def _layernorm(x, axis=-1, eps=1e-5):
    m = x.mean(dim=axis, keepdim=True)
    v = x.var(dim=axis, keepdim=True, unbiased=False)
    return (x - m) / torch.sqrt(v + eps)
def _scatter_add(tgt, idx, src, axis=0):
    return tgt.clone().index_add_(axis, idx, src)
def _segment_sum(src, seg, n):
    out = torch.zeros((n,) + src.shape[1:], dtype=src.dtype)
    return out.index_add_(0, seg, src)
def _pad(x, pw):
    flat = tuple(v for pair in reversed(pw) for v in pair)
    return torch.nn.functional.pad(x, flat)

kernel_name = 'sequential_preLN__sliding_block__dense_activation_gelu__prompt'

def setup_inputs():

    _w = (lambda a: (lambda t: t.to(torch.bfloat16) if t.is_floating_point() else t)(torch.as_tensor(a)))
    def _A_setup():
        B, S, D = 1, 2048, 1024
        return {
            "x": _w((lambda *s: torch.randn(*s, dtype=torch.bfloat16) * 0.05)(B, S, D)),
            "wqkv": _w((lambda *s: torch.randn(*s, dtype=torch.bfloat16) * 0.05)(D, 3 * D)),
            "wo": _w((lambda *s: torch.randn(*s, dtype=torch.bfloat16) * 0.05)(D, D)),
        }
    _A_in = _A_setup()

    def _B_setup():
        B, S, D, F = 1, 2048, 1024, 3584
        return {
            "x": _w((lambda *s: torch.randn(*s, dtype=torch.bfloat16) * 0.05)(B, S, D)),
            "w1": _w((lambda *s: torch.randn(*s, dtype=torch.bfloat16) * 3.2)(D, F) * (D ** -0.5)),
            "b1": _w((lambda *s: torch.randn(*s, dtype=torch.bfloat16) * 3.2)(F) * 0.01),
            "w2": _w((lambda *s: torch.randn(*s, dtype=torch.bfloat16) * 0.4)(F, D) * (F ** -0.5)),
            "b2": _w((lambda *s: torch.randn(*s, dtype=torch.bfloat16) * 0.4)(D) * 0.01),
        }
    _B_in = _B_setup()

    return {
        "A_x": _A_in["x"],
        "A_wqkv": _A_in["wqkv"],
        "A_wo": _A_in["wo"],
        "B_x": _B_in["x"],
        "B_w1": _B_in["w1"],
        "B_b1": _B_in["b1"],
        "B_w2": _B_in["w2"],
        "B_b2": _B_in["b2"],
    }

def reference(A_x, A_wqkv, A_wo, B_x, B_w1, B_b1, B_w2, B_b2):
    def _A_ref(x, wqkv, wo):
        B, S, D = x.shape
        H = 32; Dh = D // H; W = 256
        qkv = (lambda x, *d: x.permute(*d))((x @ wqkv).reshape(B, S, 3, H, Dh), 2, 0, 3, 1, 4)
        q, k, v = qkv[0], qkv[1], qkv[2]
        scores = torch.einsum("bhqd,bhkd->bhqk", q, k) * (Dh ** -0.5)
        idx = torch.arange(S)
        mask = (idx[:, None] - idx[None, :] >= 0) & (idx[:, None] - idx[None, :] < W)
        scores = torch.where(mask[None, None], scores, -1e9)
        p = _softmax(scores, axis=-1)
        o = torch.einsum("bhqk,bhkd->bhqd", p, v)
        return (lambda x, *d: x.permute(*d))(o, 0, 2, 1, 3).reshape(B, S, D) @ wo

    def _B_ref(x, w1, b1, w2, b2):
        h = torch.einsum("bsd,df->bsf", x, w1) + b1
        h = _gelu(h)
        return torch.einsum("bsf,fd->bsd", h, w2) + b2

    x = A_x
    h = x + _A_ref(_layernorm(x, axis=-1), A_wqkv, A_wo)
    h2 = h + _B_ref(_layernorm(h, axis=-1), B_w1, B_b1, B_w2, B_b2)
    return h2
```

```asm
; @launch grid=(256,1,1) block=(512,1,1) lds=163840
.amdgcn_target "amdgcn-amd-amdhsa--gfx950"
.text
.globl sequential_preLN__sliding_block__dense_activation_gelu__prompt_kernel
.p2align 8
.type sequential_preLN__sliding_block__dense_activation_gelu__prompt_kernel,@function
sequential_preLN__sliding_block__dense_activation_gelu__prompt_kernel:
  s_cmp_ge_u32 s2, 256
  s_cbranch_scc1 Ldone
  s_load_dwordx2 s[8:9], s[0:1], 80
  s_load_dwordx2 s[12:13], s[0:1], 0
  s_load_dwordx2 s[16:17], s[0:1], 8
  s_load_dwordx2 s[20:21], s[0:1], 16
  s_load_dwordx2 s[24:25], s[0:1], 32
  s_load_dwordx2 s[28:29], s[0:1], 48
  s_nop 0
  s_load_dwordx2 s[32:33], s[0:1], 40
  s_load_dwordx2 s[36:37], s[0:1], 56
  s_load_dwordx2 s[40:41], s[0:1], 64
  s_load_dwordx2 s[44:45], s[0:1], 72
  v_lshrrev_b32 v1, 6, v0
  v_and_b32 v0, 63, v0
  v_readfirstlane_b32 s50, v1
  v_lshlrev_b32 v1, 4, v0
  v_mov_b32 v254, 0
  v_mov_b32 v255, 0
  s_mov_b32 s10, 268435456
  s_mov_b32 s11, 0x20000
  s_mov_b32 s14, 4194304
  s_mov_b32 s15, 0x20000
  s_mov_b32 s18, 6291456
  s_mov_b32 s19, 0x20000
  s_mov_b32 s22, 2097152
  s_mov_b32 s23, 0x20000
  s_mov_b32 s26, 7340032
  s_mov_b32 s27, 0x20000
  s_mov_b32 s30, 7340032
  s_mov_b32 s31, 0x20000
  s_mov_b32 s34, 7168
  s_mov_b32 s35, 0x20000
  s_mov_b32 s38, 2048
  s_mov_b32 s39, 0x20000
  s_mov_b32 s42, 4194304
  s_mov_b32 s43, 0x20000
  s_mov_b32 s46, 256
  s_mov_b32 s47, 0x20000
  s_and_b32 s3, s2, 7
  s_lshr_b32 s4, s2, 3
  s_lshr_b32 s5, s3, 2
  s_lshl_b32 s5, s5, 3
  s_lshr_b32 s6, s4, 2
  s_add_u32 s48, s5, s6
  s_and_b32 s5, s3, 3
  s_lshl_b32 s5, s5, 2
  s_and_b32 s6, s4, 3
  s_add_u32 s49, s5, s6
  s_and_b32 s51, s50, 3
  s_lshr_b32 s52, s51, 1
  s_and_b32 s53, s51, 1
  s_cmp_lt_u32 s50, 4
  s_cbranch_scc1 Lcompute
  s_mov_b32 s62, 0
  s_lshl_b32 s60, s51, 12
  s_lshl_b32 s56, s48, 18
  s_lshl_b32 s4, s51, 16
  s_add_u32 s56, s56, s4
  s_add_u32 s55, s56, 2048
  s_lshl_b32 s54, s62, 6
  s_add_u32 s54, s54, s56
  v_lshrrev_b32 v3, 3, v0
  v_and_b32 v4, 7, v0
  v_lshrrev_b32 v5, 1, v3
  v_xor_b32 v4, v4, v5
  v_lshlrev_b32 v4, 4, v4
  v_lshl_add_u32 v4, v3, 11, v4
  v_xor_b32 v5, 64, v4
  s_and_b32 s56, s48, 7
  s_lshl_b32 s56, s56, 1
  s_lshr_b32 s3, s48, 3
  s_add_u32 s56, s56, s3
  s_add_u32 s56, s56, 28
  s_sub_u32 s56, s56, s49
  s_cmp_ge_u32 s56, 14
  s_cselect_b32 s3, 14, 0
  s_sub_u32 s56, s56, s3
  s_cmp_ge_u32 s56, 14
  s_cselect_b32 s3, 14, 0
  s_sub_u32 s56, s56, s3
  s_cmp_ge_u32 s56, 14
  s_cselect_b32 s3, 14, 0
  s_sub_u32 s56, s56, s3
  s_lshl_b32 s56, s56, 1
  s_add_u32 s56, s56, s52
  s_sub_u32 s56, s56, s52
  v_add_u32 v236, 0, v4
  v_add_u32 v237, 15360, v5
  v_add_u32 v238, 30720, v4
  v_add_u32 v239, 46080, v5
  s_mov_b32 s62, 0
  s_add_u32 s62, s62, s52
  s_lshl_b32 s4, s53, 2
  s_mul_i32 s4, s4, 6144
  s_add_u32 s58, s4, 6291456
  s_mul_i32 s57, s62, 196608
  s_add_u32 s57, s57, s4
  s_mul_i32 s61, s51, 6144
  s_and_b32 s7, s48, 7
  s_lshl_b32 s7, s7, 1
  s_lshr_b32 s3, s48, 3
  s_add_u32 s7, s7, s3
  s_add_u32 s7, s7, 28
  s_sub_u32 s7, s7, s49
  s_cmp_ge_u32 s7, 14
  s_cselect_b32 s3, 14, 0
  s_sub_u32 s7, s7, s3
  s_cmp_ge_u32 s7, 14
  s_cselect_b32 s3, 14, 0
  s_sub_u32 s7, s7, s3
  s_cmp_ge_u32 s7, 14
  s_cselect_b32 s3, 14, 0
  s_sub_u32 s7, s7, s3
  s_lshl_b32 s7, s7, 1
  s_add_u32 s7, s7, s52
  s_lshl_b32 s4, s49, 7
  v_lshrrev_b32 v3, 3, v0
  v_and_b32 v4, 7, v0
  v_and_b32 v5, 6, v3
  v_xor_b32 v4, v4, v5
  v_lshlrev_b32 v4, 4, v4
  v_lshrrev_b32 v5, 2, v3
  v_lshlrev_b32 v5, 3, v5
  v_and_b32 v6, 3, v3
  v_add_u32 v5, v5, v6
  v_mul_u32_u24 v5, 6144, v5
  v_add3_u32 v5, v5, v4, s4
  v_add_u32_e64 v240, 0, v5
  v_add_u32 v241, 98304, v5
  v_add_u32 v242, 2048, v5
  v_add_u32 v243, 100352, v5
  v_add_u32 v244, 4096, v5
  v_add_u32 v245, 102400, v5
  s_waitcnt lgkmcnt(0)
  s_add_u32 m0, s60, 114688
  s_nop 0
  buffer_load_dwordx4 v236, s[12:15], s54 offen offset:0 lds
  buffer_load_dwordx4 v237, s[12:15], s54 offen offset:1024 lds
  buffer_load_dwordx4 v238, s[12:15], s54 offen offset:2048 lds
  buffer_load_dwordx4 v239, s[12:15], s54 offen offset:3072 lds
  s_add_u32 m0, s61, 40960
  s_nop 0
  buffer_load_dwordx4 v240, s[16:19], s57 offen  lds
  s_add_u32 s54, s54, 128
  s_cmp_ge_u32 s54, s55
  s_cselect_b32 s3, 2048, 0
  s_sub_u32 s54, s54, s3
  s_add_u32 m0, s61, 41984
  s_nop 0
  buffer_load_dwordx4 v241, s[16:19], s57 offen  lds
  s_add_u32 m0, s61, 43008
  s_nop 0
  buffer_load_dwordx4 v242, s[16:19], s57 offen  lds
  s_add_u32 m0, s61, 44032
  s_nop 0
  buffer_load_dwordx4 v243, s[16:19], s57 offen  lds
  s_add_u32 m0, s61, 45056
  s_nop 0
  s_nop 0
  buffer_load_dwordx4 v244, s[16:19], s57 offen  lds
  s_add_u32 m0, s61, 46080
  s_nop 0
  buffer_load_dwordx4 v245, s[16:19], s57 offen  lds
  s_add_u32 m0, s60, 131072
  s_nop 0
  buffer_load_dwordx4 v236, s[12:15], s54 offen offset:0 lds
  s_add_u32 s57, s57, 393216
  s_cmp_ge_u32 s57, s58
  s_nop 0
  s_cselect_b32 s3, 6291456, 0
  s_sub_u32 s57, s57, s3
  buffer_load_dwordx4 v237, s[12:15], s54 offen offset:1024 lds
  buffer_load_dwordx4 v238, s[12:15], s54 offen offset:2048 lds
  buffer_load_dwordx4 v239, s[12:15], s54 offen offset:3072 lds
  s_add_u32 m0, s61, 65536
  s_nop 0
  buffer_load_dwordx4 v240, s[16:19], s57 offen  lds
  s_lshl_b32 s3, s56, 6
  s_add_u32 s54, s54, s3
  s_add_u32 s54, s54, 128
  s_cmp_ge_u32 s54, s55
  s_cselect_b32 s3, 2048, 0
  s_sub_u32 s54, s54, s3
  s_add_u32 m0, s61, 66560
  s_nop 0
  buffer_load_dwordx4 v241, s[16:19], s57 offen  lds
  s_add_u32 m0, s61, 67584
  s_nop 0
  buffer_load_dwordx4 v242, s[16:19], s57 offen  lds
  s_add_u32 m0, s61, 68608
  s_nop 0
  buffer_load_dwordx4 v243, s[16:19], s57 offen  lds
  s_add_u32 m0, s61, 69632
  s_nop 0
  buffer_load_dwordx4 v244, s[16:19], s57 offen  lds
  s_add_u32 m0, s61, 70656
  s_nop 0
  buffer_load_dwordx4 v245, s[16:19], s57 offen  lds
  s_nop 0
  v_mov_b32 v24, 0x3f803f80
  v_mov_b32 v25, 0x3f803f80
  v_mov_b32 v26, 0x3f803f80
  v_mov_b32 v27, 0x3f803f80
  v_lshrrev_b32 v3, 4, v0
  v_bfe_u32 v4, v0, 2, 2
  v_and_b32 v5, 1, v3
  v_lshl_add_u32 v5, v5, 2, v4
  v_lshrrev_b32 v6, 1, v3
  v_lshlrev_b32 v6, 10, v6
  v_lshl_add_u32 v6, v5, 7, v6
  v_bfe_u32 v7, v0, 1, 1
  v_lshl_add_u32 v6, v7, 4, v6
  v_and_b32 v7, 1, v0
  v_lshl_add_u32 v6, v7, 3, v6
  v_add_u32 v6, 40960, v6
  v_and_b32 v5, 6, v5
  s_mul_i32 s63, s51, 3
  s_add_u32 s63, s63, 0
  s_min_u32 s63, s63, 11
  s_mov_b32 s4, s63
  s_lshr_b32 s5, s4, 2
  s_lshl_b32 s5, s5, 11
  s_and_b32 s6, s4, 3
  s_lshl_b32 s6, s6, 1
  v_xor_b32 v7, s6, v5
  v_lshl_add_u32 v16, v7, 4, v6
  v_add_u32 v16, s5, v16
  s_mul_i32 s63, s51, 3
  s_add_u32 s63, s63, 1
  s_min_u32 s63, s63, 11
  s_mov_b32 s4, s63
  s_lshr_b32 s5, s4, 2
  s_lshl_b32 s5, s5, 11
  s_and_b32 s6, s4, 3
  s_lshl_b32 s6, s6, 1
  v_xor_b32 v7, s6, v5
  v_lshl_add_u32 v17, v7, 4, v6
  v_add_u32 v17, s5, v17
  s_mul_i32 s63, s51, 3
  s_add_u32 s63, s63, 2
  s_min_u32 s63, s63, 11
  s_mov_b32 s4, s63
  s_lshr_b32 s5, s4, 2
  s_lshl_b32 s5, s5, 11
  s_and_b32 s6, s4, 3
  s_lshl_b32 s6, s6, 1
  v_xor_b32 v7, s6, v5
  v_lshl_add_u32 v18, v7, 4, v6
  v_add_u32 v18, s5, v18
  s_lshl_b32 s63, s51, 1
  v_and_b32 v3, 15, v0
  v_lshrrev_b32 v4, 4, v0
  v_lshrrev_b32 v7, 1, v3
  v_xor_b32 v4, v4, v7
  v_lshlrev_b32 v4, 4, v4
  v_lshl_add_u32 v4, v3, 7, v4
  s_lshl_b32 s3, s63, 11
  s_add_u32 s3, s3, 114688
  v_add_u32 v20, s3, v4
  v_xor_b32 v21, 64, v20
  v_lshrrev_b32 v3, 4, v0
  v_bfe_u32 v4, v0, 2, 2
  v_and_b32 v5, 1, v3
  v_lshl_add_u32 v5, v5, 2, v4
  v_lshrrev_b32 v6, 1, v3
  v_lshlrev_b32 v6, 10, v6
  v_lshl_add_u32 v6, v5, 7, v6
  v_bfe_u32 v7, v0, 1, 1
  v_lshl_add_u32 v6, v7, 4, v6
  v_and_b32 v7, 1, v0
  v_lshl_add_u32 v6, v7, 3, v6
  v_add_u32 v6, 2048, v6
  v_and_b32 v5, 6, v5
  v_lshl_add_u32 v8, v3, 2, v4
  v_lshlrev_b32 v9, 6, v8
  v_bfe_u32 v7, v0, 1, 1
  v_lshl_add_u32 v9, v7, 4, v9
  v_and_b32 v7, 1, v0
  v_lshl_add_u32 v9, v7, 3, v9
  v_add_u32 v9, 8192, v9
  v_lshrrev_b32 v8, 1, v8
  v_and_b32 v8, 2, v8
  s_mul_i32 s63, s51, 4
  s_add_u32 s63, s63, 0
  s_min_u32 s63, s63, 13
  s_and_b32 s3, s49, 1
  s_lshl_b32 s3, s3, 1
  s_sub_u32 s4, s63, s3
  s_lshr_b32 s5, s4, 2
  s_lshl_b32 s5, s5, 11
  s_and_b32 s6, s4, 3
  s_lshl_b32 s6, s6, 1
  v_xor_b32 v7, s6, v5
  v_lshl_add_u32 v28, v7, 4, v6
  v_add_u32 v28, s5, v28
  s_and_b32 s3, s63, 1
  s_lshl_b32 s3, s3, 1
  s_cmp_ge_u32 s4, 12
  s_cselect_b64 vcc, -1, 0
  v_xor_b32 v7, s3, v8
  v_lshl_add_u32 v7, v7, 4, v9
  v_cndmask_b32 v28, v28, v7, vcc
  s_mul_i32 s63, s51, 4
  s_add_u32 s63, s63, 1
  s_min_u32 s63, s63, 13
  s_and_b32 s3, s49, 1
  s_lshl_b32 s3, s3, 1
  s_sub_u32 s4, s63, s3
  s_lshr_b32 s5, s4, 2
  s_lshl_b32 s5, s5, 11
  s_and_b32 s6, s4, 3
  s_lshl_b32 s6, s6, 1
  v_xor_b32 v7, s6, v5
  v_lshl_add_u32 v29, v7, 4, v6
  v_add_u32 v29, s5, v29
  s_and_b32 s3, s63, 1
  s_lshl_b32 s3, s3, 1
  s_cmp_ge_u32 s4, 12
  s_cselect_b64 vcc, -1, 0
  v_xor_b32 v7, s3, v8
  v_lshl_add_u32 v7, v7, 4, v9
  v_cndmask_b32 v29, v29, v7, vcc
  s_mul_i32 s63, s51, 4
  s_add_u32 s63, s63, 2
  s_min_u32 s63, s63, 13
  s_and_b32 s3, s49, 1
  s_lshl_b32 s3, s3, 1
  s_sub_u32 s4, s63, s3
  s_lshr_b32 s5, s4, 2
  s_lshl_b32 s5, s5, 11
  s_and_b32 s6, s4, 3
  s_lshl_b32 s6, s6, 1
  v_xor_b32 v7, s6, v5
  v_lshl_add_u32 v30, v7, 4, v6
  v_add_u32 v30, s5, v30
  s_and_b32 s3, s63, 1
  s_lshl_b32 s3, s3, 1
  s_cmp_ge_u32 s4, 12
  s_cselect_b64 vcc, -1, 0
  v_xor_b32 v7, s3, v8
  v_lshl_add_u32 v7, v7, 4, v9
  v_cndmask_b32 v30, v30, v7, vcc
  s_mul_i32 s63, s51, 4
  s_add_u32 s63, s63, 3
  s_min_u32 s63, s63, 13
  s_and_b32 s3, s49, 1
  s_lshl_b32 s3, s3, 1
  s_sub_u32 s4, s63, s3
  s_lshr_b32 s5, s4, 2
  s_lshl_b32 s5, s5, 11
  s_and_b32 s6, s4, 3
  s_lshl_b32 s6, s6, 1
  v_xor_b32 v7, s6, v5
  v_lshl_add_u32 v31, v7, 4, v6
  v_add_u32 v31, s5, v31
  s_and_b32 s3, s63, 1
  s_lshl_b32 s3, s3, 1
  s_cmp_ge_u32 s4, 12
  s_cselect_b64 vcc, -1, 0
  v_xor_b32 v7, s3, v8
  v_lshl_add_u32 v7, v7, 4, v9
  v_cndmask_b32 v31, v31, v7, vcc
  s_mul_i32 s4, s49, 448
  s_and_b32 s5, s49, 1
  s_cmp_eq_u32 s5, 1
  s_cselect_b32 s5, 0, 384
  s_cselect_b32 s6, 64, 0
  s_add_u32 s5, s5, s4
  s_add_u32 s4, s4, s6
  v_lshrrev_b32 v3, 3, v0
  v_and_b32 v4, 7, v0
  v_and_b32 v5, 6, v3
  v_xor_b32 v4, v4, v5
  v_lshlrev_b32 v4, 4, v4
  v_mul_u32_u24 v5, 7168, v3
  v_add3_u32 v5, v5, v4, s4
  v_add_u32 v200, 0, v5
  v_add_u32 v201, 57344, v5
  v_add_u32 v202, 128, v5
  v_add_u32 v203, 57472, v5
  v_add_u32 v204, 256, v5
  v_add_u32 v205, 57600, v5
  v_lshrrev_b32 v3, 2, v0
  v_and_b32 v4, 3, v0
  v_lshrrev_b32 v6, 1, v3
  v_and_b32 v6, 2, v6
  v_xor_b32 v4, v4, v6
  v_lshlrev_b32 v4, 4, v4
  v_mul_u32_u24 v3, 7168, v3
  v_add3_u32 v206, v3, v4, s5
  s_waitcnt vmcnt(10)
  s_barrier
  s_add_u32 m0, s60, 147456
  s_nop 0
  buffer_load_dwordx4 v236, s[12:15], s54 offen offset:0 lds
  s_sub_u32 s3, s7, s52
  s_mul_i32 s3, s3, 196608
  s_add_u32 s57, s57, s3
  s_add_u32 s57, s57, 393216
  s_cmp_ge_u32 s57, s58
  s_cselect_b32 s3, 6291456, 0
  s_sub_u32 s57, s57, s3
  s_nop 0
  buffer_load_dwordx4 v237, s[12:15], s54 offen offset:1024 lds
  buffer_load_dwordx4 v238, s[12:15], s54 offen offset:2048 lds
  buffer_load_dwordx4 v239, s[12:15], s54 offen offset:3072 lds
  s_add_u32 m0, s61, 90112
  s_nop 0
  buffer_load_dwordx4 v240, s[16:19], s57 offen  lds
  s_add_u32 s56, s56, 2
  s_cmp_ge_u32 s56, 28
  s_cselect_b32 s3, 256, 0
  s_cselect_b32 s4, 28, 0
  s_sub_u32 s56, s56, s4
  s_add_u32 s54, s54, s3
  s_add_u32 s54, s54, 128
  s_cmp_ge_u32 s54, s55
  s_cselect_b32 s3, 2048, 0
  s_sub_u32 s54, s54, s3
  s_add_u32 m0, s61, 91136
  s_nop 0
  buffer_load_dwordx4 v241, s[16:19], s57 offen  lds
  s_add_u32 m0, s61, 92160
  s_nop 0
  buffer_load_dwordx4 v242, s[16:19], s57 offen  lds
  s_add_u32 m0, s61, 93184
  s_nop 0
  buffer_load_dwordx4 v243, s[16:19], s57 offen  lds
  s_add_u32 m0, s61, 94208
  s_nop 0
  buffer_load_dwordx4 v244, s[16:19], s57 offen  lds
  s_add_u32 m0, s61, 95232
  s_nop 0
  s_nop 0
  buffer_load_dwordx4 v245, s[16:19], s57 offen  lds
  s_cmp_eq_u32 s49, 14
  s_cbranch_scc0 Lwh_1001
  ds_read_b128 v[32:35], v20 offset:0
  ds_read_b128 v[36:39], v21 offset:0
  ds_read_b128 v[40:43], v20 offset:2048
  ds_read_b128 v[44:47], v21 offset:2048
  s_waitcnt lgkmcnt(0)
  v_mfma_f32_16x16x32_bf16 v[48:51], v[24:27], v[32:35], 0
  s_nop 0
  v_mfma_f32_16x16x32_bf16 v[52:55], v[32:35], v[32:35], 0
  v_mfma_f32_16x16x32_bf16 v[56:59], v[24:27], v[40:43], 0
  v_mfma_f32_16x16x32_bf16 v[60:63], v[40:43], v[40:43], 0
  v_mfma_f32_16x16x32_bf16 v[48:51], v[24:27], v[36:39], v[48:51]
  v_mfma_f32_16x16x32_bf16 v[52:55], v[36:39], v[36:39], v[52:55]
  v_mfma_f32_16x16x32_bf16 v[56:59], v[24:27], v[44:47], v[56:59]
  v_mfma_f32_16x16x32_bf16 v[60:63], v[44:47], v[44:47], v[60:63]
  v_and_b32_e64 v3, 3, v0
  v_cmp_eq_u32 s[4:5], 1, v3
  v_cmp_eq_u32 s[100:101], 2, v3
  v_cmp_eq_u32 s[64:65], 3, v3
  v_bfe_u32 v3, v0, 2, 2
  v_lshrrev_b32 v4, 4, v0
  v_cmp_eq_u32 vcc, v3, v4
  v_and_b32 v3, 15, v0
  v_lshlrev_b32 v3, 3, v3
  s_lshl_b32 s63, s48, 4
  s_add_u32 s63, s63, s49
  s_lshl_b32 s63, s63, 10
  s_lshl_b32 s3, s51, 8
  s_add_u32 s63, s63, s3
  s_add_u32 s63, s63, 62914560
  v_cndmask_b32 v52, v52, v53, s[4:5]
  v_cndmask_b32 v52, v52, v54, s[100:101]
  v_cndmask_b32 v49, v52, v55, s[64:65]
  v_cndmask_b32 v60, v60, v61, s[4:5]
  v_cndmask_b32 v60, v60, v62, s[100:101]
  v_cndmask_b32 v57, v60, v63, s[64:65]
  s_mov_b64 exec, vcc
  buffer_store_dwordx2 v[48:49], v3, s[8:11], s63 offen offset:0 sc1
  buffer_store_dwordx2 v[56:57], v3, s[8:11], s63 offen offset:128 sc1
  s_mov_b64 exec, -1
Lwh_1001:
  s_and_b32 s3, s48, 7
  s_cmp_eq_u32 s3, 7
  s_cbranch_scc0 Lwh_1002
  ds_read_b64_tr_b16 v[64:65], v16 offset:0
  ds_read_b64_tr_b16 v[66:67], v16 offset:6144
  ds_read_b64_tr_b16 v[68:69], v17 offset:0
  ds_read_b64_tr_b16 v[70:71], v17 offset:6144
  ds_read_b64_tr_b16 v[72:73], v18 offset:0
  ds_read_b64_tr_b16 v[74:75], v18 offset:6144
  s_waitcnt lgkmcnt(0)
  v_mfma_f32_16x16x32_bf16 v[96:99], v[64:67], v[24:27], 0
  v_mfma_f32_16x16x32_bf16 v[100:103], v[68:71], v[24:27], 0
  v_mfma_f32_16x16x32_bf16 v[104:107], v[72:75], v[24:27], 0
  ds_read_b64_tr_b16 v[80:81], v16 offset:12288
  ds_read_b64_tr_b16 v[82:83], v16 offset:18432
  s_nop 0
  ds_read_b64_tr_b16 v[84:85], v17 offset:12288
  ds_read_b64_tr_b16 v[86:87], v17 offset:18432
  ds_read_b64_tr_b16 v[88:89], v18 offset:12288
  ds_read_b64_tr_b16 v[90:91], v18 offset:18432
  s_waitcnt lgkmcnt(0)
  v_mfma_f32_16x16x32_bf16 v[96:99], v[80:83], v[24:27], v[96:99]
  v_mfma_f32_16x16x32_bf16 v[100:103], v[84:87], v[24:27], v[100:103]
  v_mfma_f32_16x16x32_bf16 v[104:107], v[88:91], v[24:27], v[104:107]
Lwh_1002:
  s_waitcnt vmcnt(10)
  s_barrier
  s_add_u32 m0, s60, 114688
  s_nop 0
  buffer_load_dwordx4 v236, s[12:15], s54 offen offset:0 lds
  s_add_u32 s7, s7, 2
  s_cmp_ge_u32 s7, 28
  s_cselect_b32 s3, 786432, 0
  s_cselect_b32 s4, 28, 0
  s_sub_u32 s7, s7, s4
  s_add_u32 s57, s57, s3
  s_add_u32 s57, s57, 393216
  s_cmp_ge_u32 s57, s58
  s_cselect_b32 s3, 6291456, 0
  s_sub_u32 s57, s57, s3
  buffer_load_dwordx4 v237, s[12:15], s54 offen offset:1024 lds
  buffer_load_dwordx4 v238, s[12:15], s54 offen offset:2048 lds
  buffer_load_dwordx4 v239, s[12:15], s54 offen offset:3072 lds
  s_add_u32 m0, s61, 40960
  s_nop 0
  buffer_load_dwordx4 v240, s[16:19], s57 offen  lds
  s_add_u32 s56, s56, 2
  s_cmp_ge_u32 s56, 28
  s_cselect_b32 s3, 256, 0
  s_cselect_b32 s4, 28, 0
  s_sub_u32 s56, s56, s4
  s_add_u32 s54, s54, s3
  s_add_u32 s54, s54, 128
  s_cmp_ge_u32 s54, s55
  s_cselect_b32 s3, 2048, 0
  s_sub_u32 s54, s54, s3
  s_add_u32 m0, s61, 41984
  s_nop 0
  buffer_load_dwordx4 v241, s[16:19], s57 offen  lds
  s_add_u32 m0, s61, 43008
  s_nop 0
  buffer_load_dwordx4 v242, s[16:19], s57 offen  lds
  s_add_u32 m0, s61, 44032
  s_nop 0
  buffer_load_dwordx4 v243, s[16:19], s57 offen  lds
  s_add_u32 m0, s61, 45056
  s_nop 0
  buffer_load_dwordx4 v244, s[16:19], s57 offen  lds
  s_nop 0
  s_add_u32 m0, s61, 46080
  s_nop 0
  buffer_load_dwordx4 v245, s[16:19], s57 offen  lds
  s_cmp_eq_u32 s49, 15
  s_cbranch_scc0 Lwh_1003
  ds_read_b128 v[32:35], v20 offset:16384
  ds_read_b128 v[36:39], v21 offset:16384
  ds_read_b128 v[40:43], v20 offset:18432
  ds_read_b128 v[44:47], v21 offset:18432
  s_waitcnt lgkmcnt(0)
  v_mfma_f32_16x16x32_bf16 v[48:51], v[24:27], v[32:35], 0
  v_mfma_f32_16x16x32_bf16 v[52:55], v[32:35], v[32:35], 0
  v_mfma_f32_16x16x32_bf16 v[56:59], v[24:27], v[40:43], 0
  v_mfma_f32_16x16x32_bf16 v[60:63], v[40:43], v[40:43], 0
  v_mfma_f32_16x16x32_bf16 v[48:51], v[24:27], v[36:39], v[48:51]
  v_mfma_f32_16x16x32_bf16 v[52:55], v[36:39], v[36:39], v[52:55]
  v_mfma_f32_16x16x32_bf16 v[56:59], v[24:27], v[44:47], v[56:59]
  v_mfma_f32_16x16x32_bf16 v[60:63], v[44:47], v[44:47], v[60:63]
  v_and_b32 v3, 3, v0
  v_cmp_eq_u32 s[4:5], 1, v3
  v_cmp_eq_u32 s[100:101], 2, v3
  v_cmp_eq_u32 s[64:65], 3, v3
  v_bfe_u32 v3, v0, 2, 2
  v_lshrrev_b32 v4, 4, v0
  v_cmp_eq_u32 vcc, v3, v4
  v_and_b32 v3, 15, v0
  v_lshlrev_b32 v3, 3, v3
  s_lshl_b32 s63, s48, 4
  s_add_u32 s63, s63, s49
  s_lshl_b32 s63, s63, 10
  s_lshl_b32 s3, s51, 8
  s_add_u32 s63, s63, s3
  s_add_u32 s63, s63, 62914560
  v_cndmask_b32 v52, v52, v53, s[4:5]
  v_cndmask_b32 v52, v52, v54, s[100:101]
  v_cndmask_b32 v49, v52, v55, s[64:65]
  v_cndmask_b32 v60, v60, v61, s[4:5]
  v_cndmask_b32 v60, v60, v62, s[100:101]
  v_cndmask_b32 v57, v60, v63, s[64:65]
  s_mov_b64 exec, vcc
  buffer_store_dwordx2 v[48:49], v3, s[8:11], s63 offen offset:0 sc1
  buffer_store_dwordx2 v[56:57], v3, s[8:11], s63 offen offset:128 sc1
  s_mov_b64 exec, -1
Lwh_1003:
  s_and_b32 s3, s48, 7
  s_cmp_eq_u32 s3, 7
  s_cbranch_scc0 Lwh_1004
  ds_read_b64_tr_b16 v[64:65], v16 offset:24576
  ds_read_b64_tr_b16 v[66:67], v16 offset:30720
  ds_read_b64_tr_b16 v[68:69], v17 offset:24576
  s_nop 0
  ds_read_b64_tr_b16 v[70:71], v17 offset:30720
  ds_read_b64_tr_b16 v[72:73], v18 offset:24576
  ds_read_b64_tr_b16 v[74:75], v18 offset:30720
  s_waitcnt lgkmcnt(0)
  v_mfma_f32_16x16x32_bf16 v[96:99], v[64:67], v[24:27], v[96:99]
  v_mfma_f32_16x16x32_bf16 v[100:103], v[68:71], v[24:27], v[100:103]
  v_mfma_f32_16x16x32_bf16 v[104:107], v[72:75], v[24:27], v[104:107]
  ds_read_b64_tr_b16 v[80:81], v16 offset:36864
  s_nop 0
  ds_read_b64_tr_b16 v[82:83], v16 offset:43008
  ds_read_b64_tr_b16 v[84:85], v17 offset:36864
  ds_read_b64_tr_b16 v[86:87], v17 offset:43008
  ds_read_b64_tr_b16 v[88:89], v18 offset:36864
  ds_read_b64_tr_b16 v[90:91], v18 offset:43008
  s_waitcnt lgkmcnt(0)
  v_mfma_f32_16x16x32_bf16 v[96:99], v[80:83], v[24:27], v[96:99]
  v_mfma_f32_16x16x32_bf16 v[100:103], v[84:87], v[24:27], v[100:103]
  s_nop 0
  v_mfma_f32_16x16x32_bf16 v[104:107], v[88:91], v[24:27], v[104:107]
  v_and_b32 v3, 15, v0
  v_cmp_eq_u32 vcc, 0, v3
  v_and_b32 v3, 48, v0
  s_lshr_b32 s63, s48, 3
  s_lshl_b32 s63, s63, 4
  s_add_u32 s63, s63, s49
  s_lshl_b32 s63, s63, 3
  s_and_b32 s3, s48, 7
  s_add_u32 s63, s63, s3
  s_mul_i32 s63, s63, 768
  s_add_u32 s63, s63, 63963136
  s_nop 3
  s_mov_b64 exec, vcc
  s_mul_i32 s3, s51, 3
  s_add_u32 s3, s3, 0
  s_min_u32 s3, s3, 11
  s_lshl_b32 s3, s3, 6
  s_add_u32 s3, s3, s63
  buffer_store_dwordx4 v[96:99], v3, s[8:11], s3 offen sc1
  s_mul_i32 s3, s51, 3
  s_add_u32 s3, s3, 1
  s_min_u32 s3, s3, 11
  s_lshl_b32 s3, s3, 6
  s_add_u32 s3, s3, s63
  buffer_store_dwordx4 v[100:103], v3, s[8:11], s3 offen sc1
  s_mul_i32 s3, s51, 3
  s_add_u32 s3, s3, 2
  s_min_u32 s3, s3, 11
  s_lshl_b32 s3, s3, 6
  s_add_u32 s3, s3, s63
  buffer_store_dwordx4 v[104:107], v3, s[8:11], s3 offen sc1
  s_mov_b64 exec, -1
Lwh_1004:
  s_waitcnt vmcnt(10)
  s_barrier
  s_add_u32 m0, s60, 131072
  s_nop 0
  buffer_load_dwordx4 v236, s[12:15], s54 offen offset:0 lds
  s_add_u32 s7, s7, 2
  s_cmp_ge_u32 s7, 28
  s_cselect_b32 s3, 786432, 0
  s_cselect_b32 s4, 28, 0
  s_sub_u32 s7, s7, s4
  s_add_u32 s57, s57, s3
  s_add_u32 s57, s57, 393216
  s_cmp_ge_u32 s57, s58
  s_cselect_b32 s3, 6291456, 0
  s_sub_u32 s57, s57, s3
  buffer_load_dwordx4 v237, s[12:15], s54 offen offset:1024 lds
  buffer_load_dwordx4 v238, s[12:15], s54 offen offset:2048 lds
  s_nop 0
  buffer_load_dwordx4 v239, s[12:15], s54 offen offset:3072 lds
  s_add_u32 m0, s61, 65536
  s_nop 0
  buffer_load_dwordx4 v240, s[16:19], s57 offen  lds
  s_add_u32 s56, s56, 2
  s_cmp_ge_u32 s56, 28
  s_cselect_b32 s3, 256, 0
  s_cselect_b32 s4, 28, 0
  s_sub_u32 s56, s56, s4
  s_add_u32 s54, s54, s3
  s_add_u32 s54, s54, 128
  s_cmp_ge_u32 s54, s55
  s_cselect_b32 s3, 2048, 0
  s_sub_u32 s54, s54, s3
  s_add_u32 m0, s61, 66560
  s_nop 0
  buffer_load_dwordx4 v241, s[16:19], s57 offen  lds
  s_add_u32 m0, s61, 67584
  s_nop 0
  buffer_load_dwordx4 v242, s[16:19], s57 offen  lds
  s_add_u32 m0, s61, 68608
  s_nop 0
  buffer_load_dwordx4 v243, s[16:19], s57 offen  lds
  s_add_u32 m0, s61, 69632
  s_nop 0
  buffer_load_dwordx4 v244, s[16:19], s57 offen  lds
  s_add_u32 m0, s61, 70656
  s_nop 0
  buffer_load_dwordx4 v245, s[16:19], s57 offen  lds
  s_cmp_lt_u32 s49, 14
  s_cbranch_scc0 Lwh_1005
  s_nop 0
  ds_read_b128 v[32:35], v20 offset:32768
  ds_read_b128 v[36:39], v21 offset:32768
  ds_read_b128 v[40:43], v20 offset:34816
  ds_read_b128 v[44:47], v21 offset:34816
  s_waitcnt lgkmcnt(0)
  v_mfma_f32_16x16x32_bf16 v[48:51], v[24:27], v[32:35], 0
  v_mfma_f32_16x16x32_bf16 v[52:55], v[32:35], v[32:35], 0
  v_mfma_f32_16x16x32_bf16 v[56:59], v[24:27], v[40:43], 0
  s_nop 0
  v_mfma_f32_16x16x32_bf16 v[60:63], v[40:43], v[40:43], 0
  v_mfma_f32_16x16x32_bf16 v[48:51], v[24:27], v[36:39], v[48:51]
  v_mfma_f32_16x16x32_bf16 v[52:55], v[36:39], v[36:39], v[52:55]
  v_mfma_f32_16x16x32_bf16 v[56:59], v[24:27], v[44:47], v[56:59]
  v_mfma_f32_16x16x32_bf16 v[60:63], v[44:47], v[44:47], v[60:63]
  v_and_b32_e64 v3, 3, v0
  v_cmp_eq_u32 s[4:5], 1, v3
  v_cmp_eq_u32 s[100:101], 2, v3
  v_cmp_eq_u32 s[64:65], 3, v3
  v_bfe_u32 v3, v0, 2, 2
  v_lshrrev_b32 v4, 4, v0
  v_cmp_eq_u32 vcc, v3, v4
  v_and_b32 v3, 15, v0
  v_lshlrev_b32_e64 v3, 3, v3
  s_lshl_b32 s63, s48, 4
  s_add_u32 s63, s63, s49
  s_lshl_b32 s63, s63, 10
  s_lshl_b32 s3, s51, 8
  s_add_u32 s63, s63, s3
  s_add_u32 s63, s63, 62914560
  v_cndmask_b32 v52, v52, v53, s[4:5]
  v_cndmask_b32 v52, v52, v54, s[100:101]
  v_cndmask_b32 v49, v52, v55, s[64:65]
  v_cndmask_b32 v60, v60, v61, s[4:5]
  v_cndmask_b32 v60, v60, v62, s[100:101]
  v_cndmask_b32 v57, v60, v63, s[64:65]
  s_mov_b64 exec, vcc
  buffer_store_dwordx2 v[48:49], v3, s[8:11], s63 offen offset:0 sc1
  s_nop 0
  buffer_store_dwordx2 v[56:57], v3, s[8:11], s63 offen offset:128 sc1
  s_mov_b64 exec, -1
Lwh_1005:
  s_and_b32 s3, s48, 7
  s_cmp_lg_u32 s3, 7
  s_cbranch_scc0 Lwh_1006
  v_add_u32 v112, 49152, v16
  v_add_u32 v113, 49152, v17
  v_add_u32 v114, 49152, v18
  ds_read_b64_tr_b16 v[64:65], v112 offset:0
  ds_read_b64_tr_b16 v[66:67], v112 offset:6144
  ds_read_b64_tr_b16 v[68:69], v113 offset:0
  ds_read_b64_tr_b16 v[70:71], v113 offset:6144
  ds_read_b64_tr_b16 v[72:73], v114 offset:0
  ds_read_b64_tr_b16 v[74:75], v114 offset:6144
  s_waitcnt lgkmcnt(0)
  v_mfma_f32_16x16x32_bf16 v[96:99], v[64:67], v[24:27], 0
  v_mfma_f32_16x16x32_bf16 v[100:103], v[68:71], v[24:27], 0
  v_mfma_f32_16x16x32_bf16 v[104:107], v[72:75], v[24:27], 0
  s_nop 0
  ds_read_b64_tr_b16 v[80:81], v112 offset:12288
  ds_read_b64_tr_b16 v[82:83], v112 offset:18432
  ds_read_b64_tr_b16 v[84:85], v113 offset:12288
  ds_read_b64_tr_b16 v[86:87], v113 offset:18432
  ds_read_b64_tr_b16 v[88:89], v114 offset:12288
  ds_read_b64_tr_b16 v[90:91], v114 offset:18432
  s_waitcnt lgkmcnt(0)
  v_mfma_f32_16x16x32_bf16 v[96:99], v[80:83], v[24:27], v[96:99]
  s_nop 0
  v_mfma_f32_16x16x32_bf16 v[100:103], v[84:87], v[24:27], v[100:103]
  v_mfma_f32_16x16x32_bf16 v[104:107], v[88:91], v[24:27], v[104:107]
Lwh_1006:
  s_waitcnt vmcnt(10)
  s_barrier
  s_add_u32 m0, s60, 147456
  s_nop 0
  buffer_load_dwordx4 v236, s[12:15], s54 offen offset:0 lds
  s_add_u32 s7, s7, 2
  s_cmp_ge_u32 s7, 28
  s_cselect_b32 s3, 786432, 0
  s_cselect_b32 s4, 28, 0
  s_sub_u32 s7, s7, s4
  s_add_u32 s57, s57, s3
  s_add_u32 s57, s57, 393216
  s_cmp_ge_u32 s57, s58
  s_cselect_b32 s3, 6291456, 0
  s_sub_u32 s57, s57, s3
  buffer_load_dwordx4 v237, s[12:15], s54 offen offset:1024 lds
  buffer_load_dwordx4 v238, s[12:15], s54 offen offset:2048 lds
  buffer_load_dwordx4 v239, s[12:15], s54 offen offset:3072 lds
  s_add_u32 m0, s61, 90112
  s_nop 0
  buffer_load_dwordx4 v240, s[16:19], s57 offen  lds
  s_add_u32 s56, s56, 2
  s_cmp_ge_u32 s56, 28
  s_cselect_b32 s3, 256, 0
  s_cselect_b32 s4, 28, 0
  s_sub_u32 s56, s56, s4
  s_add_u32 s54, s54, s3
  s_add_u32 s54, s54, 128
  s_cmp_ge_u32 s54, s55
  s_cselect_b32 s3, 2048, 0
  s_sub_u32 s54, s54, s3
  s_add_u32 m0, s61, 91136
  s_nop 0
  buffer_load_dwordx4 v241, s[16:19], s57 offen  lds
  s_add_u32 m0, s61, 92160
  s_nop 0
  buffer_load_dwordx4 v242, s[16:19], s57 offen  lds
  s_add_u32 m0, s61, 93184
  s_nop 0
  buffer_load_dwordx4 v243, s[16:19], s57 offen  lds
  s_nop 0
  s_add_u32 m0, s61, 94208
  s_nop 0
  buffer_load_dwordx4 v244, s[16:19], s57 offen  lds
  s_add_u32 m0, s61, 95232
  s_nop 0
  buffer_load_dwordx4 v245, s[16:19], s57 offen  lds
  s_and_b32 s3, s48, 7
  s_cmp_lg_u32 s3, 7
  s_cbranch_scc0 Lwh_1007
  ds_read_b64_tr_b16 v[64:65], v16 offset:0
  s_nop 0
  ds_read_b64_tr_b16 v[66:67], v16 offset:6144
  ds_read_b64_tr_b16 v[68:69], v17 offset:0
  ds_read_b64_tr_b16 v[70:71], v17 offset:6144
  ds_read_b64_tr_b16 v[72:73], v18 offset:0
  ds_read_b64_tr_b16 v[74:75], v18 offset:6144
  s_waitcnt lgkmcnt(0)
  v_mfma_f32_16x16x32_bf16 v[96:99], v[64:67], v[24:27], v[96:99]
  v_mfma_f32_16x16x32_bf16 v[100:103], v[68:71], v[24:27], v[100:103]
  s_nop 0
  v_mfma_f32_16x16x32_bf16 v[104:107], v[72:75], v[24:27], v[104:107]
  ds_read_b64_tr_b16 v[80:81], v16 offset:12288
  ds_read_b64_tr_b16 v[82:83], v16 offset:18432
  ds_read_b64_tr_b16 v[84:85], v17 offset:12288
  ds_read_b64_tr_b16 v[86:87], v17 offset:18432
  ds_read_b64_tr_b16 v[88:89], v18 offset:12288
  ds_read_b64_tr_b16 v[90:91], v18 offset:18432
  s_waitcnt lgkmcnt(0)
  s_nop 0
  v_mfma_f32_16x16x32_bf16 v[96:99], v[80:83], v[24:27], v[96:99]
  v_mfma_f32_16x16x32_bf16 v[100:103], v[84:87], v[24:27], v[100:103]
  v_mfma_f32_16x16x32_bf16 v[104:107], v[88:91], v[24:27], v[104:107]
  v_and_b32 v3, 15, v0
  v_cmp_eq_u32 vcc, 0, v3
  v_and_b32_e64 v3, 48, v0
  s_lshr_b32 s63, s48, 3
  s_lshl_b32 s63, s63, 4
  s_add_u32 s63, s63, s49
  s_lshl_b32 s63, s63, 3
  s_and_b32 s3, s48, 7
  s_add_u32 s63, s63, s3
  s_mul_i32 s63, s63, 768
  s_add_u32 s63, s63, 63963136
  s_nop 3
  s_mov_b64 exec, vcc
  s_mul_i32 s3, s51, 3
  s_add_u32 s3, s3, 0
  s_min_u32 s3, s3, 11
  s_lshl_b32 s3, s3, 6
  s_add_u32 s3, s3, s63
  buffer_store_dwordx4 v[96:99], v3, s[8:11], s3 offen sc1
  s_mul_i32 s3, s51, 3
  s_add_u32 s3, s3, 1
  s_min_u32 s3, s3, 11
  s_lshl_b32 s3, s3, 6
  s_add_u32 s3, s3, s63
  buffer_store_dwordx4 v[100:103], v3, s[8:11], s3 offen sc1
  s_mul_i32 s3, s51, 3
  s_add_u32 s3, s3, 2
  s_min_u32 s3, s3, 11
  s_lshl_b32 s3, s3, 6
  s_add_u32 s3, s3, s63
  buffer_store_dwordx4 v[104:107], v3, s[8:11], s3 offen sc1
  s_mov_b64 exec, -1
Lwh_1007:
  s_waitcnt vmcnt(10)
  s_barrier
  s_add_u32 m0, s60, 114688
  s_nop 0
  buffer_load_dwordx4 v236, s[12:15], s54 offen offset:0 lds
  s_add_u32 s7, s7, 2
  s_cmp_ge_u32 s7, 28
  s_cselect_b32 s3, 786432, 0
  s_cselect_b32 s4, 28, 0
  s_sub_u32 s7, s7, s4
  s_add_u32 s57, s57, s3
  s_add_u32 s57, s57, 393216
  s_cmp_ge_u32 s57, s58
  s_cselect_b32 s3, 6291456, 0
  s_sub_u32 s57, s57, s3
  buffer_load_dwordx4 v237, s[12:15], s54 offen offset:1024 lds
  buffer_load_dwordx4 v238, s[12:15], s54 offen offset:2048 lds
  buffer_load_dwordx4 v239, s[12:15], s54 offen offset:3072 lds
  s_add_u32 m0, s61, 40960
  s_nop 0
  buffer_load_dwordx4 v240, s[16:19], s57 offen  lds
  s_add_u32 s56, s56, 2
  s_cmp_ge_u32 s56, 28
  s_cselect_b32 s3, 256, 0
  s_cselect_b32 s4, 28, 0
  s_sub_u32 s56, s56, s4
  s_add_u32 s54, s54, s3
  s_add_u32 s54, s54, 128
  s_cmp_ge_u32 s54, s55
  s_cselect_b32 s3, 2048, 0
  s_sub_u32 s54, s54, s3
  s_add_u32 m0, s61, 41984
  s_nop 0
  buffer_load_dwordx4 v241, s[16:19], s57 offen  lds
  s_add_u32 m0, s61, 43008
  s_nop 0
  buffer_load_dwordx4 v242, s[16:19], s57 offen  lds
  s_add_u32 m0, s61, 44032
  s_nop 0
  buffer_load_dwordx4 v243, s[16:19], s57 offen  lds
  s_add_u32 m0, s61, 45056
  s_nop 0
  buffer_load_dwordx4 v244, s[16:19], s57 offen  lds
  s_add_u32 m0, s61, 46080
  s_nop 0
  s_nop 0
  buffer_load_dwordx4 v245, s[16:19], s57 offen  lds
  s_lshl_b32 s59, s2, 2
  s_add_u32 s59, s59, s51
  s_mul_i32 s59, s59, 7168
  s_buffer_load_dword s66, s[28:31], s59
  s_add_u32 s59, s59, 64
  s_buffer_load_dword s67, s[28:31], s59
  s_add_u32 s59, s59, 64
  s_buffer_load_dword s66, s[28:31], s59
  s_add_u32 s59, s59, 64
  s_nop 0
  s_buffer_load_dword s67, s[28:31], s59
  s_add_u32 s59, s59, 64
  s_buffer_load_dword s66, s[28:31], s59
  s_add_u32 s59, s59, 64
  s_waitcnt vmcnt(10)
  s_barrier
  s_add_u32 m0, s60, 131072
  s_nop 0
  buffer_load_dwordx4 v236, s[12:15], s54 offen offset:0 lds
  s_add_u32 s7, s7, 2
  s_cmp_ge_u32 s7, 28
  s_nop 0
  s_cselect_b32 s3, 786432, 0
  s_cselect_b32 s4, 28, 0
  s_sub_u32 s7, s7, s4
  s_add_u32 s57, s57, s3
  s_add_u32 s57, s57, 393216
  s_cmp_ge_u32 s57, s58
  s_cselect_b32 s3, 6291456, 0
  s_sub_u32 s57, s57, s3
  buffer_load_dwordx4 v237, s[12:15], s54 offen offset:1024 lds
  buffer_load_dwordx4 v238, s[12:15], s54 offen offset:2048 lds
  s_nop 0
  buffer_load_dwordx4 v239, s[12:15], s54 offen offset:3072 lds
  s_add_u32 m0, s61, 65536
  s_nop 0
  buffer_load_dwordx4 v240, s[16:19], s57 offen  lds
  s_add_u32 s56, s56, 2
  s_cmp_ge_u32 s56, 28
  s_cselect_b32 s3, 256, 0
  s_cselect_b32 s4, 28, 0
  s_sub_u32 s56, s56, s4
  s_add_u32 s54, s54, s3
  s_add_u32 s54, s54, 128
  s_cmp_ge_u32 s54, s55
  s_cselect_b32 s3, 2048, 0
  s_sub_u32 s54, s54, s3
  s_add_u32 m0, s61, 66560
  s_nop 0
  buffer_load_dwordx4 v241, s[16:19], s57 offen  lds
  s_add_u32 m0, s61, 67584
  s_nop 0
  buffer_load_dwordx4 v242, s[16:19], s57 offen  lds
  s_add_u32 m0, s61, 68608
  s_nop 0
  buffer_load_dwordx4 v243, s[16:19], s57 offen  lds
  s_add_u32 m0, s61, 69632
  s_nop 0
  buffer_load_dwordx4 v244, s[16:19], s57 offen  lds
  s_add_u32 m0, s61, 70656
  s_nop 0
  buffer_load_dwordx4 v245, s[16:19], s57 offen  lds
  s_buffer_load_dword s66, s[28:31], s59
  s_add_u32 s59, s59, 64
  s_buffer_load_dword s67, s[28:31], s59
  s_add_u32 s59, s59, 64
  s_buffer_load_dword s66, s[28:31], s59
  s_add_u32 s59, s59, 64
  s_buffer_load_dword s67, s[28:31], s59
  s_add_u32 s59, s59, 64
  s_buffer_load_dword s66, s[28:31], s59
  s_add_u32 s59, s59, 64
  s_waitcnt vmcnt(10)
  s_barrier
  s_add_u32 m0, s60, 147456
  s_nop 0
  buffer_load_dwordx4 v236, s[12:15], s54 offen offset:0 lds
  s_add_u32 s7, s7, 2
  s_cmp_ge_u32 s7, 28
  s_cselect_b32 s3, 786432, 0
  s_cselect_b32 s4, 28, 0
  s_sub_u32 s7, s7, s4
  s_add_u32 s57, s57, s3
  s_add_u32 s57, s57, 393216
  s_cmp_ge_u32 s57, s58
  s_cselect_b32 s3, 6291456, 0
  s_sub_u32 s57, s57, s3
  buffer_load_dwordx4 v237, s[12:15], s54 offen offset:1024 lds
  buffer_load_dwordx4 v238, s[12:15], s54 offen offset:2048 lds
  buffer_load_dwordx4 v239, s[12:15], s54 offen offset:3072 lds
  s_add_u32 m0, s61, 90112
  s_nop 0
  buffer_load_dwordx4 v240, s[16:19], s57 offen  lds
  s_add_u32 s56, s56, 2
  s_cmp_ge_u32 s56, 28
  s_cselect_b32 s3, 256, 0
  s_cselect_b32 s4, 28, 0
  s_sub_u32 s56, s56, s4
  s_add_u32 s54, s54, s3
  s_add_u32 s54, s54, 128
  s_cmp_ge_u32 s54, s55
  s_cselect_b32 s3, 2048, 0
  s_sub_u32 s54, s54, s3
  s_add_u32 m0, s61, 91136
  s_nop 0
  buffer_load_dwordx4 v241, s[16:19], s57 offen  lds
  s_add_u32 m0, s61, 92160
  s_nop 0
  buffer_load_dwordx4 v242, s[16:19], s57 offen  lds
  s_add_u32 m0, s61, 93184
  s_nop 0
  buffer_load_dwordx4 v243, s[16:19], s57 offen  lds
  s_add_u32 m0, s61, 94208
  s_nop 0
  buffer_load_dwordx4 v244, s[16:19], s57 offen  lds
  s_add_u32 m0, s61, 95232
  s_nop 0
  s_nop 0
  buffer_load_dwordx4 v245, s[16:19], s57 offen  lds
  s_buffer_load_dword s66, s[28:31], s59
  s_add_u32 s59, s59, 64
  s_buffer_load_dword s67, s[28:31], s59
  s_add_u32 s59, s59, 64
  s_buffer_load_dword s66, s[28:31], s59
  s_add_u32 s59, s59, 64
  s_buffer_load_dword s67, s[28:31], s59
  s_add_u32 s59, s59, 64
  s_buffer_load_dword s66, s[28:31], s59
  s_add_u32 s59, s59, 64
  s_waitcnt vmcnt(10)
  s_barrier
  s_add_u32 m0, s60, 114688
  s_nop 0
  buffer_load_dwordx4 v236, s[12:15], s54 offen offset:0 lds
  s_add_u32 s7, s7, 2
  s_cmp_ge_u32 s7, 28
  s_cselect_b32 s3, 786432, 0
  s_cselect_b32 s4, 28, 0
  s_sub_u32 s7, s7, s4
  s_add_u32 s57, s57, s3
  s_nop 0
  s_add_u32 s57, s57, 393216
  s_cmp_ge_u32 s57, s58
  s_cselect_b32 s3, 6291456, 0
  s_sub_u32 s57, s57, s3
  buffer_load_dwordx4 v237, s[12:15], s54 offen offset:1024 lds
  buffer_load_dwordx4 v238, s[12:15], s54 offen offset:2048 lds
  buffer_load_dwordx4 v239, s[12:15], s54 offen offset:3072 lds
  s_add_u32 m0, s61, 40960
  s_nop 0
  s_nop 0
  buffer_load_dwordx4 v240, s[16:19], s57 offen  lds
  s_add_u32 s56, s56, 2
  s_cmp_ge_u32 s56, 28
  s_cselect_b32 s3, 256, 0
  s_cselect_b32 s4, 28, 0
  s_sub_u32 s56, s56, s4
  s_add_u32 s54, s54, s3
  s_add_u32 s54, s54, 128
  s_cmp_ge_u32 s54, s55
  s_cselect_b32 s3, 2048, 0
  s_sub_u32 s54, s54, s3
  s_nop 0
  s_add_u32 m0, s61, 41984
  s_nop 0
  buffer_load_dwordx4 v241, s[16:19], s57 offen  lds
  s_add_u32 m0, s61, 43008
  s_nop 0
  buffer_load_dwordx4 v242, s[16:19], s57 offen  lds
  s_add_u32 m0, s61, 44032
  s_nop 0
  buffer_load_dwordx4 v243, s[16:19], s57 offen  lds
  s_nop 0
  s_add_u32 m0, s61, 45056
  s_nop 0
  buffer_load_dwordx4 v244, s[16:19], s57 offen  lds
  s_add_u32 m0, s61, 46080
  s_nop 0
  buffer_load_dwordx4 v245, s[16:19], s57 offen  lds
  s_buffer_load_dword s66, s[28:31], s59
  s_add_u32 s59, s59, 64
  s_buffer_load_dword s67, s[28:31], s59
  s_add_u32 s59, s59, 64
  s_buffer_load_dword s66, s[28:31], s59
  s_add_u32 s59, s59, 64
  s_buffer_load_dword s67, s[28:31], s59
  s_add_u32 s59, s59, 64
  s_buffer_load_dword s66, s[28:31], s59
  s_add_u32 s59, s59, 64
  s_waitcnt vmcnt(10)
  s_barrier
  s_add_u32 m0, s60, 131072
  s_nop 0
  buffer_load_dwordx4 v236, s[12:15], s54 offen offset:0 lds
  s_add_u32 s7, s7, 2
  s_cmp_ge_u32 s7, 28
  s_cselect_b32 s3, 786432, 0
  s_cselect_b32 s4, 28, 0
  s_sub_u32 s7, s7, s4
  s_add_u32 s57, s57, s3
  s_add_u32 s57, s57, 393216
  s_cmp_ge_u32 s57, s58
  s_cselect_b32 s3, 6291456, 0
  s_sub_u32 s57, s57, s3
  buffer_load_dwordx4 v237, s[12:15], s54 offen offset:1024 lds
  s_nop 0
  buffer_load_dwordx4 v238, s[12:15], s54 offen offset:2048 lds
  buffer_load_dwordx4 v239, s[12:15], s54 offen offset:3072 lds
  s_add_u32 m0, s61, 65536
  s_nop 0
  buffer_load_dwordx4 v240, s[16:19], s57 offen  lds
  s_add_u32 s56, s56, 2
  s_cmp_ge_u32 s56, 28
  s_cselect_b32 s3, 256, 0
  s_cselect_b32 s4, 28, 0
  s_sub_u32 s56, s56, s4
  s_add_u32 s54, s54, s3
  s_add_u32 s54, s54, 128
  s_cmp_ge_u32 s54, s55
  s_cselect_b32 s3, 2048, 0
  s_sub_u32 s54, s54, s3
  s_add_u32 m0, s61, 66560
  s_nop 0
  buffer_load_dwordx4 v241, s[16:19], s57 offen  lds
  s_add_u32 m0, s61, 67584
  s_nop 0
  buffer_load_dwordx4 v242, s[16:19], s57 offen  lds
  s_add_u32 m0, s61, 68608
  s_nop 0
  buffer_load_dwordx4 v243, s[16:19], s57 offen  lds
  s_add_u32 m0, s61, 69632
  s_nop 0
  buffer_load_dwordx4 v244, s[16:19], s57 offen  lds
  s_add_u32 m0, s61, 70656
  s_nop 0
  buffer_load_dwordx4 v245, s[16:19], s57 offen  lds
  s_nop 0
  s_buffer_load_dword s66, s[28:31], s59
  s_add_u32 s59, s59, 64
  s_buffer_load_dword s67, s[28:31], s59
  s_add_u32 s59, s59, 64
  s_buffer_load_dword s66, s[28:31], s59
  s_add_u32 s59, s59, 64
  s_buffer_load_dword s67, s[28:31], s59
  s_add_u32 s59, s59, 64
  s_buffer_load_dword s66, s[28:31], s59
  s_add_u32 s59, s59, 64
  s_waitcnt vmcnt(10)
  s_barrier
  s_add_u32 m0, s60, 147456
  s_nop 0
  buffer_load_dwordx4 v236, s[12:15], s54 offen offset:0 lds
  s_add_u32 s7, s7, 2
  s_cmp_ge_u32 s7, 28
  s_cselect_b32 s3, 786432, 0
  s_cselect_b32 s4, 28, 0
  s_sub_u32 s7, s7, s4
  s_add_u32 s57, s57, s3
  s_add_u32 s57, s57, 393216
  s_cmp_ge_u32 s57, s58
  s_cselect_b32 s3, 6291456, 0
  s_sub_u32 s57, s57, s3
  buffer_load_dwordx4 v237, s[12:15], s54 offen offset:1024 lds
  buffer_load_dwordx4 v238, s[12:15], s54 offen offset:2048 lds
  buffer_load_dwordx4 v239, s[12:15], s54 offen offset:3072 lds
  s_add_u32 m0, s61, 90112
  s_nop 0
  buffer_load_dwordx4 v240, s[16:19], s57 offen  lds
  s_add_u32 s56, s56, 2
  s_cmp_ge_u32 s56, 28
  s_cselect_b32 s3, 256, 0
  s_cselect_b32 s4, 28, 0
  s_sub_u32 s56, s56, s4
  s_add_u32 s54, s54, s3
  s_add_u32 s54, s54, 128
  s_cmp_ge_u32 s54, s55
  s_cselect_b32 s3, 2048, 0
  s_sub_u32 s54, s54, s3
  s_add_u32 m0, s61, 91136
  s_nop 0
  buffer_load_dwordx4 v241, s[16:19], s57 offen  lds
  s_add_u32 m0, s61, 92160
  s_nop 0
  buffer_load_dwordx4 v242, s[16:19], s57 offen  lds
  s_add_u32 m0, s61, 93184
  s_nop 0
  buffer_load_dwordx4 v243, s[16:19], s57 offen  lds
  s_add_u32 m0, s61, 94208
  s_nop 0
  buffer_load_dwordx4 v244, s[16:19], s57 offen  lds
  s_nop 0
  s_add_u32 m0, s61, 95232
  s_nop 0
  buffer_load_dwordx4 v245, s[16:19], s57 offen  lds
  s_buffer_load_dword s66, s[28:31], s59
  s_add_u32 s59, s59, 64
  s_buffer_load_dword s67, s[28:31], s59
  s_add_u32 s59, s59, 64
  s_buffer_load_dword s66, s[28:31], s59
  s_add_u32 s59, s59, 64
  s_buffer_load_dword s67, s[28:31], s59
  s_add_u32 s59, s59, 64
  s_buffer_load_dword s66, s[28:31], s59
  s_add_u32 s59, s59, 64
  s_lshl_b32 s4, s48, 2
  s_add_u32 s4, s4, s51
  s_mul_i32 s4, s4, 114688
  s_mul_i32 s5, s51, 7168
  s_add_u32 m0, s5, 2048
  s_nop 0
  buffer_load_dwordx4 v200, s[24:27], s4 offen lds
  s_nop 0
  s_add_u32 m0, s5, 3072
  s_nop 0
  buffer_load_dwordx4 v201, s[24:27], s4 offen lds
  s_add_u32 m0, s5, 4096
  s_nop 0
  buffer_load_dwordx4 v202, s[24:27], s4 offen lds
  s_add_u32 m0, s5, 5120
  s_nop 0
  buffer_load_dwordx4 v203, s[24:27], s4 offen lds
  s_nop 0
  s_add_u32 m0, s5, 6144
  s_nop 0
  buffer_load_dwordx4 v204, s[24:27], s4 offen lds
  s_add_u32 m0, s5, 7168
  s_nop 0
  buffer_load_dwordx4 v205, s[24:27], s4 offen lds
  s_add_u32 m0, s5, 8192
  s_nop 0
  buffer_load_dwordx4 v206, s[24:27], s4 offen lds
  s_waitcnt vmcnt(17)
  s_barrier
  s_add_u32 m0, s60, 114688
  s_nop 0
  buffer_load_dwordx4 v236, s[12:15], s54 offen offset:0 lds
  s_add_u32 s7, s7, 2
  s_cmp_ge_u32 s7, 28
  s_cselect_b32 s3, 786432, 0
  s_cselect_b32 s4, 28, 0
  s_sub_u32 s7, s7, s4
  s_add_u32 s57, s57, s3
  s_add_u32 s57, s57, 393216
  s_cmp_ge_u32 s57, s58
  s_cselect_b32 s3, 6291456, 0
  s_sub_u32 s57, s57, s3
  buffer_load_dwordx4 v237, s[12:15], s54 offen offset:1024 lds
  buffer_load_dwordx4 v238, s[12:15], s54 offen offset:2048 lds
  buffer_load_dwordx4 v239, s[12:15], s54 offen offset:3072 lds
  s_add_u32 m0, s61, 40960
  s_nop 0
  buffer_load_dwordx4 v240, s[16:19], s57 offen  lds
  s_add_u32 s56, s56, 2
  s_cmp_ge_u32 s56, 28
  s_cselect_b32 s3, 256, 0
  s_cselect_b32 s4, 28, 0
  s_sub_u32 s56, s56, s4
  s_add_u32 s54, s54, s3
  s_add_u32 s54, s54, 128
  s_cmp_ge_u32 s54, s55
  s_cselect_b32 s3, 2048, 0
  s_sub_u32 s54, s54, s3
  s_add_u32 m0, s61, 41984
  s_nop 0
  buffer_load_dwordx4 v241, s[16:19], s57 offen  lds
  s_add_u32 m0, s61, 43008
  s_nop 0
  buffer_load_dwordx4 v242, s[16:19], s57 offen  lds
  s_add_u32 m0, s61, 44032
  s_nop 0
  buffer_load_dwordx4 v243, s[16:19], s57 offen  lds
  s_add_u32 m0, s61, 45056
  s_nop 0
  buffer_load_dwordx4 v244, s[16:19], s57 offen  lds
  s_nop 0
  s_add_u32 m0, s61, 46080
  s_nop 0
  buffer_load_dwordx4 v245, s[16:19], s57 offen  lds
  s_buffer_load_dword s66, s[28:31], s59
  s_add_u32 s59, s59, 64
  s_buffer_load_dword s67, s[28:31], s59
  s_add_u32 s59, s59, 64
  s_buffer_load_dword s66, s[28:31], s59
  s_add_u32 s59, s59, 64
  s_buffer_load_dword s67, s[28:31], s59
  s_add_u32 s59, s59, 64
  s_buffer_load_dword s66, s[28:31], s59
  s_add_u32 s59, s59, 64
  s_waitcnt vmcnt(17)
  s_barrier
  s_add_u32 m0, s60, 131072
  s_nop 0
  buffer_load_dwordx4 v236, s[12:15], s54 offen offset:0 lds
  s_add_u32 s7, s7, 2
  s_cmp_ge_u32 s7, 28
  s_cselect_b32 s3, 786432, 0
  s_cselect_b32 s4, 28, 0
  s_sub_u32 s7, s7, s4
  s_add_u32 s57, s57, s3
  s_add_u32 s57, s57, 393216
  s_cmp_ge_u32 s57, s58
  s_cselect_b32 s3, 6291456, 0
  s_sub_u32 s57, s57, s3
  buffer_load_dwordx4 v237, s[12:15], s54 offen offset:1024 lds
  buffer_load_dwordx4 v238, s[12:15], s54 offen offset:2048 lds
  buffer_load_dwordx4 v239, s[12:15], s54 offen offset:3072 lds
  s_add_u32 m0, s61, 65536
  s_nop 0
  buffer_load_dwordx4 v240, s[16:19], s57 offen  lds
  s_add_u32 s56, s56, 2
  s_cmp_ge_u32 s56, 28
  s_cselect_b32 s3, 256, 0
  s_cselect_b32 s4, 28, 0
  s_sub_u32 s56, s56, s4
  s_add_u32 s54, s54, s3
  s_add_u32 s54, s54, 128
  s_cmp_ge_u32 s54, s55
  s_cselect_b32 s3, 2048, 0
  s_sub_u32 s54, s54, s3
  s_add_u32 m0, s61, 66560
  s_nop 0
  buffer_load_dwordx4 v241, s[16:19], s57 offen  lds
  s_add_u32 m0, s61, 67584
  s_nop 0
  buffer_load_dwordx4 v242, s[16:19], s57 offen  lds
  s_add_u32 m0, s61, 68608
  s_nop 0
  buffer_load_dwordx4 v243, s[16:19], s57 offen  lds
  s_nop 0
  s_add_u32 m0, s61, 69632
  s_nop 0
  buffer_load_dwordx4 v244, s[16:19], s57 offen  lds
  s_add_u32 m0, s61, 70656
  s_nop 0
  buffer_load_dwordx4 v245, s[16:19], s57 offen  lds
  s_buffer_load_dword s66, s[28:31], s59
  s_add_u32 s59, s59, 64
  s_buffer_load_dword s67, s[28:31], s59
  s_add_u32 s59, s59, 64
  s_buffer_load_dword s66, s[28:31], s59
  s_add_u32 s59, s59, 64
  s_buffer_load_dword s67, s[28:31], s59
  s_add_u32 s59, s59, 64
  s_buffer_load_dword s66, s[28:31], s59
  s_add_u32 s59, s59, 64
  s_waitcnt vmcnt(10)
  s_barrier
  s_add_u32 m0, s60, 147456
  s_nop 0
  buffer_load_dwordx4 v236, s[12:15], s54 offen offset:0 lds
  s_add_u32 s7, s7, 2
  s_cmp_ge_u32 s7, 28
  s_cselect_b32 s3, 786432, 0
  s_cselect_b32 s4, 28, 0
  s_sub_u32 s7, s7, s4
  s_add_u32 s57, s57, s3
  s_add_u32 s57, s57, 393216
  s_cmp_ge_u32 s57, s58
  s_cselect_b32 s3, 6291456, 0
  s_sub_u32 s57, s57, s3
  buffer_load_dwordx4 v237, s[12:15], s54 offen offset:1024 lds
  s_nop 0
  buffer_load_dwordx4 v238, s[12:15], s54 offen offset:2048 lds
  buffer_load_dwordx4 v239, s[12:15], s54 offen offset:3072 lds
  s_add_u32 m0, s61, 90112
  s_nop 0
  buffer_load_dwordx4 v240, s[16:19], s57 offen  lds
  s_add_u32 s56, s56, 2
  s_cmp_ge_u32 s56, 28
  s_cselect_b32 s3, 256, 0
  s_cselect_b32 s4, 28, 0
  s_sub_u32 s56, s56, s4
  s_add_u32 s54, s54, s3
  s_add_u32 s54, s54, 128
  s_cmp_ge_u32 s54, s55
  s_cselect_b32 s3, 2048, 0
  s_sub_u32 s54, s54, s3
  s_add_u32 m0, s61, 91136
  s_nop 0
  buffer_load_dwordx4 v241, s[16:19], s57 offen  lds
  s_add_u32 m0, s61, 92160
  s_nop 0
  buffer_load_dwordx4 v242, s[16:19], s57 offen  lds
  s_add_u32 m0, s61, 93184
  s_nop 0
  buffer_load_dwordx4 v243, s[16:19], s57 offen  lds
  s_add_u32 m0, s61, 94208
  s_nop 0
  buffer_load_dwordx4 v244, s[16:19], s57 offen  lds
  s_add_u32 m0, s61, 95232
  s_nop 0
  buffer_load_dwordx4 v245, s[16:19], s57 offen  lds
  s_getpc_b64 s[4:5]
Lpc_1008:
  s_sub_u32 s4, s4, Lpc_1008-sequential_preLN__sliding_block__dense_activation_gelu__prompt_kernel
  s_subb_u32 s5, s5, 0
  s_lshr_b32 s3, s2, 3
  s_lshl_b32 s3, s3, 2
  s_add_u32 s3, s3, s51
  s_mul_i32 s3, s3, 6
  v_add_u32 v12, s3, v0
  v_lshlrev_b32_e64 v12, 7, v12
  v_min_u32 v12, Lend-sequential_preLN__sliding_block__dense_activation_gelu__prompt_kernel-4, v12
  s_mov_b64 exec, 0x3f
  global_load_dword v13, v12, s[4:5]
  s_mov_b64 exec, -1
  s_buffer_load_dword s66, s[28:31], s59
  s_add_u32 s59, s59, 64
  s_buffer_load_dword s67, s[28:31], s59
  s_add_u32 s59, s59, 64
  s_buffer_load_dword s66, s[28:31], s59
  s_add_u32 s59, s59, 64
  s_buffer_load_dword s67, s[28:31], s59
  s_add_u32 s59, s59, 64
  s_buffer_load_dword s66, s[28:31], s59
  s_add_u32 s59, s59, 64
  s_waitcnt vmcnt(11)
  s_barrier
  v_lshlrev_b32 v10, 7, v0
  s_mov_b64 s[64:65], 3
  s_mov_b64 exec, s[64:65]
  buffer_load_dword v11, v10, s[44:47], 0 offen sc1
  s_mov_b64 exec, -1
  s_add_u32 m0, s60, 114688
  s_nop 0
  buffer_load_dwordx4 v236, s[12:15], s54 offen offset:0 lds
  s_add_u32 s7, s7, 2
  s_cmp_ge_u32 s7, 28
  s_cselect_b32 s3, 786432, 0
  s_cselect_b32 s4, 28, 0
  s_sub_u32 s7, s7, s4
  s_add_u32 s57, s57, s3
  s_add_u32 s57, s57, 393216
  s_cmp_ge_u32 s57, s58
  s_cselect_b32 s3, 6291456, 0
  s_sub_u32 s57, s57, s3
  buffer_load_dwordx4 v237, s[12:15], s54 offen offset:1024 lds
  buffer_load_dwordx4 v238, s[12:15], s54 offen offset:2048 lds
  buffer_load_dwordx4 v239, s[12:15], s54 offen offset:3072 lds
  s_nop 0
  s_add_u32 m0, s61, 40960
  s_nop 0
  buffer_load_dwordx4 v240, s[16:19], s57 offen  lds
  s_add_u32 m0, s61, 41984
  s_nop 0
  buffer_load_dwordx4 v241, s[16:19], s57 offen  lds
  s_add_u32 m0, s61, 43008
  s_nop 0
  buffer_load_dwordx4 v242, s[16:19], s57 offen  lds
  s_nop 0
  s_add_u32 m0, s61, 44032
  s_nop 0
  buffer_load_dwordx4 v243, s[16:19], s57 offen  lds
  s_add_u32 m0, s61, 45056
  s_nop 0
  buffer_load_dwordx4 v244, s[16:19], s57 offen  lds
  s_add_u32 m0, s61, 46080
  s_nop 0
  buffer_load_dwordx4 v245, s[16:19], s57 offen  lds
  s_nop 0
  s_buffer_load_dword s66, s[28:31], s59
  s_add_u32 s59, s59, 64
  s_buffer_load_dword s67, s[28:31], s59
  s_add_u32 s59, s59, 64
  s_buffer_load_dword s66, s[28:31], s59
  s_add_u32 s59, s59, 64
  s_buffer_load_dword s67, s[28:31], s59
  s_add_u32 s59, s59, 64
  s_buffer_load_dword s66, s[28:31], s59
  s_add_u32 s59, s59, 64
  s_mov_b32 s63, 0
  s_mov_b64 exec, s[64:65]
  s_waitcnt vmcnt(10)
  v_cmp_gt_u32 vcc, 128, v11
  s_cbranch_vccz Lpd_1011
Lpoll_1010:
  buffer_load_dword v11, v10, s[44:47], 0 offen sc1
  s_add_u32 s63, s63, 1
  s_cmp_gt_u32 s63, 200000
  s_cbranch_scc1 Lpd_1011
  s_waitcnt vmcnt(0)
  v_cmp_gt_u32 vcc, 128, v11
  s_cbranch_vccz Lpd_1011
  s_sleep 1
  s_branch Lpoll_1010
Lpd_1011:
  s_mov_b64 exec, -1
  s_barrier
  s_lshl_b32 s4, s48, 14
  s_lshl_b32 s5, s51, 8
  s_add_u32 s4, s4, s5
  s_add_u32 s4, s4, 62914560
  v_and_b32 v3, 15, v0
  v_lshrrev_b32 v4, 4, v0
  v_lshlrev_b32_e64 v3, 4, v3
  v_lshl_add_u32 v5, v4, 10, v3
  buffer_load_dwordx4 v[32:35], v5, s[8:11], s4 offen sc1
  s_add_u32 s4, s4, 4096
  buffer_load_dwordx4 v[36:39], v5, s[8:11], s4 offen sc1
  s_add_u32 s4, s4, 4096
  buffer_load_dwordx4 v[40:43], v5, s[8:11], s4 offen sc1
  s_add_u32 s4, s4, 4096
  buffer_load_dwordx4 v[44:47], v5, s[8:11], s4 offen sc1
  s_lshr_b32 s4, s48, 3
  s_lshl_b32 s4, s4, 4
  s_add_u32 s4, s4, s49
  s_nop 0
  s_mul_i32 s4, s4, 6144
  s_mul_i32 s5, s51, 192
  s_add_u32 s4, s4, s5
  s_add_u32 s4, s4, 63963136
  v_mul_u32_u24 v4, 768, v4
  v_min_u32 v3, 176, v3
  v_add_u32 v5, v4, v3
  buffer_load_dwordx4 v[64:67], v5, s[8:11], s4 offen sc1
  s_add_u32 s4, s4, 3072
  buffer_load_dwordx4 v[68:71], v5, s[8:11], s4 offen sc1
  s_waitcnt vmcnt(6)
  s_barrier
  s_waitcnt vmcnt(0)
  v_pk_add_f32 v[32:33], v[32:33], v[36:37]
  v_pk_add_f32 v[34:35], v[34:35], v[38:39]
  v_pk_add_f32 v[40:41], v[40:41], v[44:45]
  v_pk_add_f32 v[42:43], v[42:43], v[46:47]
  v_pk_add_f32 v[64:65], v[64:65], v[68:69]
  s_nop 0
  v_pk_add_f32 v[66:67], v[66:67], v[70:71]
  v_pk_add_f32 v[32:33], v[32:33], v[40:41]
  v_pk_add_f32 v[34:35], v[34:35], v[42:43]
  v_mov_b32 v36, v32
  v_mov_b32 v68, v64
  v_mov_b32 v37, v33
  v_mov_b32 v69, v65
  v_mov_b32 v38, v34
  v_mov_b32 v70, v66
  v_mov_b32 v39, v35
  v_mov_b32 v71, v67
  s_nop 0
  v_permlane32_swap_b32 v32, v36
  v_permlane32_swap_b32 v64, v68
  v_permlane32_swap_b32 v33, v37
  v_permlane32_swap_b32 v65, v69
  v_permlane32_swap_b32 v34, v38
  v_permlane32_swap_b32 v66, v70
  v_permlane32_swap_b32 v35, v39
  v_permlane32_swap_b32 v67, v71
  s_nop 0
  v_pk_add_f32 v[32:33], v[32:33], v[36:37]
  v_pk_add_f32 v[34:35], v[34:35], v[38:39]
  v_pk_add_f32 v[64:65], v[64:65], v[68:69]
  v_pk_add_f32 v[66:67], v[66:67], v[70:71]
  v_mov_b32 v36, v32
  v_mov_b32 v68, v64
  v_mov_b32 v37, v33
  v_mov_b32 v69, v65
  v_mov_b32 v38, v34
  v_mov_b32 v70, v66
  v_mov_b32 v39, v35
  v_mov_b32 v71, v67
  s_nop 0
  v_permlane16_swap_b32 v32, v36
  v_permlane16_swap_b32 v64, v68
  v_permlane16_swap_b32 v33, v37
  v_permlane16_swap_b32 v65, v69
  v_permlane16_swap_b32 v34, v38
  v_permlane16_swap_b32 v66, v70
  v_permlane16_swap_b32 v35, v39
  v_permlane16_swap_b32 v67, v71
  s_nop 0
  v_pk_add_f32 v[32:33], v[32:33], v[36:37]
  v_pk_add_f32 v[34:35], v[34:35], v[38:39]
  v_pk_add_f32 v[64:65], v[64:65], v[68:69]
  v_pk_add_f32 v[66:67], v[66:67], v[70:71]
  v_mul_f32 v36, 0x3a800000, v32
  v_mul_f32 v37, 0x3a800000, v34
  v_mul_f32 v38, 0x3a800000, v33
  v_mul_f32 v39, 0x3a800000, v35
  v_fma_f32 v38, -v36, v36, v38
  v_fma_f32 v39, -v37, v37, v39
  v_max_f32 v38, 0, v38
  v_max_f32 v39, 0, v39
  v_add_f32 v38, 0x3727c5ac, v38
  v_add_f32 v39, 0x3727c5ac, v39
  v_rsq_f32 v38, v38
  v_rsq_f32 v39, v39
  s_lshl_b32 s3, s51, 7
  s_add_u32 s3, s3, 0
  v_pk_mul_f32 v[36:37], v[36:37], v[38:39] neg_lo:[1,0] neg_hi:[1,0]
  v_lshl_add_u32 v3, v0, 3, s3
  s_mul_i32 s3, s51, 192
  s_add_u32 s3, s3, 1024
  v_lshl_add_u32 v4, v0, 4, s3
  s_mov_b64 exec, 0xffff
  ds_write_b64 v3, v[38:39]
  ds_write_b64 v3, v[36:37] offset:512
  s_mov_b64 exec, 0xfff
  ds_write_b128 v4, v[64:67]
  s_mov_b64 exec, -1
  s_waitcnt lgkmcnt(0)
  s_barrier
  s_lshl_b32 s62, s49, 1
  s_add_u32 s62, s62, s52
  s_lshl_b32 s4, s53, 4
  s_mul_i32 s4, s4, 2048
  s_add_u32 s66, s4, 2097152
  s_mul_i32 s59, s62, 65536
  s_add_u32 s59, s59, s4
  s_mul_i32 s67, s51, 2048
  s_and_b32 s100, s49, 3
  s_mul_i32 s100, s100, 2
  s_sub_u32 s100, 6, s100
  s_and_b32 s3, s48, 7
  s_mul_i32 s3, s3, 4
  s_add_u32 s100, s100, s3
  s_add_u32 s100, s100, s52
  s_cmp_ge_u32 s100, 30
  s_cselect_b32 s3, 30, 0
  s_sub_u32 s100, s100, s3
  s_lshl_b32 s4, s49, 7
  v_lshrrev_b32 v3, 3, v0
  v_and_b32 v4, 7, v0
  v_and_b32 v5, 6, v3
  v_xor_b32 v4, v4, v5
  v_lshlrev_b32 v4, 4, v4
  v_mul_u32_u24 v5, 2048, v3
  v_add3_u32 v5, v5, v4, s4
  v_add_u32 v254, 0, v5
  v_add_u32 v255, 16384, v5
  s_lshl_b32 s3, s49, 1
  s_add_u32 s3, s3, s53
  s_lshl_b32 s3, s3, 4
  s_add_u32 s4, s48, s52
  s_add_u32 s3, s3, s4
  s_lshl_b32 s3, s3, 13
  s_add_u32 s3, s3, 8372224
  s_cmp_ge_u32 s4, 2
  s_cselect_b32 s4, s3, 268435456
  s_mul_i32 s5, s53, 24576
  s_lshl_b32 s6, s52, 13
  s_add_u32 s5, s5, s6
  s_mov_b32 s56, s4
  s_mov_b32 s64, s5
  ds_read_b64_tr_b16 v[64:65], v28 offset:0
  ds_read_b64_tr_b16 v[66:67], v28 offset:7168
  s_nop 0
  ds_read_b64_tr_b16 v[68:69], v29 offset:0
  ds_read_b64_tr_b16 v[70:71], v29 offset:7168
  ds_read_b64_tr_b16 v[72:73], v30 offset:0
  ds_read_b64_tr_b16 v[74:75], v30 offset:7168
  ds_read_b64_tr_b16 v[76:77], v31 offset:0
  ds_read_b64_tr_b16 v[78:79], v31 offset:7168
  s_waitcnt lgkmcnt(0)
  v_mfma_f32_16x16x32_bf16 v[96:99], v[64:67], v[24:27], 0
  s_nop 0
  v_mfma_f32_16x16x32_bf16 v[100:103], v[68:71], v[24:27], 0
  v_mfma_f32_16x16x32_bf16 v[104:107], v[72:75], v[24:27], 0
  v_mfma_f32_16x16x32_bf16 v[108:111], v[76:79], v[24:27], 0
  ds_read_b64_tr_b16 v[80:81], v28 offset:14336
  ds_read_b64_tr_b16 v[82:83], v28 offset:21504
  ds_read_b64_tr_b16 v[84:85], v29 offset:14336
  ds_read_b64_tr_b16 v[86:87], v29 offset:21504
  ds_read_b64_tr_b16 v[88:89], v30 offset:14336
  ds_read_b64_tr_b16 v[90:91], v30 offset:21504
  ds_read_b64_tr_b16 v[92:93], v31 offset:14336
  ds_read_b64_tr_b16 v[94:95], v31 offset:21504
  s_waitcnt lgkmcnt(0)
  v_mfma_f32_16x16x32_bf16 v[96:99], v[80:83], v[24:27], v[96:99]
  v_mfma_f32_16x16x32_bf16 v[100:103], v[84:87], v[24:27], v[100:103]
  v_mfma_f32_16x16x32_bf16 v[104:107], v[88:91], v[24:27], v[104:107]
  v_mfma_f32_16x16x32_bf16 v[108:111], v[92:95], v[24:27], v[108:111]
  v_and_b32 v3, 15, v0
  v_cmp_eq_u32 vcc, 0, v3
  v_and_b32_e64 v3, 48, v0
  s_lshl_b32 s63, s49, 4
  s_add_u32 s63, s63, s48
  s_mul_i32 s63, s63, 896
  s_add_u32 s63, s63, 66060288
  s_nop 3
  s_mov_b64 exec, vcc
  s_mul_i32 s3, s51, 4
  s_add_u32 s3, s3, 0
  s_min_u32 s3, s3, 13
  s_lshl_b32 s3, s3, 6
  s_add_u32 s3, s3, s63
  buffer_store_dwordx4 v[96:99], v3, s[8:11], s3 offen sc1
  s_mul_i32 s3, s51, 4
  s_add_u32 s3, s3, 1
  s_min_u32 s3, s3, 13
  s_lshl_b32 s3, s3, 6
  s_add_u32 s3, s3, s63
  buffer_store_dwordx4 v[100:103], v3, s[8:11], s3 offen sc1
  s_mul_i32 s3, s51, 4
  s_add_u32 s3, s3, 2
  s_min_u32 s3, s3, 13
  s_lshl_b32 s3, s3, 6
  s_add_u32 s3, s3, s63
  buffer_store_dwordx4 v[104:107], v3, s[8:11], s3 offen sc1
  s_mul_i32 s3, s51, 4
  s_add_u32 s3, s3, 3
  s_min_u32 s3, s3, 13
  s_lshl_b32 s3, s3, 6
  s_add_u32 s3, s3, s63
  buffer_store_dwordx4 v[108:111], v3, s[8:11], s3 offen sc1
  s_mov_b64 exec, -1
  s_and_b32 s54, s50, 1
  s_lshr_b32 s55, s51, 1
  s_mul_i32 s3, s54, 24576
  s_lshl_b32 s4, s55, 11
  s_add_u32 s3, s3, s4
  s_add_u32 s3, s3, 49152
  v_add_u32 v4, s3, v1
  s_lshl_b32 s3, s54, 13
  s_add_u32 s3, s3, s4
  s_add_u32 s3, s3, 147456
  v_add_u32 v2, s3, v1
  s_lshl_b32 s3, s55, 1
  s_lshl_b32 s4, s48, 3
  s_add_u32 s3, s3, s4
  s_sub_u32 s7, 16, s3
  s_cmp_gt_i32 s7, 0
  s_cselect_b32 s5, 0xf149f2ca, 0
  v_and_b32 v3, 15, v0
  v_lshrrev_b32 v5, 4, v0
  v_lshlrev_b32 v5, 2, v5
  v_mov_b32 v6, 0xf149f2ca
  v_mov_b32 v8, s5
  v_add_u32 v7, 0, v5
  v_cmp_gt_u32 vcc, v7, v3
  v_mov_b32 v24, 0x3f803f80
  s_nop 0
  v_cndmask_b32 v16, v6, v8, vcc
  v_cndmask_b32 v20, 0, v6, vcc
  v_add_u32 v7, 1, v5
  v_cmp_gt_u32 vcc, v7, v3
  v_mov_b32 v25, 0x3f803f80
  s_nop 0
  v_cndmask_b32 v17, v6, v8, vcc
  v_cndmask_b32 v21, 0, v6, vcc
  v_add_u32 v7, 2, v5
  v_cmp_gt_u32 vcc, v7, v3
  v_mov_b32 v26, 0x3f803f80
  s_nop 0
  v_cndmask_b32 v18, v6, v8, vcc
  v_cndmask_b32 v22, 0, v6, vcc
  v_add_u32 v7, 3, v5
  v_cmp_gt_u32 vcc, v7, v3
  v_mov_b32 v27, 0x3f803f80
  s_nop 0
  v_cndmask_b32 v19, v6, v8, vcc
  v_cndmask_b32 v23, 0, v6, vcc
  s_lshl_b32 s3, s2, 3
  s_add_u32 s3, s3, s50
  s_mul_i32 s62, s3, 3584
  s_lshl_b32 s3, s48, 4
  s_add_u32 s3, s3, s49
  s_lshl_b32 s3, s3, 1
  s_add_u32 s3, s3, s54
  s_lshl_b32 s3, s3, 2
  s_add_u32 s3, s3, s55
  s_lshl_b32 s3, s3, 11
  s_add_u32 s6, s3, 16777216
  v_mov_b32 v168, 0
  v_mov_b32 v169, 0
  s_barrier
  s_setprio 2
  s_min_u32 s65, s48, 2
  s_cmp_eq_u32 s65, 0
  s_cbranch_scc1 Lkv_1012
  s_lshl_b32 s3, s48, 4
  s_add_u32 s3, s3, s49
  s_lshl_b32 s3, s3, 10
  s_add_u32 s3, s3, 67108864
  s_nop 0
  s_mov_b32 s63, 0
  s_mov_b64 exec, 1
Lcw_1013:
  v_mov_b32_e64 v5, 0
  buffer_atomic_add v5, off, s[8:11], s3 sc0 sc1
  s_add_u32 s63, s63, 1
  s_cmp_gt_u32 s63, 200000
  s_cbranch_scc1 Lcd_1014
  s_waitcnt vmcnt(0)
  v_cmp_gt_u32 vcc, s65, v5
  s_cbranch_vccnz Lcw_1013
Lcd_1014:
  s_mov_b64 exec, -1
Lkv_1012:
  s_add_u32 m0, s64, 49152
  s_add_u32 s3, s56, 0
  buffer_load_dwordx4 v1, s[8:11], s3 offen offset:0 sc1 lds
  buffer_load_dwordx4 v1, s[8:11], s3 offen offset:1024 sc1 lds
  buffer_load_dwordx4 v1, s[8:11], s3 offen offset:2048 sc1 lds
  buffer_load_dwordx4 v1, s[8:11], s3 offen offset:3072 sc1 lds
  s_add_u32 m0, s64, 53248
  s_add_u32 s3, s56, 4096
  buffer_load_dwordx4 v1, s[8:11], s3 offen offset:0 sc1 lds
  buffer_load_dwordx4 v1, s[8:11], s3 offen offset:1024 sc1 lds
  buffer_load_dwordx4 v1, s[8:11], s3 offen offset:2048 sc1 lds
  buffer_load_dwordx4 v1, s[8:11], s3 offen offset:3072 sc1 lds
  s_add_u32 m0, s64, 98304
  s_add_u32 s3, s56, 4194304
  buffer_load_dwordx4 v1, s[8:11], s3 offen offset:0 sc1 lds
  buffer_load_dwordx4 v1, s[8:11], s3 offen offset:1024 sc1 lds
  buffer_load_dwordx4 v1, s[8:11], s3 offen offset:2048 sc1 lds
  buffer_load_dwordx4 v1, s[8:11], s3 offen offset:3072 sc1 lds
  s_add_u32 m0, s64, 102400
  s_add_u32 s3, s56, 4198400
  buffer_load_dwordx4 v1, s[8:11], s3 offen offset:0 sc1 lds
  buffer_load_dwordx4 v1, s[8:11], s3 offen offset:1024 sc1 lds
  buffer_load_dwordx4 v1, s[8:11], s3 offen offset:2048 sc1 lds
  buffer_load_dwordx4 v1, s[8:11], s3 offen offset:3072 sc1 lds
  ds_read_b128 v[8:11], v2
  ds_read_b128 v[12:15], v2 offset:1024
  s_setprio 1
  v_mov_b32 v238, s5
  v_mov_b32 v239, s5
  v_mov_b32 v240, s5
  v_mov_b32 v241, s5
  s_waitcnt vmcnt(8) lgkmcnt(0)
  s_barrier
  ds_read_b128 v[28:31], v4 offset:0
  ds_read_b128 v[32:35], v4 offset:1024
  ds_read_b128 v[36:39], v4 offset:2048
  ds_read_b128 v[40:43], v4 offset:3072
  ds_read_b128 v[44:47], v4 offset:4096
  ds_read_b128 v[48:51], v4 offset:5120
  ds_read_b128 v[52:55], v4 offset:6144
  s_nop 0
  ds_read_b128 v[56:59], v4 offset:7168
  ds_read_b128 v[60:63], v4 offset:8192
  ds_read_b128 v[64:67], v4 offset:9216
  ds_read_b128 v[68:71], v4 offset:10240
  ds_read_b128 v[72:75], v4 offset:11264
  ds_read_b128 v[76:79], v4 offset:12288
  ds_read_b128 v[80:83], v4 offset:13312
  ds_read_b128 v[84:87], v4 offset:14336
  ds_read_b128 v[88:91], v4 offset:15360
  ds_read_b128 v[92:95], v4 offset:16384
  ds_read_b128 v[96:99], v4 offset:17408
  v_add_u32 v4, 49152, v4
  s_cmp_gt_i32 s7, 0
  s_cbranch_scc1 Lsslow_1015
  s_waitcnt lgkmcnt(15)
  v_mfma_f32_16x16x32_bf16 v[100:103], v[28:31], v[8:11], v[16:19]
  v_mfma_f32_16x16x32_bf16 v[104:107], v[32:35], v[8:11], 0
  s_nop 0
  v_mfma_f32_16x16x32_bf16 v[170:173], v[32:35], v[12:15], v[16:19]
  s_waitcnt lgkmcnt(14)
  v_mfma_f32_16x16x32_bf16 v[108:111], v[36:39], v[8:11], 0
  v_mfma_f32_16x16x32_bf16 v[174:177], v[36:39], v[12:15], 0
  v_mfma_f32_16x16x32_bf16 v[112:115], v[40:43], v[8:11], 0
  s_nop 2
  v_max_f32 v2, v100, v101
  v_max_f32_e64 v3, v102, v103
  v_mfma_f32_16x16x32_bf16 v[178:181], v[40:43], v[12:15], 0
  s_waitcnt lgkmcnt(12)
  v_mfma_f32_16x16x32_bf16 v[116:119], v[44:47], v[8:11], 0
  v_max3_f32 v2, v2, v104, v105
  v_max3_f32 v3, v3, v106, v107
  v_mfma_f32_16x16x32_bf16 v[182:185], v[44:47], v[12:15], 0
  v_max_f32 v6, v170, v171
  v_max_f32 v7, v172, v173
  v_mfma_f32_16x16x32_bf16 v[120:123], v[48:51], v[8:11], 0
  v_max3_f32 v2, v2, v108, v109
  v_max3_f32 v3, v3, v110, v111
  v_mfma_f32_16x16x32_bf16 v[186:189], v[48:51], v[12:15], 0
  v_max3_f32 v6, v6, v174, v175
  v_max3_f32 v7, v7, v176, v177
  s_waitcnt lgkmcnt(10)
  v_mfma_f32_16x16x32_bf16 v[124:127], v[52:55], v[8:11], 0
  v_max3_f32 v2, v2, v112, v113
  v_max3_f32 v3, v3, v114, v115
  v_mfma_f32_16x16x32_bf16 v[190:193], v[52:55], v[12:15], 0
  s_nop 0
  v_max3_f32 v6, v6, v178, v179
  v_max3_f32 v7, v7, v180, v181
  v_mfma_f32_16x16x32_bf16 v[128:131], v[56:59], v[8:11], 0
  v_max3_f32 v2, v2, v116, v117
  v_max3_f32 v3, v3, v118, v119
  v_mfma_f32_16x16x32_bf16 v[194:197], v[56:59], v[12:15], 0
  v_max3_f32 v6, v6, v182, v183
  v_max3_f32 v7, v7, v184, v185
  s_waitcnt vmcnt(0)
  s_barrier
  s_waitcnt lgkmcnt(8)
  v_mfma_f32_16x16x32_bf16 v[132:135], v[60:63], v[8:11], 0
  v_max3_f32 v2, v2, v120, v121
  v_max3_f32 v3, v3, v122, v123
  v_mfma_f32_16x16x32_bf16 v[198:201], v[60:63], v[12:15], 0
  v_max3_f32 v6, v6, v186, v187
  v_max3_f32 v7, v7, v188, v189
  s_nop 0
  v_mfma_f32_16x16x32_bf16 v[136:139], v[64:67], v[8:11], 0
  v_max3_f32 v2, v2, v124, v125
  v_max3_f32 v3, v3, v126, v127
  v_mfma_f32_16x16x32_bf16 v[202:205], v[64:67], v[12:15], 0
  v_max3_f32 v6, v6, v190, v191
  v_max3_f32 v7, v7, v192, v193
  s_waitcnt lgkmcnt(6)
  v_mfma_f32_16x16x32_bf16 v[140:143], v[68:71], v[8:11], 0
  s_nop 0
  v_max3_f32 v2, v2, v128, v129
  v_max3_f32 v3, v3, v130, v131
  v_mfma_f32_16x16x32_bf16 v[206:209], v[68:71], v[12:15], 0
  v_max3_f32 v6, v6, v194, v195
  v_max3_f32 v7, v7, v196, v197
  v_mfma_f32_16x16x32_bf16 v[144:147], v[72:75], v[8:11], 0
  v_max3_f32 v2, v2, v132, v133
  v_max3_f32 v3, v3, v134, v135
  v_mfma_f32_16x16x32_bf16 v[210:213], v[72:75], v[12:15], 0
  v_max3_f32 v6, v6, v198, v199
  v_max3_f32 v7, v7, v200, v201
  s_waitcnt lgkmcnt(4)
  v_mfma_f32_16x16x32_bf16 v[148:151], v[76:79], v[8:11], 0
  v_max3_f32 v2, v2, v136, v137
  v_max3_f32 v3, v3, v138, v139
  v_mfma_f32_16x16x32_bf16 v[214:217], v[76:79], v[12:15], 0
  s_nop 0
  v_max3_f32 v6, v6, v202, v203
  v_max3_f32 v7, v7, v204, v205
  v_mfma_f32_16x16x32_bf16 v[152:155], v[80:83], v[8:11], 0
  v_max3_f32 v2, v2, v140, v141
  v_max3_f32 v3, v3, v142, v143
  v_mfma_f32_16x16x32_bf16 v[218:221], v[80:83], v[12:15], 0
  v_max3_f32 v6, v6, v206, v207
  v_max3_f32 v7, v7, v208, v209
  s_waitcnt lgkmcnt(2)
  v_mfma_f32_16x16x32_bf16 v[156:159], v[84:87], v[8:11], 0
  v_max3_f32 v2, v2, v144, v145
  v_max3_f32 v3, v3, v146, v147
  v_mfma_f32_16x16x32_bf16 v[222:225], v[84:87], v[12:15], 0
  v_max3_f32 v6, v6, v210, v211
  v_max3_f32 v7, v7, v212, v213
  v_mfma_f32_16x16x32_bf16 v[160:163], v[88:91], v[8:11], 0
  s_nop 0
  v_max3_f32 v2, v2, v148, v149
  v_max3_f32 v3, v3, v150, v151
  v_mfma_f32_16x16x32_bf16 v[226:229], v[88:91], v[12:15], 0
  v_max3_f32 v6, v6, v214, v215
  v_max3_f32 v7, v7, v216, v217
  s_waitcnt lgkmcnt(0)
  v_mfma_f32_16x16x32_bf16 v[164:167], v[92:95], v[8:11], v[20:23]
  v_max3_f32 v2, v2, v152, v153
  s_nop 0
  v_max3_f32 v3, v3, v154, v155
  v_mfma_f32_16x16x32_bf16 v[230:233], v[92:95], v[12:15], 0
  v_max3_f32 v6, v6, v218, v219
  v_max3_f32 v7, v7, v220, v221
  v_max3_f32 v2, v2, v156, v157
  v_max3_f32 v3, v3, v158, v159
  v_mfma_f32_16x16x32_bf16 v[234:237], v[96:99], v[12:15], v[20:23]
  v_max3_f32 v6, v6, v222, v223
  v_max3_f32 v7, v7, v224, v225
  ds_read_b128 v[28:31], v4 offset:0
  ds_read_b128 v[32:35], v4 offset:1024
  ds_read_b128 v[36:39], v4 offset:2048
  ds_read_b128 v[40:43], v4 offset:3072
  ds_read_b128 v[44:47], v4 offset:4096
  ds_read_b128 v[48:51], v4 offset:5120
  v_max3_f32 v2, v2, v160, v161
  v_max3_f32 v3, v3, v162, v163
  v_max3_f32 v6, v6, v226, v227
  v_max3_f32 v7, v7, v228, v229
  ds_read_b128 v[52:55], v4 offset:6144
  ds_read_b128 v[56:59], v4 offset:7168
  ds_read_b128 v[60:63], v4 offset:8192
  ds_read_b128 v[64:67], v4 offset:9216
  ds_read_b128 v[68:71], v4 offset:10240
  ds_read_b128 v[72:75], v4 offset:11264
  v_max3_f32 v2, v2, v164, v165
  v_max3_f32 v3, v3, v166, v167
  v_max3_f32 v6, v6, v230, v231
  v_max3_f32 v7, v7, v232, v233
  ds_read_b128 v[76:79], v4 offset:12288
  ds_read_b128 v[80:83], v4 offset:13312
  ds_read_b128 v[84:87], v4 offset:14336
  ds_read_b128 v[88:91], v4 offset:15360
  ds_read_b128 v[92:95], v4 offset:16384
  ds_read_b128 v[96:99], v4 offset:17408
  v_max3_f32 v6, v6, v234, v235
  v_max3_f32 v7, v7, v236, v237
Lsdone_1016:
  v_max_f32 v2, v2, v3
  v_max_f32 v6, v6, v7
  v_mov_b32 v3, v2
  v_mov_b32 v7, v6
  s_nop 0
  v_permlane32_swap_b32 v2, v3
  v_permlane32_swap_b32 v6, v7
  s_nop 0
  v_max_f32 v2, v2, v3
  v_max_f32 v6, v6, v7
  v_mov_b32 v3, v2
  v_mov_b32 v7, v6
  s_nop 0
  v_permlane16_swap_b32 v2, v3
  v_permlane16_swap_b32 v6, v7
  s_nop 0
  v_max_f32 v2, v2, v3
  v_max_f32 v6, v6, v7
  v_pk_add_f32 v[100:101], v[100:101], v[2:3] op_sel_hi:[1,0] neg_lo:[0,1] neg_hi:[0,1]
  v_pk_add_f32 v[102:103], v[102:103], v[2:3] op_sel_hi:[1,0] neg_lo:[0,1] neg_hi:[0,1]
  v_pk_add_f32 v[104:105], v[104:105], v[2:3] op_sel_hi:[1,0] neg_lo:[0,1] neg_hi:[0,1]
  v_pk_add_f32 v[106:107], v[106:107], v[2:3] op_sel_hi:[1,0] neg_lo:[0,1] neg_hi:[0,1]
  v_exp_f32 v100, v100
  v_exp_f32 v101, v101
  v_exp_f32 v102, v102
  v_exp_f32 v103, v103
  v_exp_f32 v104, v104
  v_exp_f32 v105, v105
  v_exp_f32 v106, v106
  v_exp_f32 v107, v107
  v_cvt_pk_bf16_f32 v100, v100, v101
  v_cvt_pk_bf16_f32 v101, v102, v103
  v_cvt_pk_bf16_f32 v102, v104, v105
  v_cvt_pk_bf16_f32 v103, v106, v107
  v_pk_add_f32 v[108:109], v[108:109], v[2:3] op_sel_hi:[1,0] neg_lo:[0,1] neg_hi:[0,1]
  v_pk_add_f32 v[110:111], v[110:111], v[2:3] op_sel_hi:[1,0] neg_lo:[0,1] neg_hi:[0,1]
  v_pk_add_f32 v[112:113], v[112:113], v[2:3] op_sel_hi:[1,0] neg_lo:[0,1] neg_hi:[0,1]
  v_pk_add_f32 v[114:115], v[114:115], v[2:3] op_sel_hi:[1,0] neg_lo:[0,1] neg_hi:[0,1]
  s_waitcnt lgkmcnt(0)
  v_exp_f32 v108, v108
  v_exp_f32_e64 v109, v109
  v_mfma_f32_16x16x32_bf16 v[238:241], v[28:31], v[100:103], 0
  v_exp_f32 v110, v110
  v_exp_f32 v111, v111
  v_mfma_f32_16x16x32_bf16 v[242:245], v[32:35], v[100:103], 0
  v_exp_f32 v112, v112
  v_exp_f32 v113, v113
  v_mfma_f32_16x16x32_bf16 v[246:249], v[24:27], v[100:103], 0
  v_exp_f32 v114, v114
  v_exp_f32_e64 v115, v115
  s_setprio 1
  s_add_u32 m0, s67, 0
  s_nop 0
  buffer_load_dwordx4 v254, s[20:23], s59 offen  lds
  s_add_u32 m0, s67, 1024
  s_nop 0
  buffer_load_dwordx4 v255, s[20:23], s59 offen  lds
  v_cvt_pk_bf16_f32 v104, v108, v109
  v_cvt_pk_bf16_f32 v105, v110, v111
  v_cvt_pk_bf16_f32 v106, v112, v113
  v_cvt_pk_bf16_f32 v107, v114, v115
  s_nop 0
  v_pk_add_f32 v[116:117], v[116:117], v[2:3] op_sel_hi:[1,0] neg_lo:[0,1] neg_hi:[0,1]
  v_pk_add_f32 v[118:119], v[118:119], v[2:3] op_sel_hi:[1,0] neg_lo:[0,1] neg_hi:[0,1]
  v_pk_add_f32 v[120:121], v[120:121], v[2:3] op_sel_hi:[1,0] neg_lo:[0,1] neg_hi:[0,1]
  v_pk_add_f32 v[122:123], v[122:123], v[2:3] op_sel_hi:[1,0] neg_lo:[0,1] neg_hi:[0,1]
  v_exp_f32 v116, v116
  v_exp_f32 v117, v117
  v_mfma_f32_16x16x32_bf16 v[238:241], v[36:39], v[104:107], v[238:241]
  v_exp_f32 v118, v118
  v_exp_f32 v119, v119
  v_mfma_f32_16x16x32_bf16 v[242:245], v[40:43], v[104:107], v[242:245]
  v_exp_f32 v120, v120
  v_exp_f32 v121, v121
  v_mfma_f32_16x16x32_bf16 v[246:249], v[24:27], v[104:107], v[246:249]
  v_exp_f32 v122, v122
  v_exp_f32 v123, v123
  v_cvt_pk_bf16_f32 v108, v116, v117
  v_cvt_pk_bf16_f32 v109, v118, v119
  v_cvt_pk_bf16_f32 v110, v120, v121
  v_cvt_pk_bf16_f32 v111, v122, v123
  v_pk_add_f32 v[124:125], v[124:125], v[2:3] op_sel_hi:[1,0] neg_lo:[0,1] neg_hi:[0,1]
  v_pk_add_f32 v[126:127], v[126:127], v[2:3] op_sel_hi:[1,0] neg_lo:[0,1] neg_hi:[0,1]
  v_pk_add_f32 v[128:129], v[128:129], v[2:3] op_sel_hi:[1,0] neg_lo:[0,1] neg_hi:[0,1]
  v_pk_add_f32 v[130:131], v[130:131], v[2:3] op_sel_hi:[1,0] neg_lo:[0,1] neg_hi:[0,1]
  v_exp_f32 v124, v124
  v_exp_f32 v125, v125
  v_mfma_f32_16x16x32_bf16 v[238:241], v[44:47], v[108:111], v[238:241]
  v_exp_f32 v126, v126
  v_exp_f32 v127, v127
  v_mfma_f32_16x16x32_bf16 v[242:245], v[48:51], v[108:111], v[242:245]
  v_exp_f32 v128, v128
  v_exp_f32 v129, v129
  v_mfma_f32_16x16x32_bf16 v[246:249], v[24:27], v[108:111], v[246:249]
  v_exp_f32 v130, v130
  v_exp_f32_e64 v131, v131
  s_setprio 1
  s_sub_u32 s3, s100, s52
  s_mul_i32 s3, s3, 65536
  s_add_u32 s59, s59, s3
  s_add_u32 s59, s59, 131072
  s_cmp_ge_u32 s59, s66
  s_cselect_b32 s3, 2097152, 0
  s_sub_u32 s59, s59, s3
  s_add_u32 m0, s67, 8192
  s_nop 0
  buffer_load_dwordx4 v254, s[20:23], s59 offen  lds
  s_add_u32 m0, s67, 9216
  s_nop 0
  buffer_load_dwordx4 v255, s[20:23], s59 offen  lds
  v_cvt_pk_bf16_f32 v112, v124, v125
  v_cvt_pk_bf16_f32 v113, v126, v127
  v_cvt_pk_bf16_f32 v114, v128, v129
  v_cvt_pk_bf16_f32 v115, v130, v131
  v_pk_add_f32 v[132:133], v[132:133], v[2:3] op_sel_hi:[1,0] neg_lo:[0,1] neg_hi:[0,1]
  v_pk_add_f32 v[134:135], v[134:135], v[2:3] op_sel_hi:[1,0] neg_lo:[0,1] neg_hi:[0,1]
  v_pk_add_f32 v[136:137], v[136:137], v[2:3] op_sel_hi:[1,0] neg_lo:[0,1] neg_hi:[0,1]
  v_pk_add_f32 v[138:139], v[138:139], v[2:3] op_sel_hi:[1,0] neg_lo:[0,1] neg_hi:[0,1]
  v_exp_f32 v132, v132
  v_exp_f32 v133, v133
  v_mfma_f32_16x16x32_bf16 v[238:241], v[52:55], v[112:115], v[238:241]
  v_exp_f32 v134, v134
  v_exp_f32 v135, v135
  v_mfma_f32_16x16x32_bf16 v[242:245], v[56:59], v[112:115], v[242:245]
  v_exp_f32 v136, v136
  v_exp_f32 v137, v137
  v_mfma_f32_16x16x32_bf16 v[246:249], v[24:27], v[112:115], v[246:249]
  v_exp_f32 v138, v138
  v_exp_f32 v139, v139
  v_cvt_pk_bf16_f32 v116, v132, v133
  v_cvt_pk_bf16_f32 v117, v134, v135
  v_cvt_pk_bf16_f32 v118, v136, v137
  v_cvt_pk_bf16_f32 v119, v138, v139
  v_pk_add_f32 v[140:141], v[140:141], v[2:3] op_sel_hi:[1,0] neg_lo:[0,1] neg_hi:[0,1]
  v_pk_add_f32 v[142:143], v[142:143], v[2:3] op_sel_hi:[1,0] neg_lo:[0,1] neg_hi:[0,1]
  v_pk_add_f32 v[144:145], v[144:145], v[2:3] op_sel_hi:[1,0] neg_lo:[0,1] neg_hi:[0,1]
  v_pk_add_f32 v[146:147], v[146:147], v[2:3] op_sel_hi:[1,0] neg_lo:[0,1] neg_hi:[0,1]
  v_exp_f32 v140, v140
  v_exp_f32 v141, v141
  v_mfma_f32_16x16x32_bf16 v[238:241], v[60:63], v[116:119], v[238:241]
  v_exp_f32 v142, v142
  v_exp_f32 v143, v143
  v_mfma_f32_16x16x32_bf16 v[242:245], v[64:67], v[116:119], v[242:245]
  v_exp_f32 v144, v144
  v_exp_f32 v145, v145
  v_mfma_f32_16x16x32_bf16 v[246:249], v[24:27], v[116:119], v[246:249]
  v_exp_f32 v146, v146
  v_exp_f32 v147, v147
  v_cvt_pk_bf16_f32 v120, v140, v141
  v_cvt_pk_bf16_f32 v121, v142, v143
  v_cvt_pk_bf16_f32 v122, v144, v145
  v_cvt_pk_bf16_f32 v123, v146, v147
  v_pk_add_f32 v[148:149], v[148:149], v[2:3] op_sel_hi:[1,0] neg_lo:[0,1] neg_hi:[0,1]
  v_pk_add_f32 v[150:151], v[150:151], v[2:3] op_sel_hi:[1,0] neg_lo:[0,1] neg_hi:[0,1]
  v_pk_add_f32 v[152:153], v[152:153], v[2:3] op_sel_hi:[1,0] neg_lo:[0,1] neg_hi:[0,1]
  v_pk_add_f32 v[154:155], v[154:155], v[2:3] op_sel_hi:[1,0] neg_lo:[0,1] neg_hi:[0,1]
  v_exp_f32 v148, v148
  v_exp_f32 v149, v149
  v_mfma_f32_16x16x32_bf16 v[238:241], v[68:71], v[120:123], v[238:241]
  v_exp_f32 v150, v150
  v_exp_f32 v151, v151
  v_mfma_f32_16x16x32_bf16 v[242:245], v[72:75], v[120:123], v[242:245]
  v_exp_f32 v152, v152
  v_exp_f32 v153, v153
  v_mfma_f32_16x16x32_bf16 v[246:249], v[24:27], v[120:123], v[246:249]
  v_exp_f32 v154, v154
  v_exp_f32_e64 v155, v155
  s_setprio 1
  s_add_u32 s100, s100, 2
  s_cmp_ge_u32 s100, 30
  s_cselect_b32 s3, 131072, 0
  s_cselect_b32 s4, 30, 0
  s_sub_u32 s100, s100, s4
  s_add_u32 s59, s59, s3
  s_add_u32 s59, s59, 131072
  s_cmp_ge_u32 s59, s66
  s_cselect_b32 s3, 2097152, 0
  s_sub_u32 s59, s59, s3
  s_add_u32 m0, s67, 16384
  s_nop 0
  buffer_load_dwordx4 v254, s[20:23], s59 offen  lds
  s_add_u32 m0, s67, 17408
  s_nop 0
  buffer_load_dwordx4 v255, s[20:23], s59 offen  lds
  v_cvt_pk_bf16_f32 v124, v148, v149
  s_nop 0
  v_cvt_pk_bf16_f32 v125, v150, v151
  v_cvt_pk_bf16_f32 v126, v152, v153
  v_cvt_pk_bf16_f32 v127, v154, v155
  v_pk_add_f32 v[156:157], v[156:157], v[2:3] op_sel_hi:[1,0] neg_lo:[0,1] neg_hi:[0,1]
  v_pk_add_f32 v[158:159], v[158:159], v[2:3] op_sel_hi:[1,0] neg_lo:[0,1] neg_hi:[0,1]
  v_pk_add_f32 v[160:161], v[160:161], v[2:3] op_sel_hi:[1,0] neg_lo:[0,1] neg_hi:[0,1]
  v_pk_add_f32 v[162:163], v[162:163], v[2:3] op_sel_hi:[1,0] neg_lo:[0,1] neg_hi:[0,1]
  v_exp_f32 v156, v156
  v_exp_f32 v157, v157
  v_mfma_f32_16x16x32_bf16 v[238:241], v[76:79], v[124:127], v[238:241]
  v_exp_f32 v158, v158
  v_exp_f32 v159, v159
  v_mfma_f32_16x16x32_bf16 v[242:245], v[80:83], v[124:127], v[242:245]
  v_exp_f32 v160, v160
  v_exp_f32 v161, v161
  v_mfma_f32_16x16x32_bf16 v[246:249], v[24:27], v[124:127], v[246:249]
  v_exp_f32 v162, v162
  v_exp_f32 v163, v163
  v_cvt_pk_bf16_f32 v128, v156, v157
  v_cvt_pk_bf16_f32 v129, v158, v159
  v_cvt_pk_bf16_f32 v130, v160, v161
  v_cvt_pk_bf16_f32 v131, v162, v163
  v_pk_add_f32 v[164:165], v[164:165], v[2:3] op_sel_hi:[1,0] neg_lo:[0,1] neg_hi:[0,1]
  v_pk_add_f32 v[166:167], v[166:167], v[2:3] op_sel_hi:[1,0] neg_lo:[0,1] neg_hi:[0,1]
  v_exp_f32 v164, v164
  v_exp_f32 v165, v165
  v_mfma_f32_16x16x32_bf16 v[238:241], v[84:87], v[128:131], v[238:241]
  v_exp_f32 v166, v166
  v_exp_f32 v167, v167
  v_mfma_f32_16x16x32_bf16 v[242:245], v[88:91], v[128:131], v[242:245]
  v_mfma_f32_16x16x32_bf16 v[246:249], v[24:27], v[128:131], v[246:249]
  s_nop 0
  v_cvt_pk_bf16_f32 v132, v164, v165
  v_cvt_pk_bf16_f32 v133, v166, v167
  v_mov_b32 v134, 0
  v_mov_b32 v135, 0
  v_pk_add_f32 v[170:171], v[170:171], v[6:7] op_sel_hi:[1,0] neg_lo:[0,1] neg_hi:[0,1]
  v_pk_add_f32 v[172:173], v[172:173], v[6:7] op_sel_hi:[1,0] neg_lo:[0,1] neg_hi:[0,1]
  v_exp_f32 v170, v170
  v_exp_f32_e64 v171, v171
  v_mfma_f32_16x16x32_bf16 v[238:241], v[92:95], v[132:135], v[238:241]
  v_exp_f32 v172, v172
  v_exp_f32 v173, v173
  v_mfma_f32_16x16x32_bf16 v[242:245], v[96:99], v[132:135], v[242:245]
  v_mfma_f32_16x16x32_bf16 v[246:249], v[24:27], v[132:135], v[246:249]
  s_setprio 0
  s_add_u32 s100, s100, 2
  s_cmp_ge_u32 s100, 30
  s_cselect_b32 s3, 131072, 0
  s_cselect_b32 s4, 30, 0
  s_sub_u32 s100, s100, s4
  s_add_u32 s59, s59, s3
  s_add_u32 s59, s59, 131072
  s_cmp_ge_u32 s59, s66
  s_cselect_b32 s3, 2097152, 0
  s_sub_u32 s59, s59, s3
  s_add_u32 m0, s67, 24576
  s_nop 0
  buffer_load_dwordx4 v254, s[20:23], s59 offen  lds
  s_add_u32 m0, s67, 25600
  s_nop 0
  buffer_load_dwordx4 v255, s[20:23], s59 offen  lds
  s_nop 0
  v_cvt_pk_bf16_f32 v170, v170, v171
  v_cvt_pk_bf16_f32 v171, v172, v173
  v_pk_add_f32 v[174:175], v[174:175], v[6:7] op_sel_hi:[1,0] neg_lo:[0,1] neg_hi:[0,1]
  v_pk_add_f32 v[176:177], v[176:177], v[6:7] op_sel_hi:[1,0] neg_lo:[0,1] neg_hi:[0,1]
  v_pk_add_f32 v[178:179], v[178:179], v[6:7] op_sel_hi:[1,0] neg_lo:[0,1] neg_hi:[0,1]
  v_pk_add_f32 v[180:181], v[180:181], v[6:7] op_sel_hi:[1,0] neg_lo:[0,1] neg_hi:[0,1]
  v_exp_f32 v174, v174
  v_exp_f32_e64 v175, v175
  v_mfma_f32_16x16x32_bf16 v[8:11], v[28:31], v[168:171], 0
  v_exp_f32 v176, v176
  v_exp_f32 v177, v177
  v_mfma_f32_16x16x32_bf16 v[12:15], v[32:35], v[168:171], 0
  v_exp_f32 v178, v178
  v_exp_f32 v179, v179
  v_mfma_f32_16x16x32_bf16 v[250:253], v[24:27], v[168:171], 0
  v_exp_f32 v180, v180
  v_exp_f32 v181, v181
  v_cvt_pk_bf16_f32 v172, v174, v175
  v_cvt_pk_bf16_f32 v173, v176, v177
  v_cvt_pk_bf16_f32 v174, v178, v179
  v_cvt_pk_bf16_f32 v175, v180, v181
  v_pk_add_f32 v[182:183], v[182:183], v[6:7] op_sel_hi:[1,0] neg_lo:[0,1] neg_hi:[0,1]
  v_pk_add_f32 v[184:185], v[184:185], v[6:7] op_sel_hi:[1,0] neg_lo:[0,1] neg_hi:[0,1]
  v_pk_add_f32 v[186:187], v[186:187], v[6:7] op_sel_hi:[1,0] neg_lo:[0,1] neg_hi:[0,1]
  v_pk_add_f32 v[188:189], v[188:189], v[6:7] op_sel_hi:[1,0] neg_lo:[0,1] neg_hi:[0,1]
  v_exp_f32 v182, v182
  v_exp_f32 v183, v183
  v_mfma_f32_16x16x32_bf16 v[8:11], v[36:39], v[172:175], v[8:11]
  v_exp_f32 v184, v184
  v_exp_f32 v185, v185
  v_mfma_f32_16x16x32_bf16 v[12:15], v[40:43], v[172:175], v[12:15]
  v_exp_f32 v186, v186
  v_exp_f32 v187, v187
  v_mfma_f32_16x16x32_bf16 v[250:253], v[24:27], v[172:175], v[250:253]
  v_exp_f32 v188, v188
  v_exp_f32 v189, v189
  s_setprio 1
  s_add_u32 s100, s100, 2
  s_cmp_ge_u32 s100, 30
  s_cselect_b32 s3, 131072, 0
  s_cselect_b32 s4, 30, 0
  s_sub_u32 s100, s100, s4
  s_add_u32 s59, s59, s3
  s_add_u32 s59, s59, 131072
  s_cmp_ge_u32 s59, s66
  s_cselect_b32 s3, 2097152, 0
  s_sub_u32 s59, s59, s3
  s_add_u32 m0, s67, 32768
  s_nop 0
  buffer_load_dwordx4 v254, s[20:23], s59 offen  lds
  s_add_u32 m0, s67, 33792
  s_nop 0
  buffer_load_dwordx4 v255, s[20:23], s59 offen  lds
  v_cvt_pk_bf16_f32 v176, v182, v183
  v_cvt_pk_bf16_f32 v177, v184, v185
  v_cvt_pk_bf16_f32 v178, v186, v187
  v_cvt_pk_bf16_f32 v179, v188, v189
  v_rcp_f32 v2, v246
  s_nop 0
  v_pk_mul_f32 v[238:239], v[238:239], v[2:3] op_sel_hi:[1,0]
  v_pk_mul_f32 v[240:241], v[240:241], v[2:3] op_sel_hi:[1,0]
  v_pk_mul_f32 v[242:243], v[242:243], v[2:3] op_sel_hi:[1,0]
  v_pk_mul_f32 v[244:245], v[244:245], v[2:3] op_sel_hi:[1,0]
  v_cvt_pk_bf16_f32 v136, v238, v239
  v_cvt_pk_bf16_f32 v137, v240, v241
  v_cvt_pk_bf16_f32 v138, v242, v243
  v_cvt_pk_bf16_f32 v139, v244, v245
  buffer_store_dwordx4 v[136:139], v1, s[8:11], s6 offen offset:0 sc1
  s_lshl_b32 s3, s54, 2
  s_add_u32 s3, s3, s55
  s_lshl_b32 s3, s3, 11
  s_add_u32 s3, s3, 147456
  v_add_u32 v3, s3, v1
  ds_write_b128 v3, v[136:139] offset:0
  v_pk_add_f32 v[190:191], v[190:191], v[6:7] op_sel_hi:[1,0] neg_lo:[0,1] neg_hi:[0,1]
  v_pk_add_f32 v[192:193], v[192:193], v[6:7] op_sel_hi:[1,0] neg_lo:[0,1] neg_hi:[0,1]
  v_pk_add_f32 v[194:195], v[194:195], v[6:7] op_sel_hi:[1,0] neg_lo:[0,1] neg_hi:[0,1]
  v_pk_add_f32 v[196:197], v[196:197], v[6:7] op_sel_hi:[1,0] neg_lo:[0,1] neg_hi:[0,1]
  v_exp_f32 v190, v190
  v_exp_f32 v191, v191
  v_mfma_f32_16x16x32_bf16 v[8:11], v[44:47], v[176:179], v[8:11]
  v_exp_f32 v192, v192
  v_exp_f32 v193, v193
  v_mfma_f32_16x16x32_bf16 v[12:15], v[48:51], v[176:179], v[12:15]
  v_exp_f32 v194, v194
  v_exp_f32 v195, v195
  v_mfma_f32_16x16x32_bf16 v[250:253], v[24:27], v[176:179], v[250:253]
  v_exp_f32 v196, v196
  v_exp_f32 v197, v197
  v_cvt_pk_bf16_f32 v180, v190, v191
  v_cvt_pk_bf16_f32 v181, v192, v193
  v_cvt_pk_bf16_f32 v182, v194, v195
  v_cvt_pk_bf16_f32 v183, v196, v197
  v_pk_add_f32 v[198:199], v[198:199], v[6:7] op_sel_hi:[1,0] neg_lo:[0,1] neg_hi:[0,1]
  v_pk_add_f32 v[200:201], v[200:201], v[6:7] op_sel_hi:[1,0] neg_lo:[0,1] neg_hi:[0,1]
  v_pk_add_f32 v[202:203], v[202:203], v[6:7] op_sel_hi:[1,0] neg_lo:[0,1] neg_hi:[0,1]
  v_pk_add_f32 v[204:205], v[204:205], v[6:7] op_sel_hi:[1,0] neg_lo:[0,1] neg_hi:[0,1]
  v_exp_f32 v198, v198
  v_exp_f32 v199, v199
  v_mfma_f32_16x16x32_bf16 v[8:11], v[52:55], v[180:183], v[8:11]
  v_exp_f32 v200, v200
  v_exp_f32 v201, v201
  v_mfma_f32_16x16x32_bf16 v[12:15], v[56:59], v[180:183], v[12:15]
  v_exp_f32 v202, v202
  v_exp_f32 v203, v203
  v_mfma_f32_16x16x32_bf16 v[250:253], v[24:27], v[180:183], v[250:253]
  v_exp_f32 v204, v204
  v_exp_f32 v205, v205
  v_cvt_pk_bf16_f32 v184, v198, v199
  v_cvt_pk_bf16_f32 v185, v200, v201
  v_cvt_pk_bf16_f32 v186, v202, v203
  v_cvt_pk_bf16_f32 v187, v204, v205
  v_pk_add_f32 v[206:207], v[206:207], v[6:7] op_sel_hi:[1,0] neg_lo:[0,1] neg_hi:[0,1]
  v_pk_add_f32 v[208:209], v[208:209], v[6:7] op_sel_hi:[1,0] neg_lo:[0,1] neg_hi:[0,1]
  v_pk_add_f32 v[210:211], v[210:211], v[6:7] op_sel_hi:[1,0] neg_lo:[0,1] neg_hi:[0,1]
  v_pk_add_f32 v[212:213], v[212:213], v[6:7] op_sel_hi:[1,0] neg_lo:[0,1] neg_hi:[0,1]
  v_exp_f32 v206, v206
  v_exp_f32 v207, v207
  v_mfma_f32_16x16x32_bf16 v[8:11], v[60:63], v[184:187], v[8:11]
  v_exp_f32 v208, v208
  v_exp_f32 v209, v209
  v_mfma_f32_16x16x32_bf16 v[12:15], v[64:67], v[184:187], v[12:15]
  v_exp_f32 v210, v210
  v_exp_f32 v211, v211
  v_mfma_f32_16x16x32_bf16 v[250:253], v[24:27], v[184:187], v[250:253]
  v_exp_f32 v212, v212
  v_exp_f32 v213, v213
  s_setprio 0
  s_add_u32 s100, s100, 2
  s_cmp_ge_u32 s100, 30
  s_cselect_b32 s3, 131072, 0
  s_cselect_b32 s4, 30, 0
  s_sub_u32 s100, s100, s4
  s_add_u32 s59, s59, s3
  s_add_u32 s59, s59, 131072
  s_cmp_ge_u32 s59, s66
  s_cselect_b32 s3, 2097152, 0
  s_sub_u32 s59, s59, s3
  s_add_u32 m0, s67, 40960
  s_nop 0
  buffer_load_dwordx4 v254, s[20:23], s59 offen  lds
  s_add_u32 m0, s67, 41984
  s_nop 0
  buffer_load_dwordx4 v255, s[20:23], s59 offen  lds
  v_cvt_pk_bf16_f32 v188, v206, v207
  v_cvt_pk_bf16_f32 v189, v208, v209
  v_cvt_pk_bf16_f32 v190, v210, v211
  v_cvt_pk_bf16_f32 v191, v212, v213
  v_pk_add_f32 v[214:215], v[214:215], v[6:7] op_sel_hi:[1,0] neg_lo:[0,1] neg_hi:[0,1]
  v_pk_add_f32 v[216:217], v[216:217], v[6:7] op_sel_hi:[1,0] neg_lo:[0,1] neg_hi:[0,1]
  v_pk_add_f32 v[218:219], v[218:219], v[6:7] op_sel_hi:[1,0] neg_lo:[0,1] neg_hi:[0,1]
  v_pk_add_f32 v[220:221], v[220:221], v[6:7] op_sel_hi:[1,0] neg_lo:[0,1] neg_hi:[0,1]
  v_exp_f32 v214, v214
  v_exp_f32 v215, v215
  v_mfma_f32_16x16x32_bf16 v[8:11], v[68:71], v[188:191], v[8:11]
  v_exp_f32 v216, v216
  v_exp_f32 v217, v217
  v_mfma_f32_16x16x32_bf16 v[12:15], v[72:75], v[188:191], v[12:15]
  v_exp_f32 v218, v218
  v_exp_f32 v219, v219
  v_mfma_f32_16x16x32_bf16 v[250:253], v[24:27], v[188:191], v[250:253]
  v_exp_f32 v220, v220
  v_exp_f32 v221, v221
  v_cvt_pk_bf16_f32 v192, v214, v215
  v_cvt_pk_bf16_f32 v193, v216, v217
  v_cvt_pk_bf16_f32 v194, v218, v219
  v_cvt_pk_bf16_f32 v195, v220, v221
  v_pk_add_f32 v[222:223], v[222:223], v[6:7] op_sel_hi:[1,0] neg_lo:[0,1] neg_hi:[0,1]
  v_pk_add_f32 v[224:225], v[224:225], v[6:7] op_sel_hi:[1,0] neg_lo:[0,1] neg_hi:[0,1]
  v_pk_add_f32 v[226:227], v[226:227], v[6:7] op_sel_hi:[1,0] neg_lo:[0,1] neg_hi:[0,1]
  v_pk_add_f32 v[228:229], v[228:229], v[6:7] op_sel_hi:[1,0] neg_lo:[0,1] neg_hi:[0,1]
  v_exp_f32 v222, v222
  v_exp_f32 v223, v223
  v_mfma_f32_16x16x32_bf16 v[8:11], v[76:79], v[192:195], v[8:11]
  v_exp_f32 v224, v224
  v_exp_f32 v225, v225
  v_mfma_f32_16x16x32_bf16 v[12:15], v[80:83], v[192:195], v[12:15]
  v_exp_f32 v226, v226
  v_exp_f32 v227, v227
  v_mfma_f32_16x16x32_bf16 v[250:253], v[24:27], v[192:195], v[250:253]
  v_exp_f32 v228, v228
  v_exp_f32 v229, v229
  v_cvt_pk_bf16_f32 v196, v222, v223
  v_cvt_pk_bf16_f32 v197, v224, v225
  v_cvt_pk_bf16_f32 v198, v226, v227
  v_cvt_pk_bf16_f32 v199, v228, v229
  v_pk_add_f32 v[230:231], v[230:231], v[6:7] op_sel_hi:[1,0] neg_lo:[0,1] neg_hi:[0,1]
  v_pk_add_f32 v[232:233], v[232:233], v[6:7] op_sel_hi:[1,0] neg_lo:[0,1] neg_hi:[0,1]
  v_pk_add_f32 v[234:235], v[234:235], v[6:7] op_sel_hi:[1,0] neg_lo:[0,1] neg_hi:[0,1]
  v_pk_add_f32 v[236:237], v[236:237], v[6:7] op_sel_hi:[1,0] neg_lo:[0,1] neg_hi:[0,1]
  v_exp_f32 v230, v230
  v_exp_f32 v231, v231
  v_mfma_f32_16x16x32_bf16 v[8:11], v[84:87], v[196:199], v[8:11]
  v_exp_f32 v232, v232
  v_exp_f32 v233, v233
  v_mfma_f32_16x16x32_bf16 v[12:15], v[88:91], v[196:199], v[12:15]
  v_exp_f32 v234, v234
  v_exp_f32 v235, v235
  v_mfma_f32_16x16x32_bf16 v[250:253], v[24:27], v[196:199], v[250:253]
  v_exp_f32 v236, v236
  v_exp_f32 v237, v237
  v_cvt_pk_bf16_f32 v200, v230, v231
  v_cvt_pk_bf16_f32 v201, v232, v233
  v_cvt_pk_bf16_f32 v202, v234, v235
  v_cvt_pk_bf16_f32 v203, v236, v237
  s_nop 1
  v_mfma_f32_16x16x32_bf16 v[8:11], v[92:95], v[200:203], v[8:11]
  v_mfma_f32_16x16x32_bf16 v[12:15], v[96:99], v[200:203], v[12:15]
  v_mfma_f32_16x16x32_bf16 v[250:253], v[24:27], v[200:203], v[250:253]
  s_nop 7
  v_rcp_f32 v2, v250
  s_nop 0
  v_pk_mul_f32 v[8:9], v[8:9], v[2:3] op_sel_hi:[1,0]
  v_pk_mul_f32 v[10:11], v[10:11], v[2:3] op_sel_hi:[1,0]
  v_pk_mul_f32 v[12:13], v[12:13], v[2:3] op_sel_hi:[1,0]
  v_pk_mul_f32 v[14:15], v[14:15], v[2:3] op_sel_hi:[1,0]
  v_cvt_pk_bf16_f32 v160, v8, v9
  v_cvt_pk_bf16_f32 v161, v10, v11
  v_cvt_pk_bf16_f32 v162, v12, v13
  v_cvt_pk_bf16_f32 v163, v14, v15
  buffer_store_dwordx4 v[160:163], v1, s[8:11], s6 offen offset:1024 sc1
  s_lshl_b32 s3, s54, 2
  s_add_u32 s3, s3, s55
  s_lshl_b32 s3, s3, 11
  s_add_u32 s3, s3, 147456
  v_add_u32 v3, s3, v1
  ds_write_b128 v3, v[160:163] offset:1024
  s_setprio 0
  s_waitcnt vmcnt(0) lgkmcnt(0)
  s_barrier
  s_add_u32 s100, s100, 2
  s_cmp_ge_u32 s100, 30
  s_cselect_b32 s3, 131072, 0
  s_cselect_b32 s4, 30, 0
  s_sub_u32 s100, s100, s4
  s_add_u32 s59, s59, s3
  s_add_u32 s59, s59, 131072
  s_cmp_ge_u32 s59, s66
  s_cselect_b32 s3, 2097152, 0
  s_sub_u32 s59, s59, s3
  s_add_u32 m0, s67, 49152
  s_nop 0
  buffer_load_dwordx4 v254, s[20:23], s59 offen  lds
  s_add_u32 m0, s67, 50176
  s_nop 0
  buffer_load_dwordx4 v255, s[20:23], s59 offen  lds
  s_add_u32 s100, s100, 2
  s_cmp_ge_u32 s100, 30
  s_cselect_b32 s3, 131072, 0
  s_cselect_b32 s4, 30, 0
  s_sub_u32 s100, s100, s4
  s_add_u32 s59, s59, s3
  s_add_u32 s59, s59, 131072
  s_cmp_ge_u32 s59, s66
  s_cselect_b32 s3, 2097152, 0
  s_sub_u32 s59, s59, s3
  s_add_u32 m0, s67, 57344
  s_nop 0
  buffer_load_dwordx4 v254, s[20:23], s59 offen  lds
  s_add_u32 m0, s67, 58368
  s_nop 0
  buffer_load_dwordx4 v255, s[20:23], s59 offen  lds
  s_add_u32 s100, s100, 2
  s_cmp_ge_u32 s100, 30
  s_cselect_b32 s3, 131072, 0
  s_cselect_b32 s4, 30, 0
  s_sub_u32 s100, s100, s4
  s_add_u32 s59, s59, s3
  s_add_u32 s59, s59, 131072
  s_cmp_ge_u32 s59, s66
  s_cselect_b32 s3, 2097152, 0
  s_sub_u32 s59, s59, s3
  s_add_u32 m0, s67, 65536
  s_nop 0
  buffer_load_dwordx4 v254, s[20:23], s59 offen  lds
  s_add_u32 m0, s67, 66560
  s_nop 0
  buffer_load_dwordx4 v255, s[20:23], s59 offen  lds
  s_add_u32 s100, s100, 2
  s_cmp_ge_u32 s100, 30
  s_cselect_b32 s3, 131072, 0
  s_cselect_b32 s4, 30, 0
  s_sub_u32 s100, s100, s4
  s_add_u32 s59, s59, s3
  s_add_u32 s59, s59, 131072
  s_cmp_ge_u32 s59, s66
  s_cselect_b32 s3, 2097152, 0
  s_sub_u32 s59, s59, s3
  s_add_u32 m0, s67, 73728
  s_nop 0
  buffer_load_dwordx4 v254, s[20:23], s59 offen  lds
  s_add_u32 m0, s67, 74752
  s_nop 0
  buffer_load_dwordx4 v255, s[20:23], s59 offen  lds
  s_add_u32 s100, s100, 2
  s_cmp_ge_u32 s100, 30
  s_cselect_b32 s3, 131072, 0
  s_cselect_b32 s4, 30, 0
  s_sub_u32 s100, s100, s4
  s_add_u32 s59, s59, s3
  s_add_u32 s59, s59, 131072
  s_cmp_ge_u32 s59, s66
  s_nop 0
  s_cselect_b32 s3, 2097152, 0
  s_sub_u32 s59, s59, s3
  s_add_u32 m0, s67, 81920
  s_nop 0
  buffer_load_dwordx4 v254, s[20:23], s59 offen  lds
  s_add_u32 m0, s67, 82944
  s_nop 0
  buffer_load_dwordx4 v255, s[20:23], s59 offen  lds
  s_add_u32 s100, s100, 2
  s_cmp_ge_u32 s100, 30
  s_nop 0
  s_cselect_b32 s3, 131072, 0
  s_cselect_b32 s4, 30, 0
  s_sub_u32 s100, s100, s4
  s_add_u32 s59, s59, s3
  s_add_u32 s59, s59, 131072
  s_cmp_ge_u32 s59, s66
  s_cselect_b32 s3, 2097152, 0
  s_sub_u32 s59, s59, s3
  s_add_u32 m0, s67, 90112
  s_nop 0
  buffer_load_dwordx4 v254, s[20:23], s59 offen  lds
  s_add_u32 m0, s67, 91136
  s_nop 0
  buffer_load_dwordx4 v255, s[20:23], s59 offen  lds
  s_lshl_b32 s62, s49, 1
  s_lshl_b32 s60, s51, 12
  s_mul_i32 s56, s48, 262144
  s_lshl_b32 s4, s53, 12
  s_add_u32 s56, s56, s4
  s_add_u32 s56, s56, 16777216
  s_add_u32 s55, s56, 262144
  s_add_u32 s62, s62, s52
  s_add_u32 s62, s62, 2
  s_lshl_b32 s54, s62, 13
  s_add_u32 s54, s54, s56
  s_and_b32 s56, s49, 3
  s_mul_i32 s56, s56, 2
  s_sub_u32 s56, 6, s56
  s_and_b32 s3, s48, 7
  s_mul_i32 s3, s3, 4
  s_add_u32 s56, s56, s3
  s_add_u32 s56, s56, s52
  s_cmp_ge_u32 s56, 30
  s_cselect_b32 s3, 30, 0
  s_sub_u32 s56, s56, s3
  s_sub_u32 s3, s56, s52
  s_lshl_b32 s3, s3, 13
  s_add_u32 s54, s54, s3
  s_cmp_ge_u32 s54, s55
  s_cselect_b32 s3, 262144, 0
  s_sub_u32 s54, s54, s3
  s_lshl_b32 s3, s48, 4
  s_add_u32 s3, s3, s49
  s_lshl_b32 s3, s3, 10
  s_add_u32 s3, s3, 67108992
  s_nop 0
  s_mov_b32 s63, 0
  s_mov_b64 exec, 1
Lcw_1017:
  v_mov_b32 v11, 0
  buffer_atomic_add v11, off, s[8:11], s3 sc0 sc1
  s_add_u32 s63, s63, 1
  s_cmp_gt_u32 s63, 200000
  s_cbranch_scc1 Lcd_1018
  s_waitcnt vmcnt(0)
  v_cmp_gt_u32 vcc, 16, v11
  s_cbranch_vccnz Lcw_1017
Lcd_1018:
  s_mov_b64 exec, -1
  s_add_u32 m0, s60, 98304
  s_nop 0
  buffer_load_dwordx4 v1, s[8:11], s54 offen offset:0 sc1 lds
  s_add_u32 s100, s100, 2
  s_cmp_ge_u32 s100, 30
  s_cselect_b32 s3, 131072, 0
  s_cselect_b32 s4, 30, 0
  s_sub_u32 s100, s100, s4
  s_add_u32 s59, s59, s3
  s_add_u32 s59, s59, 131072
  s_cmp_ge_u32 s59, s66
  s_cselect_b32 s3, 2097152, 0
  s_sub_u32 s59, s59, s3
  buffer_load_dwordx4 v1, s[8:11], s54 offen offset:1024 sc1 lds
  buffer_load_dwordx4 v1, s[8:11], s54 offen offset:2048 sc1 lds
  buffer_load_dwordx4 v1, s[8:11], s54 offen offset:3072 sc1 lds
  s_add_u32 s56, s56, 2
  s_cmp_ge_u32 s56, 30
  s_cselect_b32 s3, 16384, 0
  s_cselect_b32 s4, 30, 0
  s_sub_u32 s56, s56, s4
  s_add_u32 s54, s54, s3
  s_add_u32 s54, s54, 16384
  s_cmp_ge_u32 s54, s55
  s_cselect_b32 s3, 262144, 0
  s_sub_u32 s54, s54, s3
  s_add_u32 m0, s60, 114688
  s_nop 0
  s_nop 0
  buffer_load_dwordx4 v1, s[8:11], s54 offen offset:0 sc1 lds
  buffer_load_dwordx4 v1, s[8:11], s54 offen offset:1024 sc1 lds
  buffer_load_dwordx4 v1, s[8:11], s54 offen offset:2048 sc1 lds
  buffer_load_dwordx4 v1, s[8:11], s54 offen offset:3072 sc1 lds
  s_add_u32 s56, s56, 2
  s_cmp_ge_u32 s56, 30
  s_cselect_b32 s3, 16384, 0
  s_cselect_b32 s4, 30, 0
  s_sub_u32 s56, s56, s4
  s_add_u32 s54, s54, s3
  s_nop 0
  s_add_u32 s54, s54, 16384
  s_cmp_ge_u32 s54, s55
  s_cselect_b32 s3, 262144, 0
  s_sub_u32 s54, s54, s3
  s_add_u32 m0, s60, 131072
  s_nop 0
  buffer_load_dwordx4 v1, s[8:11], s54 offen offset:0 sc1 lds
  buffer_load_dwordx4 v1, s[8:11], s54 offen offset:1024 sc1 lds
  buffer_load_dwordx4 v1, s[8:11], s54 offen offset:2048 sc1 lds
  s_nop 0
  buffer_load_dwordx4 v1, s[8:11], s54 offen offset:3072 sc1 lds
  s_waitcnt vmcnt(8)
  s_barrier
  s_add_u32 s56, s56, 2
  s_cmp_ge_u32 s56, 30
  s_cselect_b32 s3, 16384, 0
  s_cselect_b32 s4, 30, 0
  s_sub_u32 s56, s56, s4
  s_add_u32 s54, s54, s3
  s_add_u32 s54, s54, 16384
  s_cmp_ge_u32 s54, s55
  s_cselect_b32 s3, 262144, 0
  s_sub_u32 s54, s54, s3
  s_add_u32 m0, s60, 147456
  s_nop 0
  buffer_load_dwordx4 v1, s[8:11], s54 offen offset:0 sc1 lds
  buffer_load_dwordx4 v1, s[8:11], s54 offen offset:1024 sc1 lds
  buffer_load_dwordx4 v1, s[8:11], s54 offen offset:2048 sc1 lds
  buffer_load_dwordx4 v1, s[8:11], s54 offen offset:3072 sc1 lds
  s_add_u32 m0, s67, 0
  s_nop 0
  buffer_load_dwordx4 v254, s[20:23], s59 offen  lds
  s_add_u32 s56, s56, 2
  s_cmp_ge_u32 s56, 30
  s_cselect_b32 s3, 16384, 0
  s_cselect_b32 s4, 30, 0
  s_sub_u32 s56, s56, s4
  s_add_u32 s54, s54, s3
  s_add_u32 s54, s54, 16384
  s_cmp_ge_u32 s54, s55
  s_cselect_b32 s3, 262144, 0
  s_sub_u32 s54, s54, s3
  s_add_u32 m0, s67, 1024
  s_nop 0
  buffer_load_dwordx4 v255, s[20:23], s59 offen  lds
  s_waitcnt vmcnt(10)
  s_barrier
  s_add_u32 m0, s60, 98304
  s_nop 0
  buffer_load_dwordx4 v1, s[8:11], s54 offen offset:0 sc1 lds
  s_add_u32 s100, s100, 2
  s_cmp_ge_u32 s100, 30
  s_cselect_b32 s3, 131072, 0
  s_cselect_b32 s4, 30, 0
  s_sub_u32 s100, s100, s4
  s_add_u32 s59, s59, s3
  s_add_u32 s59, s59, 131072
  s_cmp_ge_u32 s59, s66
  s_cselect_b32 s3, 2097152, 0
  s_sub_u32 s59, s59, s3
  buffer_load_dwordx4 v1, s[8:11], s54 offen offset:1024 sc1 lds
  buffer_load_dwordx4 v1, s[8:11], s54 offen offset:2048 sc1 lds
  buffer_load_dwordx4 v1, s[8:11], s54 offen offset:3072 sc1 lds
  s_add_u32 m0, s67, 8192
  s_nop 0
  s_nop 0
  buffer_load_dwordx4 v254, s[20:23], s59 offen  lds
  s_add_u32 s56, s56, 2
  s_cmp_ge_u32 s56, 30
  s_cselect_b32 s3, 16384, 0
  s_cselect_b32 s4, 30, 0
  s_sub_u32 s56, s56, s4
  s_add_u32 s54, s54, s3
  s_add_u32 s54, s54, 16384
  s_cmp_ge_u32 s54, s55
  s_cselect_b32 s3, 262144, 0
  s_sub_u32 s54, s54, s3
  s_nop 0
  s_add_u32 m0, s67, 9216
  s_nop 0
  buffer_load_dwordx4 v255, s[20:23], s59 offen  lds
  s_waitcnt vmcnt(12)
  s_barrier
  s_add_u32 m0, s60, 114688
  s_nop 0
  buffer_load_dwordx4 v1, s[8:11], s54 offen offset:0 sc1 lds
  s_add_u32 s100, s100, 2
  s_cmp_ge_u32 s100, 30
  s_cselect_b32 s3, 131072, 0
  s_cselect_b32 s4, 30, 0
  s_sub_u32 s100, s100, s4
  s_add_u32 s59, s59, s3
  s_add_u32 s59, s59, 131072
  s_cmp_ge_u32 s59, s66
  s_cselect_b32 s3, 2097152, 0
  s_sub_u32 s59, s59, s3
  buffer_load_dwordx4 v1, s[8:11], s54 offen offset:1024 sc1 lds
  buffer_load_dwordx4 v1, s[8:11], s54 offen offset:2048 sc1 lds
  buffer_load_dwordx4 v1, s[8:11], s54 offen offset:3072 sc1 lds
  s_nop 0
  s_add_u32 m0, s67, 16384
  s_nop 0
  buffer_load_dwordx4 v254, s[20:23], s59 offen  lds
  s_add_u32 s56, s56, 2
  s_cmp_ge_u32 s56, 30
  s_cselect_b32 s3, 16384, 0
  s_cselect_b32 s4, 30, 0
  s_sub_u32 s56, s56, s4
  s_add_u32 s54, s54, s3
  s_add_u32 s54, s54, 16384
  s_cmp_ge_u32 s54, s55
  s_nop 0
  s_cselect_b32 s3, 262144, 0
  s_sub_u32 s54, s54, s3
  s_add_u32 m0, s67, 17408
  s_nop 0
  buffer_load_dwordx4 v255, s[20:23], s59 offen  lds
  s_waitcnt vmcnt(14)
  s_barrier
  s_add_u32 m0, s60, 131072
  s_nop 0
  buffer_load_dwordx4 v1, s[8:11], s54 offen offset:0 sc1 lds
  s_add_u32 s100, s100, 2
  s_cmp_ge_u32 s100, 30
  s_cselect_b32 s3, 131072, 0
  s_cselect_b32 s4, 30, 0
  s_sub_u32 s100, s100, s4
  s_add_u32 s59, s59, s3
  s_add_u32 s59, s59, 131072
  s_cmp_ge_u32 s59, s66
  s_cselect_b32 s3, 2097152, 0
  s_sub_u32 s59, s59, s3
  buffer_load_dwordx4 v1, s[8:11], s54 offen offset:1024 sc1 lds
  buffer_load_dwordx4 v1, s[8:11], s54 offen offset:2048 sc1 lds
  buffer_load_dwordx4 v1, s[8:11], s54 offen offset:3072 sc1 lds
  s_add_u32 m0, s67, 24576
  s_nop 0
  buffer_load_dwordx4 v254, s[20:23], s59 offen  lds
  s_add_u32 s56, s56, 2
  s_cmp_ge_u32 s56, 30
  s_cselect_b32 s3, 16384, 0
  s_cselect_b32 s4, 30, 0
  s_sub_u32 s56, s56, s4
  s_add_u32 s54, s54, s3
  s_add_u32 s54, s54, 16384
  s_cmp_ge_u32 s54, s55
  s_cselect_b32 s3, 262144, 0
  s_sub_u32 s54, s54, s3
  s_add_u32 m0, s67, 25600
  s_nop 0
  buffer_load_dwordx4 v255, s[20:23], s59 offen  lds
  s_waitcnt vmcnt(14)
  s_barrier
  s_add_u32 m0, s60, 147456
  s_nop 0
  buffer_load_dwordx4 v1, s[8:11], s54 offen offset:0 sc1 lds
  buffer_load_dwordx4 v1, s[8:11], s54 offen offset:1024 sc1 lds
  buffer_load_dwordx4 v1, s[8:11], s54 offen offset:2048 sc1 lds
  buffer_load_dwordx4 v1, s[8:11], s54 offen offset:3072 sc1 lds
  s_waitcnt vmcnt(12)
  s_barrier
  s_add_u32 s56, s56, 2
  s_cmp_ge_u32 s56, 30
  s_cselect_b32 s3, 16384, 0
  s_cselect_b32 s4, 30, 0
  s_sub_u32 s56, s56, s4
  s_add_u32 s54, s54, s3
  s_nop 0
  s_add_u32 s54, s54, 16384
  s_cmp_ge_u32 s54, s55
  s_cselect_b32 s3, 262144, 0
  s_sub_u32 s54, s54, s3
  s_add_u32 m0, s60, 98304
  s_nop 0
  buffer_load_dwordx4 v1, s[8:11], s54 offen offset:0 sc1 lds
  buffer_load_dwordx4 v1, s[8:11], s54 offen offset:1024 sc1 lds
  buffer_load_dwordx4 v1, s[8:11], s54 offen offset:2048 sc1 lds
  s_nop 0
  buffer_load_dwordx4 v1, s[8:11], s54 offen offset:3072 sc1 lds
  s_waitcnt vmcnt(10)
  s_barrier
  s_add_u32 s56, s56, 2
  s_cmp_ge_u32 s56, 30
  s_cselect_b32 s3, 16384, 0
  s_cselect_b32 s4, 30, 0
  s_sub_u32 s56, s56, s4
  s_add_u32 s54, s54, s3
  s_add_u32 s54, s54, 16384
  s_cmp_ge_u32 s54, s55
  s_cselect_b32 s3, 262144, 0
  s_sub_u32 s54, s54, s3
  s_add_u32 m0, s60, 114688
  s_nop 0
  buffer_load_dwordx4 v1, s[8:11], s54 offen offset:0 sc1 lds
  buffer_load_dwordx4 v1, s[8:11], s54 offen offset:1024 sc1 lds
  buffer_load_dwordx4 v1, s[8:11], s54 offen offset:2048 sc1 lds
  buffer_load_dwordx4 v1, s[8:11], s54 offen offset:3072 sc1 lds
  s_waitcnt vmcnt(8)
  s_barrier
  s_add_u32 s56, s56, 2
  s_cmp_ge_u32 s56, 30
  s_cselect_b32 s3, 16384, 0
  s_cselect_b32 s4, 30, 0
  s_sub_u32 s56, s56, s4
  s_add_u32 s54, s54, s3
  s_add_u32 s54, s54, 16384
  s_cmp_ge_u32 s54, s55
  s_cselect_b32 s3, 262144, 0
  s_sub_u32 s54, s54, s3
  s_add_u32 m0, s60, 131072
  s_nop 0
  buffer_load_dwordx4 v1, s[8:11], s54 offen offset:0 sc1 lds
  buffer_load_dwordx4 v1, s[8:11], s54 offen offset:1024 sc1 lds
  buffer_load_dwordx4 v1, s[8:11], s54 offen offset:2048 sc1 lds
  buffer_load_dwordx4 v1, s[8:11], s54 offen offset:3072 sc1 lds
  s_lshl_b32 s62, s49, 1
  s_add_u32 s62, s62, s52
  s_lshl_b32 s4, s53, 4
  s_mul_i32 s4, s4, 7168
  s_add_u32 s58, s4, 7340032
  s_mul_i32 s57, s62, 229376
  s_add_u32 s57, s57, s4
  s_mul_i32 s61, s51, 7168
  s_and_b32 s7, s49, 3
  s_mul_i32 s7, s7, 2
  s_sub_u32 s7, 6, s7
  s_and_b32 s3, s48, 7
  s_mul_i32 s3, s3, 1
  s_add_u32 s7, s7, s3
  s_add_u32 s7, s7, s52
  s_cmp_ge_u32 s7, 30
  s_cselect_b32 s3, 30, 0
  s_sub_u32 s7, s7, s3
  s_mul_i32 s4, s49, 448
  s_and_b32 s5, s49, 1
  s_cmp_eq_u32 s5, 1
  s_cselect_b32 s5, 0, 384
  s_cselect_b32 s6, 64, 0
  s_add_u32 s5, s5, s4
  s_add_u32 s4, s4, s6
  v_lshrrev_b32 v3, 3, v0
  v_and_b32 v4, 7, v0
  v_and_b32 v5, 6, v3
  v_xor_b32 v4, v4, v5
  v_lshlrev_b32 v4, 4, v4
  v_mul_u32_u24 v5, 7168, v3
  v_add3_u32 v5, v5, v4, s4
  v_add_u32_e64 v240, 0, v5
  v_add_u32 v241, 57344, v5
  v_add_u32 v242, 128, v5
  v_add_u32 v243, 57472, v5
  v_add_u32 v244, 256, v5
  v_add_u32 v245, 57600, v5
  v_lshrrev_b32 v3, 2, v0
  v_and_b32 v4, 3, v0
  v_lshrrev_b32 v6, 1, v3
  v_and_b32 v6, 2, v6
  v_xor_b32 v4, v4, v6
  v_lshlrev_b32 v4, 4, v4
  v_mul_u32_u24 v3, 7168, v3
  v_add3_u32 v246, v3, v4, s5
  s_waitcnt vmcnt(8)
  s_barrier
  s_add_u32 s56, s56, 2
  s_cmp_ge_u32 s56, 30
  s_cselect_b32 s3, 16384, 0
  s_cselect_b32 s4, 30, 0
  s_sub_u32 s56, s56, s4
  s_add_u32 s54, s54, s3
  s_add_u32 s54, s54, 16384
  s_cmp_ge_u32 s54, s55
  s_cselect_b32 s3, 262144, 0
  s_sub_u32 s54, s54, s3
  s_add_u32 m0, s60, 147456
  s_nop 0
  buffer_load_dwordx4 v1, s[8:11], s54 offen offset:0 sc1 lds
  buffer_load_dwordx4 v1, s[8:11], s54 offen offset:1024 sc1 lds
  buffer_load_dwordx4 v1, s[8:11], s54 offen offset:2048 sc1 lds
  buffer_load_dwordx4 v1, s[8:11], s54 offen offset:3072 sc1 lds
  s_waitcnt vmcnt(8)
  s_barrier
  s_add_u32 s56, s56, 2
  s_cmp_ge_u32 s56, 30
  s_cselect_b32 s3, 16384, 0
  s_cselect_b32 s4, 30, 0
  s_sub_u32 s56, s56, s4
  s_add_u32 s54, s54, s3
  s_add_u32 s54, s54, 16384
  s_cmp_ge_u32 s54, s55
  s_cselect_b32 s3, 262144, 0
  s_sub_u32 s54, s54, s3
  s_add_u32 m0, s60, 98304
  s_nop 0
  buffer_load_dwordx4 v1, s[8:11], s54 offen offset:0 sc1 lds
  buffer_load_dwordx4 v1, s[8:11], s54 offen offset:1024 sc1 lds
  buffer_load_dwordx4 v1, s[8:11], s54 offen offset:2048 sc1 lds
  buffer_load_dwordx4 v1, s[8:11], s54 offen offset:3072 sc1 lds
  s_waitcnt vmcnt(8)
  s_barrier
  s_add_u32 s56, s56, 2
  s_cmp_ge_u32 s56, 30
  s_cselect_b32 s3, 16384, 0
  s_cselect_b32 s4, 30, 0
  s_sub_u32 s56, s56, s4
  s_add_u32 s54, s54, s3
  s_add_u32 s54, s54, 16384
  s_cmp_ge_u32 s54, s55
  s_cselect_b32 s3, 262144, 0
  s_sub_u32 s54, s54, s3
  s_add_u32 m0, s60, 114688
  s_nop 0
  buffer_load_dwordx4 v1, s[8:11], s54 offen offset:0 sc1 lds
  buffer_load_dwordx4 v1, s[8:11], s54 offen offset:1024 sc1 lds
  buffer_load_dwordx4 v1, s[8:11], s54 offen offset:2048 sc1 lds
  buffer_load_dwordx4 v1, s[8:11], s54 offen offset:3072 sc1 lds
  s_getpc_b64 s[4:5]
Lpc_1019:
  s_sub_u32 s4, s4, Lpc_1019-sequential_preLN__sliding_block__dense_activation_gelu__prompt_kernel
  s_subb_u32 s5, s5, 0
  s_lshr_b32 s3, s2, 3
  s_lshl_b32 s3, s3, 2
  s_add_u32 s3, s3, s51
  s_mul_i32 s3, s3, 6
  v_add_u32 v12, s3, v0
  v_lshlrev_b32_e64 v12, 7, v12
  v_min_u32 v12, Lend-sequential_preLN__sliding_block__dense_activation_gelu__prompt_kernel-4, v12
  s_mov_b64 exec, 0x3f
  global_load_dword v13, v12, s[4:5]
  s_mov_b64 exec, -1
  s_waitcnt vmcnt(9)
  s_barrier
  s_add_u32 s56, s56, 2
  s_cmp_ge_u32 s56, 30
  s_cselect_b32 s3, 16384, 0
  s_cselect_b32 s4, 30, 0
  s_sub_u32 s56, s56, s4
  s_add_u32 s54, s54, s3
  s_add_u32 s54, s54, 16384
  s_cmp_ge_u32 s54, s55
  s_nop 0
  s_cselect_b32 s3, 262144, 0
  s_sub_u32 s54, s54, s3
  s_add_u32 m0, s60, 131072
  s_nop 0
  buffer_load_dwordx4 v1, s[8:11], s54 offen offset:0 sc1 lds
  buffer_load_dwordx4 v1, s[8:11], s54 offen offset:1024 sc1 lds
  buffer_load_dwordx4 v1, s[8:11], s54 offen offset:2048 sc1 lds
  buffer_load_dwordx4 v1, s[8:11], s54 offen offset:3072 sc1 lds
  s_waitcnt vmcnt(9)
  s_barrier
  s_add_u32 m0, s61, 49152
  s_nop 0
  buffer_load_dwordx4 v240, s[24:27], s57 offen  lds
  s_add_u32 m0, s61, 50176
  s_nop 0
  buffer_load_dwordx4 v241, s[24:27], s57 offen  lds
  s_add_u32 m0, s61, 51200
  s_nop 0
  buffer_load_dwordx4 v242, s[24:27], s57 offen  lds
  s_nop 0
  s_add_u32 m0, s61, 52224
  s_nop 0
  buffer_load_dwordx4 v243, s[24:27], s57 offen  lds
  s_add_u32 m0, s61, 53248
  s_nop 0
  buffer_load_dwordx4 v244, s[24:27], s57 offen  lds
  s_add_u32 m0, s61, 54272
  s_nop 0
  buffer_load_dwordx4 v245, s[24:27], s57 offen  lds
  s_nop 0
  s_add_u32 m0, s61, 55296
  s_nop 0
  buffer_load_dwordx4 v246, s[24:27], s57 offen  lds
  s_waitcnt vmcnt(12)
  s_barrier
  s_waitcnt vmcnt(7)
  s_barrier
  s_barrier
  s_lshl_b32 s62, s49, 1
  s_lshl_b32 s60, s51, 12
  s_mul_i32 s56, s48, 262144
  s_lshl_b32 s4, s53, 12
  s_add_u32 s56, s56, s4
  s_add_u32 s56, s56, 20971520
  s_add_u32 s55, s56, 262144
  s_add_u32 s62, s62, s52
  s_add_u32 s62, s62, 2
  s_lshl_b32 s54, s62, 13
  s_add_u32 s54, s54, s56
  s_and_b32 s56, s49, 3
  s_mul_i32 s56, s56, 2
  s_sub_u32 s56, 6, s56
  s_and_b32 s3, s48, 7
  s_mul_i32 s3, s3, 1
  s_add_u32 s56, s56, s3
  s_add_u32 s56, s56, s52
  s_cmp_ge_u32 s56, 30
  s_cselect_b32 s3, 30, 0
  s_sub_u32 s56, s56, s3
  s_sub_u32 s3, s56, s52
  s_lshl_b32 s3, s3, 13
  s_add_u32 s54, s54, s3
  s_cmp_ge_u32 s54, s55
  s_cselect_b32 s3, 262144, 0
  s_sub_u32 s54, s54, s3
  s_lshl_b32 s63, s51, 1
  s_lshl_b32 s3, s63, 10
  s_add_u32 s3, s3, 0
  v_add_u32_e64 v20, s3, v1
  v_mov_b32 v24, 0x3f803f80
  v_mov_b32 v25, 0x3f803f80
  v_mov_b32 v26, 0x3f803f80
  v_mov_b32 v27, 0x3f803f80
  s_lshl_b32 s3, s48, 4
  s_add_u32 s3, s3, s49
  s_lshl_b32 s3, s3, 10
  s_add_u32 s3, s3, 67109120
  v_lshl_add_u32 v10, v0, 2, s3

  s_waitcnt vmcnt(0)
  s_barrier
  s_sub_u32 s3, s7, s52
  s_mul_i32 s3, s3, 229376
  s_add_u32 s57, s57, s3
  s_add_u32 s57, s57, 458752
  s_cmp_ge_u32 s57, s58
  s_cselect_b32 s3, 7340032, 0
  s_sub_u32 s57, s57, s3
  s_add_u32 m0, s61, 77824
  s_nop 0
  buffer_load_dwordx4 v240, s[24:27], s57 offen  lds
  s_add_u32 m0, s61, 78848
  s_nop 0
  buffer_load_dwordx4 v241, s[24:27], s57 offen  lds
  s_add_u32 m0, s61, 79872
  s_nop 0
  buffer_load_dwordx4 v242, s[24:27], s57 offen  lds
  s_add_u32 m0, s61, 80896
  s_nop 0
  buffer_load_dwordx4 v243, s[24:27], s57 offen  lds
  s_add_u32 m0, s61, 81920
  s_nop 0
  buffer_load_dwordx4 v244, s[24:27], s57 offen  lds
  s_add_u32 m0, s61, 82944
  s_nop 0
  buffer_load_dwordx4 v245, s[24:27], s57 offen  lds
  s_add_u32 m0, s61, 83968
  s_nop 0
  buffer_load_dwordx4 v246, s[24:27], s57 offen  lds
  s_mov_b64 s[64:65], 0xffff
  s_lshl_b32 s3, s48, 4
  s_add_u32 s3, s3, s49
  s_lshl_b32 s3, s3, 10
  s_add_u32 s3, s3, 67109120
  s_nop 0
  s_mov_b32 s63, 0
  s_mov_b64 exec, 1
Lcw_1021:
  v_mov_b32 v11, 0
  buffer_atomic_add v11, off, s[8:11], s3 sc0 sc1
  s_add_u32 s63, s63, 1
  s_cmp_gt_u32 s63, 200000
  s_cbranch_scc1 Lcd_1022
  s_waitcnt vmcnt(0)
  v_cmp_gt_u32 vcc, 16, v11
  s_cbranch_vccnz Lcw_1021
Lcd_1022:
  s_mov_b64 exec, -1
  s_add_u32 m0, s60, 16384
  s_nop 0
  buffer_load_dwordx4 v1, s[8:11], s54 offen offset:0 sc1 lds
  s_add_u32 s7, s7, 2
  s_cmp_ge_u32 s7, 30
  s_cselect_b32 s3, 458752, 0
  s_cselect_b32 s4, 30, 0
  s_sub_u32 s7, s7, s4
  s_add_u32 s57, s57, s3
  s_add_u32 s57, s57, 458752
  s_cmp_ge_u32 s57, s58
  s_cselect_b32 s3, 7340032, 0
  s_sub_u32 s57, s57, s3
  buffer_load_dwordx4 v1, s[8:11], s54 offen offset:1024 sc1 lds
  buffer_load_dwordx4 v1, s[8:11], s54 offen offset:2048 sc1 lds
  buffer_load_dwordx4 v1, s[8:11], s54 offen offset:3072 sc1 lds
  s_add_u32 s56, s56, 2
  s_cmp_ge_u32 s56, 30
  s_cselect_b32 s3, 16384, 0
  s_cselect_b32 s4, 30, 0
  s_sub_u32 s56, s56, s4
  s_add_u32 s54, s54, s3
  s_add_u32 s54, s54, 16384
  s_cmp_ge_u32 s54, s55
  s_cselect_b32 s3, 262144, 0
  s_sub_u32 s54, s54, s3
  s_add_u32 m0, s60, 32768
  s_nop 0
  buffer_load_dwordx4 v1, s[8:11], s54 offen offset:0 sc1 lds
  buffer_load_dwordx4 v1, s[8:11], s54 offen offset:1024 sc1 lds
  buffer_load_dwordx4 v1, s[8:11], s54 offen offset:2048 sc1 lds
  s_nop 0
  buffer_load_dwordx4 v1, s[8:11], s54 offen offset:3072 sc1 lds
  s_add_u32 m0, s61, 106496
  s_nop 0
  buffer_load_dwordx4 v240, s[24:27], s57 offen  lds
  s_add_u32 s56, s56, 2
  s_cmp_ge_u32 s56, 30
  s_cselect_b32 s3, 16384, 0
  s_cselect_b32 s4, 30, 0
  s_sub_u32 s56, s56, s4
  s_add_u32 s54, s54, s3
  s_add_u32 s54, s54, 16384
  s_cmp_ge_u32 s54, s55
  s_cselect_b32 s3, 262144, 0
  s_sub_u32 s54, s54, s3
  s_add_u32 m0, s61, 107520
  s_nop 0
  buffer_load_dwordx4 v241, s[24:27], s57 offen  lds
  s_add_u32 m0, s61, 108544
  s_nop 0
  buffer_load_dwordx4 v242, s[24:27], s57 offen  lds
  s_add_u32 m0, s61, 109568
  s_nop 0
  buffer_load_dwordx4 v243, s[24:27], s57 offen  lds
  s_add_u32 m0, s61, 110592
  s_nop 0
  buffer_load_dwordx4 v244, s[24:27], s57 offen  lds
  s_add_u32 m0, s61, 111616
  s_nop 0
  buffer_load_dwordx4 v245, s[24:27], s57 offen  lds
  s_add_u32 m0, s61, 112640
  s_nop 0
  buffer_load_dwordx4 v246, s[24:27], s57 offen  lds
  ds_read_b128 v[32:35], v20 offset:0
  ds_read_b128 v[36:39], v20 offset:8192
  ds_read_b128 v[40:43], v20 offset:1024
  ds_read_b128 v[44:47], v20 offset:9216
  s_waitcnt lgkmcnt(0)
  s_waitcnt vmcnt(11)
  s_barrier
  s_add_u32 m0, s60, 0
  s_nop 0
  s_nop 0
  buffer_load_dwordx4 v1, s[8:11], s54 offen offset:0 sc1 lds
  s_add_u32 s7, s7, 2
  s_cmp_ge_u32 s7, 30
  s_cselect_b32 s3, 458752, 0
  s_cselect_b32 s4, 30, 0
  s_sub_u32 s7, s7, s4
  s_add_u32 s57, s57, s3
  s_add_u32 s57, s57, 458752
  s_cmp_ge_u32 s57, s58
  s_cselect_b32 s3, 7340032, 0
  s_sub_u32 s57, s57, s3
  s_nop 0
  buffer_load_dwordx4 v1, s[8:11], s54 offen offset:1024 sc1 lds
  buffer_load_dwordx4 v1, s[8:11], s54 offen offset:2048 sc1 lds
  buffer_load_dwordx4 v1, s[8:11], s54 offen offset:3072 sc1 lds
  s_add_u32 m0, s61, 49152
  s_nop 0
  buffer_load_dwordx4 v240, s[24:27], s57 offen  lds
  s_add_u32 s56, s56, 2
  s_cmp_ge_u32 s56, 30
  s_cselect_b32 s3, 16384, 0
  s_cselect_b32 s4, 30, 0
  s_sub_u32 s56, s56, s4
  s_add_u32 s54, s54, s3
  s_add_u32 s54, s54, 16384
  s_cmp_ge_u32 s54, s55
  s_cselect_b32 s3, 262144, 0
  s_sub_u32 s54, s54, s3
  s_add_u32 m0, s61, 50176
  s_nop 0
  buffer_load_dwordx4 v241, s[24:27], s57 offen  lds
  s_add_u32 m0, s61, 51200
  s_nop 0
  buffer_load_dwordx4 v242, s[24:27], s57 offen  lds
  s_add_u32 m0, s61, 52224
  s_nop 0
  buffer_load_dwordx4 v243, s[24:27], s57 offen  lds
  s_add_u32 m0, s61, 53248
  s_nop 0
  buffer_load_dwordx4 v244, s[24:27], s57 offen  lds
  s_add_u32 m0, s61, 54272
  s_nop 0
  s_nop 0
  buffer_load_dwordx4 v245, s[24:27], s57 offen  lds
  s_add_u32 m0, s61, 55296
  s_nop 0
  buffer_load_dwordx4 v246, s[24:27], s57 offen  lds
  v_mfma_f32_16x16x32_bf16 v[48:51], v[24:27], v[32:35], 0
  v_mfma_f32_16x16x32_bf16 v[52:55], v[32:35], v[32:35], 0
  v_mfma_f32_16x16x32_bf16 v[56:59], v[24:27], v[40:43], 0
  v_mfma_f32_16x16x32_bf16 v[60:63], v[40:43], v[40:43], 0
  s_nop 0
  v_mfma_f32_16x16x32_bf16 v[48:51], v[24:27], v[36:39], v[48:51]
  v_mfma_f32_16x16x32_bf16 v[52:55], v[36:39], v[36:39], v[52:55]
  v_mfma_f32_16x16x32_bf16 v[56:59], v[24:27], v[44:47], v[56:59]
  v_mfma_f32_16x16x32_bf16 v[60:63], v[44:47], v[44:47], v[60:63]
  v_and_b32_e64 v3, 3, v0
  v_cmp_eq_u32 s[4:5], 1, v3
  v_cmp_eq_u32 s[100:101], 2, v3
  v_cmp_eq_u32 s[64:65], 3, v3
  v_bfe_u32 v3, v0, 2, 2
  v_lshrrev_b32 v4, 4, v0
  v_cmp_eq_u32 vcc, v3, v4
  v_and_b32 v3, 15, v0
  v_lshlrev_b32_e64 v3, 3, v3
  s_lshl_b32 s63, s48, 4
  s_add_u32 s63, s63, s49
  s_lshl_b32 s63, s63, 10
  s_lshl_b32 s3, s51, 8
  s_add_u32 s63, s63, s3
  s_add_u32 s63, s63, 65011712
  v_cndmask_b32 v52, v52, v53, s[4:5]
  v_cndmask_b32 v52, v52, v54, s[100:101]
  v_cndmask_b32 v49, v52, v55, s[64:65]
  v_cndmask_b32 v60, v60, v61, s[4:5]
  v_cndmask_b32 v60, v60, v62, s[100:101]
  v_cndmask_b32 v57, v60, v63, s[64:65]
  s_mov_b64 exec, vcc
  buffer_store_dwordx2 v[48:49], v3, s[8:11], s63 offen offset:0 sc1
  buffer_store_dwordx2 v[56:57], v3, s[8:11], s63 offen offset:128 sc1
  s_mov_b64 exec, -1
  s_waitcnt vmcnt(13)
  s_barrier
  s_add_u32 m0, s60, 16384
  s_nop 0
  buffer_load_dwordx4 v1, s[8:11], s54 offen offset:0 sc1 lds
  s_add_u32 s7, s7, 2
  s_cmp_ge_u32 s7, 30
  s_cselect_b32 s3, 458752, 0
  s_cselect_b32 s4, 30, 0
  s_sub_u32 s7, s7, s4
  s_add_u32 s57, s57, s3
  s_add_u32 s57, s57, 458752
  s_cmp_ge_u32 s57, s58
  s_cselect_b32 s3, 7340032, 0
  s_sub_u32 s57, s57, s3
  buffer_load_dwordx4 v1, s[8:11], s54 offen offset:1024 sc1 lds
  buffer_load_dwordx4 v1, s[8:11], s54 offen offset:2048 sc1 lds
  buffer_load_dwordx4 v1, s[8:11], s54 offen offset:3072 sc1 lds
  s_add_u32 m0, s61, 77824
  s_nop 0
  buffer_load_dwordx4 v240, s[24:27], s57 offen  lds
  s_add_u32 s56, s56, 2
  s_cmp_ge_u32 s56, 30
  s_cselect_b32 s3, 16384, 0
  s_cselect_b32 s4, 30, 0
  s_sub_u32 s56, s56, s4
  s_add_u32 s54, s54, s3
  s_add_u32 s54, s54, 16384
  s_cmp_ge_u32 s54, s55
  s_cselect_b32 s3, 262144, 0
  s_sub_u32 s54, s54, s3
  s_add_u32 m0, s61, 78848
  s_nop 0
  s_nop 0
  buffer_load_dwordx4 v241, s[24:27], s57 offen  lds
  s_add_u32 m0, s61, 79872
  s_nop 0
  buffer_load_dwordx4 v242, s[24:27], s57 offen  lds
  s_add_u32 m0, s61, 80896
  s_nop 0
  buffer_load_dwordx4 v243, s[24:27], s57 offen  lds
  s_add_u32 m0, s61, 81920
  s_nop 0
  s_nop 0
  buffer_load_dwordx4 v244, s[24:27], s57 offen  lds
  s_add_u32 m0, s61, 82944
  s_nop 0
  buffer_load_dwordx4 v245, s[24:27], s57 offen  lds
  s_add_u32 m0, s61, 83968
  s_nop 0
  buffer_load_dwordx4 v246, s[24:27], s57 offen  lds
  s_lshl_b32 s59, s2, 2
  s_add_u32 s59, s59, s51
  s_mul_i32 s59, s59, 7168
  s_add_u32 s59, s59, 3200
  s_buffer_load_dword s66, s[28:31], s59
  s_add_u32 s59, s59, 64
  s_buffer_load_dword s67, s[28:31], s59
  s_add_u32 s59, s59, 64
  s_buffer_load_dword s66, s[28:31], s59
  s_add_u32 s59, s59, 64
  s_buffer_load_dword s67, s[28:31], s59
  s_add_u32 s59, s59, 64
  s_buffer_load_dword s66, s[28:31], s59
  s_add_u32 s59, s59, 64
  s_buffer_load_dword s67, s[28:31], s59
  s_add_u32 s59, s59, 64
  s_waitcnt vmcnt(13)
  s_waitcnt vmcnt(11)
  s_barrier
  s_add_u32 m0, s60, 32768
  s_nop 0
  buffer_load_dwordx4 v1, s[8:11], s54 offen offset:0 sc1 lds
  s_add_u32 s7, s7, 2
  s_cmp_ge_u32 s7, 30
  s_cselect_b32 s3, 458752, 0
  s_cselect_b32 s4, 30, 0
  s_sub_u32 s7, s7, s4
  s_add_u32 s57, s57, s3
  s_add_u32 s57, s57, 458752
  s_cmp_ge_u32 s57, s58
  s_cselect_b32 s3, 7340032, 0
  s_sub_u32 s57, s57, s3
  buffer_load_dwordx4 v1, s[8:11], s54 offen offset:1024 sc1 lds
  buffer_load_dwordx4 v1, s[8:11], s54 offen offset:2048 sc1 lds
  buffer_load_dwordx4 v1, s[8:11], s54 offen offset:3072 sc1 lds
  s_nop 0
  s_add_u32 m0, s61, 106496
  s_nop 0
  buffer_load_dwordx4 v240, s[24:27], s57 offen  lds
  s_add_u32 s56, s56, 2
  s_cmp_ge_u32 s56, 30
  s_cselect_b32 s3, 16384, 0
  s_cselect_b32 s4, 30, 0
  s_sub_u32 s56, s56, s4
  s_add_u32 s54, s54, s3
  s_add_u32 s54, s54, 16384
  s_cmp_ge_u32 s54, s55
  s_nop 0
  s_cselect_b32 s3, 262144, 0
  s_sub_u32 s54, s54, s3
  s_add_u32 m0, s61, 107520
  s_nop 0
  buffer_load_dwordx4 v241, s[24:27], s57 offen  lds
  s_add_u32 m0, s61, 108544
  s_nop 0
  buffer_load_dwordx4 v242, s[24:27], s57 offen  lds
  s_add_u32 m0, s61, 109568
  s_nop 0
  buffer_load_dwordx4 v243, s[24:27], s57 offen  lds
  s_add_u32 m0, s61, 110592
  s_nop 0
  buffer_load_dwordx4 v244, s[24:27], s57 offen  lds
  s_add_u32 m0, s61, 111616
  s_nop 0
  buffer_load_dwordx4 v245, s[24:27], s57 offen  lds
  s_add_u32 m0, s61, 112640
  s_nop 0
  s_nop 0
  buffer_load_dwordx4 v246, s[24:27], s57 offen  lds
  s_buffer_load_dword s66, s[28:31], s59
  s_add_u32 s59, s59, 64
  s_buffer_load_dword s67, s[28:31], s59
  s_add_u32 s59, s59, 64
  s_buffer_load_dword s66, s[28:31], s59
  s_add_u32 s59, s59, 64
  s_buffer_load_dword s67, s[28:31], s59
  s_add_u32 s59, s59, 64
  s_buffer_load_dword s66, s[28:31], s59
  s_add_u32 s59, s59, 64
  s_buffer_load_dword s67, s[28:31], s59
  s_add_u32 s59, s59, 64
  s_waitcnt vmcnt(11)
  s_barrier
  s_cmp_lg_u32 s51, 0
  s_cbranch_scc1 Lar_1023
  s_lshl_b32 s3, s48, 14
  s_lshl_b32 s4, s49, 2
  s_add_u32 s3, s3, s4
  s_add_u32 s3, s3, 67109248
  v_lshl_add_u32 v10, v0, 10, s3
  v_mov_b32 v11, 1
  s_mov_b64 exec, 0xffff
  buffer_store_dword v11, v10, s[8:11], 0 offen sc1
  s_mov_b64 exec, -1
Lar_1023:
  s_add_u32 m0, s60, 0
  s_nop 0
  buffer_load_dwordx4 v1, s[8:11], s54 offen offset:0 sc1 lds
  s_add_u32 s7, s7, 2
  s_cmp_ge_u32 s7, 30
  s_cselect_b32 s3, 458752, 0
  s_cselect_b32 s4, 30, 0
  s_sub_u32 s7, s7, s4
  s_add_u32 s57, s57, s3
  s_add_u32 s57, s57, 458752
  s_cmp_ge_u32 s57, s58
  s_cselect_b32 s3, 7340032, 0
  s_sub_u32 s57, s57, s3
  buffer_load_dwordx4 v1, s[8:11], s54 offen offset:1024 sc1 lds
  buffer_load_dwordx4 v1, s[8:11], s54 offen offset:2048 sc1 lds
  buffer_load_dwordx4 v1, s[8:11], s54 offen offset:3072 sc1 lds
  s_add_u32 m0, s61, 49152
  s_nop 0
  s_nop 0
  buffer_load_dwordx4 v240, s[24:27], s57 offen  lds
  s_add_u32 s56, s56, 2
  s_cmp_ge_u32 s56, 30
  s_cselect_b32 s3, 16384, 0
  s_cselect_b32 s4, 30, 0
  s_sub_u32 s56, s56, s4
  s_add_u32 s54, s54, s3
  s_add_u32 s54, s54, 16384
  s_cmp_ge_u32 s54, s55
  s_cselect_b32 s3, 262144, 0
  s_sub_u32 s54, s54, s3
  s_nop 0
  s_add_u32 m0, s61, 50176
  s_nop 0
  buffer_load_dwordx4 v241, s[24:27], s57 offen  lds
  s_add_u32 m0, s61, 51200
  s_nop 0
  buffer_load_dwordx4 v242, s[24:27], s57 offen  lds
  s_add_u32 m0, s61, 52224
  s_nop 0
  buffer_load_dwordx4 v243, s[24:27], s57 offen  lds
  s_nop 0
  s_add_u32 m0, s61, 53248
  s_nop 0
  buffer_load_dwordx4 v244, s[24:27], s57 offen  lds
  s_add_u32 m0, s61, 54272
  s_nop 0
  buffer_load_dwordx4 v245, s[24:27], s57 offen  lds
  s_add_u32 m0, s61, 55296
  s_nop 0
  buffer_load_dwordx4 v246, s[24:27], s57 offen  lds
  s_nop 0
  s_buffer_load_dword s66, s[28:31], s59
  s_add_u32 s59, s59, 64
  s_buffer_load_dword s67, s[28:31], s59
  s_add_u32 s59, s59, 64
  s_buffer_load_dword s66, s[28:31], s59
  s_add_u32 s59, s59, 64
  s_buffer_load_dword s67, s[28:31], s59
  s_add_u32 s59, s59, 64
  s_buffer_load_dword s66, s[28:31], s59
  s_add_u32 s59, s59, 64
  s_nop 0
  s_buffer_load_dword s67, s[28:31], s59
  s_add_u32 s59, s59, 64
  s_waitcnt vmcnt(11)
  s_barrier
  s_add_u32 m0, s60, 16384
  s_nop 0
  buffer_load_dwordx4 v1, s[8:11], s54 offen offset:0 sc1 lds
  s_add_u32 s7, s7, 2
  s_cmp_ge_u32 s7, 30
  s_cselect_b32 s3, 458752, 0
  s_cselect_b32 s4, 30, 0
  s_sub_u32 s7, s7, s4
  s_add_u32 s57, s57, s3
  s_add_u32 s57, s57, 458752
  s_cmp_ge_u32 s57, s58
  s_cselect_b32 s3, 7340032, 0
  s_sub_u32 s57, s57, s3
  buffer_load_dwordx4 v1, s[8:11], s54 offen offset:1024 sc1 lds
  buffer_load_dwordx4 v1, s[8:11], s54 offen offset:2048 sc1 lds
  buffer_load_dwordx4 v1, s[8:11], s54 offen offset:3072 sc1 lds
  s_add_u32 m0, s61, 77824
  s_nop 0
  buffer_load_dwordx4 v240, s[24:27], s57 offen  lds
  s_add_u32 s56, s56, 2
  s_cmp_ge_u32 s56, 30
  s_cselect_b32 s3, 16384, 0
  s_cselect_b32 s4, 30, 0
  s_sub_u32 s56, s56, s4
  s_add_u32 s54, s54, s3
  s_add_u32 s54, s54, 16384
  s_cmp_ge_u32 s54, s55
  s_cselect_b32 s3, 262144, 0
  s_sub_u32 s54, s54, s3
  s_nop 0
  s_add_u32 m0, s61, 78848
  s_nop 0
  buffer_load_dwordx4 v241, s[24:27], s57 offen  lds
  s_add_u32 m0, s61, 79872
  s_nop 0
  buffer_load_dwordx4 v242, s[24:27], s57 offen  lds
  s_add_u32 m0, s61, 80896
  s_nop 0
  buffer_load_dwordx4 v243, s[24:27], s57 offen  lds
  s_nop 0
  s_add_u32 m0, s61, 81920
  s_nop 0
  buffer_load_dwordx4 v244, s[24:27], s57 offen  lds
  s_add_u32 m0, s61, 82944
  s_nop 0
  buffer_load_dwordx4 v245, s[24:27], s57 offen  lds
  s_add_u32 m0, s61, 83968
  s_nop 0
  buffer_load_dwordx4 v246, s[24:27], s57 offen  lds
  s_nop 0
  s_buffer_load_dword s66, s[28:31], s59
  s_add_u32 s59, s59, 64
  s_buffer_load_dword s67, s[28:31], s59
  s_add_u32 s59, s59, 64
  s_buffer_load_dword s66, s[28:31], s59
  s_add_u32 s59, s59, 64
  s_buffer_load_dword s67, s[28:31], s59
  s_add_u32 s59, s59, 64
  s_buffer_load_dword s66, s[28:31], s59
  s_add_u32 s59, s59, 64
  s_nop 0
  s_buffer_load_dword s67, s[28:31], s59
  s_add_u32 s59, s59, 64
  s_waitcnt vmcnt(11)
  s_barrier
  s_add_u32 m0, s60, 32768
  s_nop 0
  buffer_load_dwordx4 v1, s[8:11], s54 offen offset:0 sc1 lds
  s_add_u32 s7, s7, 2
  s_cmp_ge_u32 s7, 30
  s_cselect_b32 s3, 458752, 0
  s_cselect_b32 s4, 30, 0
  s_sub_u32 s7, s7, s4
  s_add_u32 s57, s57, s3
  s_add_u32 s57, s57, 458752
  s_cmp_ge_u32 s57, s58
  s_cselect_b32 s3, 7340032, 0
  s_sub_u32 s57, s57, s3
  buffer_load_dwordx4 v1, s[8:11], s54 offen offset:1024 sc1 lds
  buffer_load_dwordx4 v1, s[8:11], s54 offen offset:2048 sc1 lds
  buffer_load_dwordx4 v1, s[8:11], s54 offen offset:3072 sc1 lds
  s_add_u32 m0, s61, 106496
  s_nop 0
  buffer_load_dwordx4 v240, s[24:27], s57 offen  lds
  s_add_u32 s56, s56, 2
  s_cmp_ge_u32 s56, 30
  s_cselect_b32 s3, 16384, 0
  s_cselect_b32 s4, 30, 0
  s_sub_u32 s56, s56, s4
  s_add_u32 s54, s54, s3
  s_add_u32 s54, s54, 16384
  s_cmp_ge_u32 s54, s55
  s_cselect_b32 s3, 262144, 0
  s_sub_u32 s54, s54, s3
  s_nop 0
  s_add_u32 m0, s61, 107520
  s_nop 0
  buffer_load_dwordx4 v241, s[24:27], s57 offen  lds
  s_add_u32 m0, s61, 108544
  s_nop 0
  buffer_load_dwordx4 v242, s[24:27], s57 offen  lds
  s_add_u32 m0, s61, 109568
  s_nop 0
  buffer_load_dwordx4 v243, s[24:27], s57 offen  lds
  s_nop 0
  s_add_u32 m0, s61, 110592
  s_nop 0
  buffer_load_dwordx4 v244, s[24:27], s57 offen  lds
  s_add_u32 m0, s61, 111616
  s_nop 0
  buffer_load_dwordx4 v245, s[24:27], s57 offen  lds
  s_add_u32 m0, s61, 112640
  s_nop 0
  buffer_load_dwordx4 v246, s[24:27], s57 offen  lds
  s_nop 0
  s_buffer_load_dword s66, s[28:31], s59
  s_add_u32 s59, s59, 64
  s_buffer_load_dword s67, s[28:31], s59
  s_add_u32 s59, s59, 64
  s_buffer_load_dword s66, s[28:31], s59
  s_add_u32 s59, s59, 64
  s_buffer_load_dword s67, s[28:31], s59
  s_add_u32 s59, s59, 64
  s_buffer_load_dword s66, s[28:31], s59
  s_add_u32 s59, s59, 64
  s_nop 0
  s_buffer_load_dword s67, s[28:31], s59
  s_add_u32 s59, s59, 64
  s_waitcnt vmcnt(11)
  s_barrier
  s_add_u32 m0, s60, 0
  s_nop 0
  buffer_load_dwordx4 v1, s[8:11], s54 offen offset:0 sc1 lds
  s_add_u32 s7, s7, 2
  s_cmp_ge_u32 s7, 30
  s_cselect_b32 s3, 458752, 0
  s_cselect_b32 s4, 30, 0
  s_sub_u32 s7, s7, s4
  s_add_u32 s57, s57, s3
  s_add_u32 s57, s57, 458752
  s_cmp_ge_u32 s57, s58
  s_cselect_b32 s3, 7340032, 0
  s_sub_u32 s57, s57, s3
  buffer_load_dwordx4 v1, s[8:11], s54 offen offset:1024 sc1 lds
  buffer_load_dwordx4 v1, s[8:11], s54 offen offset:2048 sc1 lds
  buffer_load_dwordx4 v1, s[8:11], s54 offen offset:3072 sc1 lds
  s_add_u32 m0, s61, 49152
  s_nop 0
  s_nop 0
  buffer_load_dwordx4 v240, s[24:27], s57 offen  lds
  s_add_u32 s56, s56, 2
  s_cmp_ge_u32 s56, 30
  s_cselect_b32 s3, 16384, 0
  s_cselect_b32 s4, 30, 0
  s_sub_u32 s56, s56, s4
  s_add_u32 s54, s54, s3
  s_add_u32 s54, s54, 16384
  s_cmp_ge_u32 s54, s55
  s_cselect_b32 s3, 262144, 0
  s_sub_u32 s54, s54, s3
  s_nop 0
  s_add_u32 m0, s61, 50176
  s_nop 0
  buffer_load_dwordx4 v241, s[24:27], s57 offen  lds
  s_add_u32 m0, s61, 51200
  s_nop 0
  buffer_load_dwordx4 v242, s[24:27], s57 offen  lds
  s_add_u32 m0, s61, 52224
  s_nop 0
  buffer_load_dwordx4 v243, s[24:27], s57 offen  lds
  s_nop 0
  s_add_u32 m0, s61, 53248
  s_nop 0
  buffer_load_dwordx4 v244, s[24:27], s57 offen  lds
  s_add_u32 m0, s61, 54272
  s_nop 0
  buffer_load_dwordx4 v245, s[24:27], s57 offen  lds
  s_add_u32 m0, s61, 55296
  s_nop 0
  buffer_load_dwordx4 v246, s[24:27], s57 offen  lds
  s_nop 0
  s_buffer_load_dword s66, s[28:31], s59
  s_add_u32 s59, s59, 64
  s_buffer_load_dword s67, s[28:31], s59
  s_add_u32 s59, s59, 64
  s_buffer_load_dword s66, s[28:31], s59
  s_add_u32 s59, s59, 64
  s_buffer_load_dword s67, s[28:31], s59
  s_add_u32 s59, s59, 64
  s_buffer_load_dword s66, s[28:31], s59
  s_add_u32 s59, s59, 64
  s_nop 0
  s_buffer_load_dword s67, s[28:31], s59
  s_add_u32 s59, s59, 64
  s_waitcnt vmcnt(11)
  s_barrier
  s_add_u32 m0, s60, 16384
  s_nop 0
  buffer_load_dwordx4 v1, s[8:11], s54 offen offset:0 sc1 lds
  s_add_u32 s7, s7, 2
  s_cmp_ge_u32 s7, 30
  s_cselect_b32 s3, 458752, 0
  s_cselect_b32 s4, 30, 0
  s_sub_u32 s7, s7, s4
  s_add_u32 s57, s57, s3
  s_add_u32 s57, s57, 458752
  s_cmp_ge_u32 s57, s58
  s_cselect_b32 s3, 7340032, 0
  s_sub_u32 s57, s57, s3
  buffer_load_dwordx4 v1, s[8:11], s54 offen offset:1024 sc1 lds
  buffer_load_dwordx4 v1, s[8:11], s54 offen offset:2048 sc1 lds
  buffer_load_dwordx4 v1, s[8:11], s54 offen offset:3072 sc1 lds
  s_add_u32 m0, s61, 77824
  s_nop 0
  buffer_load_dwordx4 v240, s[24:27], s57 offen  lds
  s_add_u32 s56, s56, 2
  s_cmp_ge_u32 s56, 30
  s_cselect_b32 s3, 16384, 0
  s_cselect_b32 s4, 30, 0
  s_sub_u32 s56, s56, s4
  s_add_u32 s54, s54, s3
  s_add_u32 s54, s54, 16384
  s_cmp_ge_u32 s54, s55
  s_cselect_b32 s3, 262144, 0
  s_sub_u32 s54, s54, s3
  s_nop 0
  s_add_u32 m0, s61, 78848
  s_nop 0
  buffer_load_dwordx4 v241, s[24:27], s57 offen  lds
  s_add_u32 m0, s61, 79872
  s_nop 0
  buffer_load_dwordx4 v242, s[24:27], s57 offen  lds
  s_add_u32 m0, s61, 80896
  s_nop 0
  buffer_load_dwordx4 v243, s[24:27], s57 offen  lds
  s_nop 0
  s_add_u32 m0, s61, 81920
  s_nop 0
  buffer_load_dwordx4 v244, s[24:27], s57 offen  lds
  s_add_u32 m0, s61, 82944
  s_nop 0
  buffer_load_dwordx4 v245, s[24:27], s57 offen  lds
  s_add_u32 m0, s61, 83968
  s_nop 0
  buffer_load_dwordx4 v246, s[24:27], s57 offen  lds
  s_nop 0
  s_buffer_load_dword s66, s[28:31], s59
  s_add_u32 s59, s59, 64
  s_buffer_load_dword s67, s[28:31], s59
  s_add_u32 s59, s59, 64
  s_buffer_load_dword s66, s[28:31], s59
  s_add_u32 s59, s59, 64
  s_buffer_load_dword s67, s[28:31], s59
  s_add_u32 s59, s59, 64
  s_buffer_load_dword s66, s[28:31], s59
  s_add_u32 s59, s59, 64
  s_nop 0
  s_buffer_load_dword s67, s[28:31], s59
  s_add_u32 s59, s59, 64
  s_waitcnt vmcnt(11)
  s_barrier
  s_add_u32 m0, s60, 32768
  s_nop 0
  buffer_load_dwordx4 v1, s[8:11], s54 offen offset:0 sc1 lds
  s_add_u32 s7, s7, 2
  s_cmp_ge_u32 s7, 30
  s_cselect_b32 s3, 458752, 0
  s_cselect_b32 s4, 30, 0
  s_sub_u32 s7, s7, s4
  s_add_u32 s57, s57, s3
  s_add_u32 s57, s57, 458752
  s_cmp_ge_u32 s57, s58
  s_cselect_b32 s3, 7340032, 0
  s_sub_u32 s57, s57, s3
  buffer_load_dwordx4 v1, s[8:11], s54 offen offset:1024 sc1 lds
  buffer_load_dwordx4 v1, s[8:11], s54 offen offset:2048 sc1 lds
  buffer_load_dwordx4 v1, s[8:11], s54 offen offset:3072 sc1 lds
  s_add_u32 m0, s61, 106496
  s_nop 0
  buffer_load_dwordx4 v240, s[24:27], s57 offen  lds
  s_add_u32 s56, s56, 2
  s_cmp_ge_u32 s56, 30
  s_cselect_b32 s3, 16384, 0
  s_cselect_b32 s4, 30, 0
  s_sub_u32 s56, s56, s4
  s_add_u32 s54, s54, s3
  s_add_u32 s54, s54, 16384
  s_cmp_ge_u32 s54, s55
  s_cselect_b32 s3, 262144, 0
  s_sub_u32 s54, s54, s3
  s_nop 0
  s_add_u32 m0, s61, 107520
  s_nop 0
  buffer_load_dwordx4 v241, s[24:27], s57 offen  lds
  s_add_u32 m0, s61, 108544
  s_nop 0
  buffer_load_dwordx4 v242, s[24:27], s57 offen  lds
  s_add_u32 m0, s61, 109568
  s_nop 0
  buffer_load_dwordx4 v243, s[24:27], s57 offen  lds
  s_nop 0
  s_add_u32 m0, s61, 110592
  s_nop 0
  buffer_load_dwordx4 v244, s[24:27], s57 offen  lds
  s_add_u32 m0, s61, 111616
  s_nop 0
  buffer_load_dwordx4 v245, s[24:27], s57 offen  lds
  s_add_u32 m0, s61, 112640
  s_nop 0
  buffer_load_dwordx4 v246, s[24:27], s57 offen  lds
  s_nop 0
  s_buffer_load_dword s66, s[28:31], s59
  s_add_u32 s59, s59, 64
  s_buffer_load_dword s67, s[28:31], s59
  s_add_u32 s59, s59, 64
  s_buffer_load_dword s66, s[28:31], s59
  s_add_u32 s59, s59, 64
  s_buffer_load_dword s67, s[28:31], s59
  s_add_u32 s59, s59, 64
  s_buffer_load_dword s66, s[28:31], s59
  s_add_u32 s59, s59, 64
  s_nop 0
  s_buffer_load_dword s67, s[28:31], s59
  s_add_u32 s59, s59, 64
  s_waitcnt vmcnt(11)
  s_barrier
  s_add_u32 m0, s60, 0
  s_nop 0
  buffer_load_dwordx4 v1, s[8:11], s54 offen offset:0 sc1 lds
  s_add_u32 s7, s7, 2
  s_cmp_ge_u32 s7, 30
  s_cselect_b32 s3, 458752, 0
  s_cselect_b32 s4, 30, 0
  s_sub_u32 s7, s7, s4
  s_add_u32 s57, s57, s3
  s_add_u32 s57, s57, 458752
  s_cmp_ge_u32 s57, s58
  s_cselect_b32 s3, 7340032, 0
  s_sub_u32 s57, s57, s3
  buffer_load_dwordx4 v1, s[8:11], s54 offen offset:1024 sc1 lds
  buffer_load_dwordx4 v1, s[8:11], s54 offen offset:2048 sc1 lds
  buffer_load_dwordx4 v1, s[8:11], s54 offen offset:3072 sc1 lds
  s_add_u32 m0, s61, 49152
  s_nop 0
  s_nop 0
  buffer_load_dwordx4 v240, s[24:27], s57 offen  lds
  s_add_u32 s56, s56, 2
  s_cmp_ge_u32 s56, 30
  s_cselect_b32 s3, 16384, 0
  s_cselect_b32 s4, 30, 0
  s_sub_u32 s56, s56, s4
  s_add_u32 s54, s54, s3
  s_add_u32 s54, s54, 16384
  s_cmp_ge_u32 s54, s55
  s_cselect_b32 s3, 262144, 0
  s_sub_u32 s54, s54, s3
  s_nop 0
  s_add_u32 m0, s61, 50176
  s_nop 0
  buffer_load_dwordx4 v241, s[24:27], s57 offen  lds
  s_add_u32 m0, s61, 51200
  s_nop 0
  buffer_load_dwordx4 v242, s[24:27], s57 offen  lds
  s_add_u32 m0, s61, 52224
  s_nop 0
  buffer_load_dwordx4 v243, s[24:27], s57 offen  lds
  s_nop 0
  s_add_u32 m0, s61, 53248
  s_nop 0
  buffer_load_dwordx4 v244, s[24:27], s57 offen  lds
  s_add_u32 m0, s61, 54272
  s_nop 0
  buffer_load_dwordx4 v245, s[24:27], s57 offen  lds
  s_add_u32 m0, s61, 55296
  s_nop 0
  buffer_load_dwordx4 v246, s[24:27], s57 offen  lds
  s_nop 0
  s_buffer_load_dword s66, s[28:31], s59
  s_add_u32 s59, s59, 64
  s_buffer_load_dword s67, s[28:31], s59
  s_add_u32 s59, s59, 64
  s_buffer_load_dword s66, s[28:31], s59
  s_add_u32 s59, s59, 64
  s_buffer_load_dword s67, s[28:31], s59
  s_add_u32 s59, s59, 64
  s_buffer_load_dword s66, s[28:31], s59
  s_add_u32 s59, s59, 64
  s_nop 0
  s_buffer_load_dword s67, s[28:31], s59
  s_add_u32 s59, s59, 64
  s_waitcnt vmcnt(11)
  s_barrier
  s_add_u32 m0, s60, 16384
  s_nop 0
  buffer_load_dwordx4 v1, s[8:11], s54 offen offset:0 sc1 lds
  s_add_u32 s7, s7, 2
  s_cmp_ge_u32 s7, 30
  s_cselect_b32 s3, 458752, 0
  s_cselect_b32 s4, 30, 0
  s_sub_u32 s7, s7, s4
  s_add_u32 s57, s57, s3
  s_add_u32 s57, s57, 458752
  s_cmp_ge_u32 s57, s58
  s_cselect_b32 s3, 7340032, 0
  s_sub_u32 s57, s57, s3
  buffer_load_dwordx4 v1, s[8:11], s54 offen offset:1024 sc1 lds
  buffer_load_dwordx4 v1, s[8:11], s54 offen offset:2048 sc1 lds
  buffer_load_dwordx4 v1, s[8:11], s54 offen offset:3072 sc1 lds
  s_add_u32 m0, s61, 77824
  s_nop 0
  buffer_load_dwordx4 v240, s[24:27], s57 offen  lds
  s_add_u32 s56, s56, 2
  s_cmp_ge_u32 s56, 30
  s_cselect_b32 s3, 16384, 0
  s_cselect_b32 s4, 30, 0
  s_sub_u32 s56, s56, s4
  s_add_u32 s54, s54, s3
  s_add_u32 s54, s54, 16384
  s_cmp_ge_u32 s54, s55
  s_cselect_b32 s3, 262144, 0
  s_sub_u32 s54, s54, s3
  s_nop 0
  s_add_u32 m0, s61, 78848
  s_nop 0
  buffer_load_dwordx4 v241, s[24:27], s57 offen  lds
  s_add_u32 m0, s61, 79872
  s_nop 0
  buffer_load_dwordx4 v242, s[24:27], s57 offen  lds
  s_add_u32 m0, s61, 80896
  s_nop 0
  buffer_load_dwordx4 v243, s[24:27], s57 offen  lds
  s_nop 0
  s_add_u32 m0, s61, 81920
  s_nop 0
  buffer_load_dwordx4 v244, s[24:27], s57 offen  lds
  s_add_u32 m0, s61, 82944
  s_nop 0
  buffer_load_dwordx4 v245, s[24:27], s57 offen  lds
  s_add_u32 m0, s61, 83968
  s_nop 0
  buffer_load_dwordx4 v246, s[24:27], s57 offen  lds
  s_nop 0
  s_buffer_load_dword s66, s[28:31], s59
  s_add_u32 s59, s59, 64
  s_buffer_load_dword s67, s[28:31], s59
  s_add_u32 s59, s59, 64
  s_buffer_load_dword s66, s[28:31], s59
  s_add_u32 s59, s59, 64
  s_buffer_load_dword s67, s[28:31], s59
  s_add_u32 s59, s59, 64
  s_buffer_load_dword s66, s[28:31], s59
  s_add_u32 s59, s59, 64
  s_nop 0
  s_buffer_load_dword s67, s[28:31], s59
  s_add_u32 s59, s59, 64
  s_waitcnt vmcnt(11)
  s_barrier
  s_add_u32 m0, s60, 32768
  s_nop 0
  buffer_load_dwordx4 v1, s[8:11], s54 offen offset:0 sc1 lds
  s_add_u32 s7, s7, 2
  s_cmp_ge_u32 s7, 30
  s_cselect_b32 s3, 458752, 0
  s_cselect_b32 s4, 30, 0
  s_sub_u32 s7, s7, s4
  s_add_u32 s57, s57, s3
  s_add_u32 s57, s57, 458752
  s_cmp_ge_u32 s57, s58
  s_cselect_b32 s3, 7340032, 0
  s_sub_u32 s57, s57, s3
  buffer_load_dwordx4 v1, s[8:11], s54 offen offset:1024 sc1 lds
  buffer_load_dwordx4 v1, s[8:11], s54 offen offset:2048 sc1 lds
  buffer_load_dwordx4 v1, s[8:11], s54 offen offset:3072 sc1 lds
  s_add_u32 m0, s61, 106496
  s_nop 0
  buffer_load_dwordx4 v240, s[24:27], s57 offen  lds
  s_add_u32 s56, s56, 2
  s_cmp_ge_u32 s56, 30
  s_cselect_b32 s3, 16384, 0
  s_cselect_b32 s4, 30, 0
  s_sub_u32 s56, s56, s4
  s_add_u32 s54, s54, s3
  s_add_u32 s54, s54, 16384
  s_cmp_ge_u32 s54, s55
  s_cselect_b32 s3, 262144, 0
  s_sub_u32 s54, s54, s3
  s_nop 0
  s_add_u32 m0, s61, 107520
  s_nop 0
  buffer_load_dwordx4 v241, s[24:27], s57 offen  lds
  s_add_u32 m0, s61, 108544
  s_nop 0
  buffer_load_dwordx4 v242, s[24:27], s57 offen  lds
  s_add_u32 m0, s61, 109568
  s_nop 0
  buffer_load_dwordx4 v243, s[24:27], s57 offen  lds
  s_nop 0
  s_add_u32 m0, s61, 110592
  s_nop 0
  buffer_load_dwordx4 v244, s[24:27], s57 offen  lds
  s_add_u32 m0, s61, 111616
  s_nop 0
  buffer_load_dwordx4 v245, s[24:27], s57 offen  lds
  s_add_u32 m0, s61, 112640
  s_nop 0
  buffer_load_dwordx4 v246, s[24:27], s57 offen  lds
  s_nop 0
  s_buffer_load_dword s66, s[28:31], s59
  s_add_u32 s59, s59, 64
  s_buffer_load_dword s67, s[28:31], s59
  s_add_u32 s59, s59, 64
  s_getpc_b64 s[4:5]
Lpc_1024:
  s_sub_u32 s4, s4, Lpc_1024-sequential_preLN__sliding_block__dense_activation_gelu__prompt_kernel
  s_subb_u32 s5, s5, 0
  s_lshr_b32 s3, s2, 3
  s_lshl_b32 s3, s3, 2
  s_add_u32 s3, s3, s51
  s_mul_i32 s3, s3, 6
  v_add_u32 v12, s3, v0
  v_lshlrev_b32 v12, 7, v12
  v_min_u32 v12, Lend-sequential_preLN__sliding_block__dense_activation_gelu__prompt_kernel-4, v12
  s_mov_b64 exec, 0x3f
  global_load_dword v13, v12, s[4:5]
  s_mov_b64 exec, -1
  s_waitcnt vmcnt(12)
  s_barrier
  s_lshl_b32 s3, s48, 4
  s_add_u32 s3, s3, s49
  s_lshl_b32 s3, s3, 10
  s_add_u32 s3, s3, 67109248
  v_lshl_add_u32 v10, v0, 2, s3
  v_cmp_lt_u32 vcc, 15, v0
  v_add_u32 v11, 320, v10
  s_mov_b32 s64, -1
  s_mov_b32 s65, 0
  v_cndmask_b32_e64 v10, v10, v11, vcc
  s_mov_b64 exec, s[64:65]
  buffer_load_dword v11, v10, s[8:11], 0 offen sc1
  s_mov_b64 exec, -1
  s_add_u32 m0, s60, 0
  s_nop 0
  buffer_load_dwordx4 v1, s[8:11], s54 offen offset:0 sc1 lds
  s_add_u32 s7, s7, 2
  s_cmp_ge_u32 s7, 30
  s_cselect_b32 s3, 458752, 0
  s_cselect_b32 s4, 30, 0
  s_sub_u32 s7, s7, s4
  s_add_u32 s57, s57, s3
  s_add_u32 s57, s57, 458752
  s_cmp_ge_u32 s57, s58
  s_cselect_b32 s3, 7340032, 0
  s_sub_u32 s57, s57, s3
  buffer_load_dwordx4 v1, s[8:11], s54 offen offset:1024 sc1 lds
  buffer_load_dwordx4 v1, s[8:11], s54 offen offset:2048 sc1 lds
  s_nop 0
  buffer_load_dwordx4 v1, s[8:11], s54 offen offset:3072 sc1 lds
  s_add_u32 m0, s61, 49152
  s_nop 0
  buffer_load_dwordx4 v240, s[24:27], s57 offen  lds
  s_add_u32 m0, s61, 50176
  s_nop 0
  buffer_load_dwordx4 v241, s[24:27], s57 offen  lds
  s_add_u32 m0, s61, 51200
  s_nop 0
  s_nop 0
  buffer_load_dwordx4 v242, s[24:27], s57 offen  lds
  s_add_u32 m0, s61, 52224
  s_nop 0
  buffer_load_dwordx4 v243, s[24:27], s57 offen  lds
  s_add_u32 m0, s61, 53248
  s_nop 0
  buffer_load_dwordx4 v244, s[24:27], s57 offen  lds
  s_add_u32 m0, s61, 54272
  s_nop 0
  s_nop 0
  buffer_load_dwordx4 v245, s[24:27], s57 offen  lds
  s_add_u32 m0, s61, 55296
  s_nop 0
  buffer_load_dwordx4 v246, s[24:27], s57 offen  lds
  s_mov_b32 s63, 0
  s_mov_b64 exec, s[64:65]
  s_waitcnt vmcnt(11)
  v_cmp_ne_u32 vcc, 1, v11
  s_cbranch_vccz Lpd_1027
Lpoll_1026:
  buffer_load_dword v11, v10, s[8:11], 0 offen sc1
  s_add_u32 s63, s63, 1
  s_nop 0
  s_cmp_gt_u32 s63, 200000
  s_cbranch_scc1 Lpd_1027
  s_waitcnt vmcnt(0)
  v_cmp_ne_u32 vcc, 1, v11
  s_cbranch_vccz Lpd_1027
  s_sleep 1
  s_branch Lpoll_1026
Lpd_1027:
  s_mov_b64 exec, -1
  s_barrier
  s_lshl_b32 s4, s48, 14
  s_lshl_b32 s5, s51, 8
  s_add_u32 s4, s4, s5
  s_add_u32 s4, s4, 65011712
  v_and_b32 v3, 15, v0
  v_lshrrev_b32 v4, 4, v0
  v_lshlrev_b32 v3, 4, v3
  v_lshl_add_u32 v5, v4, 10, v3
  buffer_load_dwordx4 v[32:35], v5, s[8:11], s4 offen sc1
  s_add_u32 s4, s4, 4096
  buffer_load_dwordx4 v[36:39], v5, s[8:11], s4 offen sc1
  s_add_u32 s4, s4, 4096
  buffer_load_dwordx4 v[40:43], v5, s[8:11], s4 offen sc1
  s_add_u32 s4, s4, 4096
  buffer_load_dwordx4 v[44:47], v5, s[8:11], s4 offen sc1
  s_mov_b32 s4, s49
  s_mul_i32 s4, s4, 14336
  s_mul_i32 s5, s51, 224
  s_add_u32 s4, s4, s5
  s_add_u32 s4, s4, 66060288
  v_mul_u32_u24 v4, 896, v4
  v_min_u32 v3, 208, v3
  v_add_u32_e64 v5, v4, v3
  buffer_load_dwordx4 v[64:67], v5, s[8:11], s4 offen sc1
  s_add_u32 s4, s4, 3584
  buffer_load_dwordx4 v[68:71], v5, s[8:11], s4 offen sc1
  s_add_u32 s4, s4, 3584
  buffer_load_dwordx4 v[72:75], v5, s[8:11], s4 offen sc1
  s_add_u32 s4, s4, 3584
  buffer_load_dwordx4 v[76:79], v5, s[8:11], s4 offen sc1
  s_waitcnt vmcnt(8)
  s_barrier
  s_waitcnt vmcnt(0)
  v_pk_add_f32 v[32:33], v[32:33], v[36:37]
  v_pk_add_f32 v[34:35], v[34:35], v[38:39]
  v_pk_add_f32 v[40:41], v[40:41], v[44:45]
  v_pk_add_f32 v[42:43], v[42:43], v[46:47]
  v_pk_add_f32 v[64:65], v[64:65], v[68:69]
  v_pk_add_f32 v[66:67], v[66:67], v[70:71]
  v_pk_add_f32 v[72:73], v[72:73], v[76:77]
  s_nop 0
  v_pk_add_f32 v[74:75], v[74:75], v[78:79]
  v_pk_add_f32 v[32:33], v[32:33], v[40:41]
  v_pk_add_f32 v[34:35], v[34:35], v[42:43]
  v_pk_add_f32 v[64:65], v[64:65], v[72:73]
  v_pk_add_f32 v[66:67], v[66:67], v[74:75]
  v_mov_b32 v36, v32
  v_mov_b32 v68, v64
  v_mov_b32 v37, v33
  v_mov_b32 v69, v65
  v_mov_b32 v38, v34
  v_mov_b32 v70, v66
  v_mov_b32 v39, v35
  v_mov_b32 v71, v67
  s_nop 0
  v_permlane32_swap_b32 v32, v36
  v_permlane32_swap_b32 v64, v68
  v_permlane32_swap_b32 v33, v37
  v_permlane32_swap_b32 v65, v69
  v_permlane32_swap_b32 v34, v38
  v_permlane32_swap_b32 v66, v70
  v_permlane32_swap_b32 v35, v39
  v_permlane32_swap_b32 v67, v71
  s_nop 0
  v_pk_add_f32 v[32:33], v[32:33], v[36:37]
  v_pk_add_f32 v[34:35], v[34:35], v[38:39]
  v_pk_add_f32 v[64:65], v[64:65], v[68:69]
  v_pk_add_f32 v[66:67], v[66:67], v[70:71]
  v_mov_b32 v36, v32
  v_mov_b32 v68, v64
  v_mov_b32 v37, v33
  v_mov_b32 v69, v65
  v_mov_b32 v38, v34
  v_mov_b32 v70, v66
  v_mov_b32 v39, v35
  v_mov_b32 v71, v67
  s_nop 0
  v_permlane16_swap_b32 v32, v36
  v_permlane16_swap_b32 v64, v68
  v_permlane16_swap_b32 v33, v37
  v_permlane16_swap_b32 v65, v69
  v_permlane16_swap_b32 v34, v38
  v_permlane16_swap_b32 v66, v70
  v_permlane16_swap_b32 v35, v39
  v_permlane16_swap_b32 v67, v71
  s_nop 0
  v_pk_add_f32 v[32:33], v[32:33], v[36:37]
  v_pk_add_f32 v[34:35], v[34:35], v[38:39]
  v_pk_add_f32 v[64:65], v[64:65], v[68:69]
  v_pk_add_f32 v[66:67], v[66:67], v[70:71]
  v_mul_f32 v36, 0x3a800000, v32
  v_mul_f32 v37, 0x3a800000, v34
  v_mul_f32 v38, 0x3a800000, v33
  v_mul_f32 v39, 0x3a800000, v35
  v_fma_f32 v38, -v36, v36, v38
  v_fma_f32 v39, -v37, v37, v39
  v_max_f32 v38, 0, v38
  v_max_f32 v39, 0, v39
  v_add_f32 v38, 0x3727c5ac, v38
  v_add_f32 v39, 0x3727c5ac, v39
  v_rsq_f32 v38, v38
  v_rsq_f32_e64 v39, v39
  s_lshl_b32 s3, s51, 7
  s_add_u32 s3, s3, 77824
  v_pk_mul_f32 v[36:37], v[36:37], v[38:39] neg_lo:[1,0] neg_hi:[1,0]
  v_lshl_add_u32 v3, v0, 3, s3
  s_mul_i32 s3, s51, 224
  s_add_u32 s3, s3, 78848
  v_lshl_add_u32 v4, v0, 4, s3
  s_mov_b64 exec, 0xffff
  ds_write_b64 v3, v[38:39]
  ds_write_b64 v3, v[36:37] offset:512
  s_mov_b64 exec, 0x3fff
  ds_write_b128 v4, v[64:67]
  s_mov_b64 exec, -1
  s_waitcnt lgkmcnt(0)
  s_barrier
  s_and_b32 s62, s49, 7
  s_mul_i32 s62, s62, 7
  s_add_u32 s62, s62, s52
  s_lshl_b32 s4, s53, 4
  s_lshr_b32 s5, s49, 3
  s_mul_i32 s5, s5, 1792
  s_add_u32 s4, s4, s5
  s_mul_i32 s4, s4, 2048
  s_add_u32 s66, s4, 3670016
  s_mul_i32 s59, s62, 65536
  s_add_u32 s59, s59, s4
  s_mul_i32 s67, s51, 4096
  s_and_b32 s7, s49, 3
  s_mul_i32 s7, s7, 7
  s_sub_u32 s7, 50, s7
  s_and_b32 s3, s48, 7
  s_mul_i32 s3, s3, 0
  s_add_u32 s7, s7, s3
  s_add_u32 s7, s7, s52
  s_cmp_ge_u32 s7, 50
  s_cselect_b32 s3, 50, 0
  s_sub_u32 s7, s7, s3
  s_and_b32 s4, s49, 7
  s_lshl_b32 s4, s4, 8
  v_lshrrev_b32 v3, 3, v0
  v_and_b32 v4, 7, v0
  v_and_b32 v5, 6, v3
  v_xor_b32 v4, v4, v5
  v_lshlrev_b32_e64 v4, 4, v4
  v_mul_u32_u24 v5, 2048, v3
  v_add3_u32 v5, v5, v4, s4
  v_add_u32 v232, 0, v5
  v_add_u32 v233, 16384, v5
  v_add_u32 v234, 128, v5
  v_add_u32 v235, 16512, v5
  s_and_b32 s62, s49, 7
  s_mul_i32 s62, s62, 7
  s_lshl_b32 s60, s51, 12
  s_mul_i32 s56, s48, 917504
  s_lshr_b32 s4, s49, 3
  s_mul_i32 s4, s4, 458752
  s_add_u32 s56, s56, s4
  s_lshl_b32 s4, s53, 12
  s_add_u32 s56, s56, s4
  s_add_u32 s56, s56, 33554432
  s_add_u32 s55, s56, 458752
  s_add_u32 s62, s62, s52
  s_add_u32 s62, s62, 6
  s_lshl_b32 s54, s62, 13
  s_add_u32 s54, s54, s56
  s_and_b32 s56, s49, 3
  s_mul_i32 s56, s56, 7
  s_sub_u32 s56, 50, s56
  s_and_b32 s3, s48, 7
  s_mul_i32 s3, s3, 0
  s_add_u32 s56, s56, s3
  s_add_u32 s56, s56, s52
  s_cmp_ge_u32 s56, 50
  s_cselect_b32 s3, 50, 0
  s_sub_u32 s56, s56, s3
  s_sub_u32 s3, s56, s52
  s_lshl_b32 s3, s3, 13
  s_add_u32 s54, s54, s3
  s_cmp_ge_u32 s54, s55
  s_cselect_b32 s3, 458752, 0
  s_sub_u32 s54, s54, s3
  s_nop 0
  s_add_u32 m0, s67, 81920
  s_nop 0
  buffer_load_dwordx4 v232, s[28:31], s59 offen  lds
  s_add_u32 m0, s67, 82944
  s_nop 0
  buffer_load_dwordx4 v233, s[28:31], s59 offen  lds
  s_add_u32 m0, s67, 83968
  s_nop 0
  buffer_load_dwordx4 v234, s[28:31], s59 offen  lds
  s_waitcnt vmcnt(2)
  s_add_u32 m0, s67, 84992
  s_nop 0
  buffer_load_dwordx4 v235, s[28:31], s59 offen  lds
  s_waitcnt vmcnt(2)
  s_add_u32 s59, s59, 131072
  s_cmp_ge_u32 s59, s66
  s_cselect_b32 s3, 3670016, 0
  s_sub_u32 s59, s59, s3
  s_add_u32 m0, s67, 98304
  s_nop 0
  s_nop 0
  buffer_load_dwordx4 v232, s[28:31], s59 offen  lds
  s_waitcnt vmcnt(2)
  s_add_u32 m0, s67, 99328
  s_nop 0
  buffer_load_dwordx4 v233, s[28:31], s59 offen  lds
  s_waitcnt vmcnt(2)
  s_add_u32 m0, s67, 100352
  s_nop 0
  buffer_load_dwordx4 v234, s[28:31], s59 offen  lds
  s_waitcnt vmcnt(2)
  s_nop 0
  s_add_u32 m0, s67, 101376
  s_nop 0
  buffer_load_dwordx4 v235, s[28:31], s59 offen  lds
  s_waitcnt vmcnt(2)
  s_add_u32 s59, s59, 131072
  s_cmp_ge_u32 s59, s66
  s_cselect_b32 s3, 3670016, 0
  s_sub_u32 s59, s59, s3
  s_add_u32 m0, s67, 114688
  s_nop 0
  s_nop 0
  buffer_load_dwordx4 v232, s[28:31], s59 offen  lds
  s_waitcnt vmcnt(2)
  s_add_u32 m0, s67, 115712
  s_nop 0
  buffer_load_dwordx4 v233, s[28:31], s59 offen  lds
  s_waitcnt vmcnt(2)
  s_add_u32 m0, s67, 116736
  s_nop 0
  buffer_load_dwordx4 v234, s[28:31], s59 offen  lds
  s_waitcnt vmcnt(2)
  s_nop 0
  s_add_u32 m0, s67, 117760
  s_nop 0
  buffer_load_dwordx4 v235, s[28:31], s59 offen  lds
  s_waitcnt vmcnt(2)
  s_lshl_b32 s3, s48, 4
  s_add_u32 s3, s3, s49
  s_lshl_b32 s3, s3, 10
  s_add_u32 s3, s3, 67109376
  v_lshl_add_u32 v10, v0, 2, s3
  s_and_b32 s4, s49, 8
  s_lshl_b32 s64, 0xff, s4
  s_mov_b32 s65, 0
  s_waitcnt vmcnt(0)
  s_barrier
  s_sub_u32 s3, s7, s52
  s_mul_i32 s3, s3, 65536
  s_add_u32 s59, s59, s3
  s_add_u32 s59, s59, 131072
  s_cmp_ge_u32 s59, s66
  s_cselect_b32 s3, 3670016, 0
  s_sub_u32 s59, s59, s3
  s_add_u32 m0, s67, 131072
  s_nop 0
  buffer_load_dwordx4 v232, s[28:31], s59 offen  lds
  s_add_u32 m0, s67, 132096
  s_nop 0
  buffer_load_dwordx4 v233, s[28:31], s59 offen  lds
  s_add_u32 m0, s67, 133120
  s_nop 0
  buffer_load_dwordx4 v234, s[28:31], s59 offen  lds
  s_add_u32 m0, s67, 134144
  s_nop 0
  s_nop 0
  buffer_load_dwordx4 v235, s[28:31], s59 offen  lds
  s_add_u32 s7, s7, 2
  s_cmp_ge_u32 s7, 50
  s_cselect_b32 s3, 393216, 0
  s_cselect_b32 s4, 50, 0
  s_sub_u32 s7, s7, s4
  s_add_u32 s59, s59, s3
  s_add_u32 s59, s59, 131072
  s_cmp_ge_u32 s59, s66
  s_cselect_b32 s3, 3670016, 0
  s_sub_u32 s59, s59, s3
  s_nop 0
  s_add_u32 m0, s67, 147456
  s_nop 0
  buffer_load_dwordx4 v232, s[28:31], s59 offen  lds
  s_add_u32 m0, s67, 148480
  s_nop 0
  buffer_load_dwordx4 v233, s[28:31], s59 offen  lds
  s_add_u32 m0, s67, 149504
  s_nop 0
  buffer_load_dwordx4 v234, s[28:31], s59 offen  lds
  s_nop 0
  s_add_u32 m0, s67, 150528
  s_nop 0
  buffer_load_dwordx4 v235, s[28:31], s59 offen  lds
  s_lshl_b32 s3, s48, 4
  s_add_u32 s3, s3, s49
  s_lshl_b32 s3, s3, 10
  s_add_u32 s3, s3, 67109376
  s_nop 0
  s_mov_b32 s63, 0
  s_mov_b64 exec, 1
Lcw_1028:
  v_mov_b32 v11, 0
  buffer_atomic_add v11, off, s[8:11], s3 sc0 sc1
  s_add_u32 s63, s63, 1
  s_cmp_gt_u32 s63, 200000
  s_cbranch_scc1 Lcd_1029
  s_waitcnt vmcnt(0)
  v_cmp_gt_u32 vcc, 4, v11
  s_cbranch_vccnz Lcw_1028
Lcd_1029:
  s_mov_b64 exec, -1
  s_add_u32 m0, s60, 49152
  s_nop 0
  buffer_load_dwordx4 v1, s[8:11], s54 offen offset:0 sc1 lds
  s_add_u32 s7, s7, 2
  s_cmp_ge_u32 s7, 50
  s_nop 0
  s_cselect_b32 s3, 393216, 0
  s_cselect_b32 s4, 50, 0
  s_sub_u32 s7, s7, s4
  s_add_u32 s59, s59, s3
  s_add_u32 s59, s59, 131072
  s_cmp_ge_u32 s59, s66
  s_cselect_b32 s3, 3670016, 0
  s_sub_u32 s59, s59, s3
  buffer_load_dwordx4 v1, s[8:11], s54 offen offset:1024 sc1 lds
  buffer_load_dwordx4 v1, s[8:11], s54 offen offset:2048 sc1 lds
  s_nop 0
  buffer_load_dwordx4 v1, s[8:11], s54 offen offset:3072 sc1 lds
  s_add_u32 s56, s56, 2
  s_cmp_ge_u32 s56, 50
  s_cselect_b32 s3, 49152, 0
  s_cselect_b32 s4, 50, 0
  s_sub_u32 s56, s56, s4
  s_add_u32 s54, s54, s3
  s_add_u32 s54, s54, 16384
  s_cmp_ge_u32 s54, s55
  s_cselect_b32 s3, 458752, 0
  s_sub_u32 s54, s54, s3
  s_nop 0
  s_add_u32 m0, s60, 65536
  s_nop 0
  buffer_load_dwordx4 v1, s[8:11], s54 offen offset:0 sc1 lds
  buffer_load_dwordx4 v1, s[8:11], s54 offen offset:1024 sc1 lds
  buffer_load_dwordx4 v1, s[8:11], s54 offen offset:2048 sc1 lds
  buffer_load_dwordx4 v1, s[8:11], s54 offen offset:3072 sc1 lds
  s_waitcnt vmcnt(4)
  s_barrier
  s_add_u32 s56, s56, 2
  s_cmp_ge_u32 s56, 50
  s_nop 0
  s_cselect_b32 s3, 49152, 0
  s_cselect_b32 s4, 50, 0
  s_sub_u32 s56, s56, s4
  s_add_u32 s54, s54, s3
  s_add_u32 s54, s54, 16384
  s_cmp_ge_u32 s54, s55
  s_cselect_b32 s3, 458752, 0
  s_sub_u32 s54, s54, s3
  s_add_u32 m0, s60, 0
  s_nop 0
  buffer_load_dwordx4 v1, s[8:11], s54 offen offset:0 sc1 lds
  s_nop 0
  buffer_load_dwordx4 v1, s[8:11], s54 offen offset:1024 sc1 lds
  buffer_load_dwordx4 v1, s[8:11], s54 offen offset:2048 sc1 lds
  buffer_load_dwordx4 v1, s[8:11], s54 offen offset:3072 sc1 lds
  s_add_u32 m0, s67, 81920
  s_nop 0
  buffer_load_dwordx4 v232, s[28:31], s59 offen  lds
  s_add_u32 s56, s56, 2
  s_cmp_ge_u32 s56, 50
  s_cselect_b32 s3, 49152, 0
  s_cselect_b32 s4, 50, 0
  s_sub_u32 s56, s56, s4
  s_add_u32 s54, s54, s3
  s_add_u32 s54, s54, 16384
  s_cmp_ge_u32 s54, s55
  s_cselect_b32 s3, 458752, 0
  s_sub_u32 s54, s54, s3
  s_add_u32 m0, s67, 82944
  s_nop 0
  buffer_load_dwordx4 v233, s[28:31], s59 offen  lds
  s_add_u32 m0, s67, 83968
  s_nop 0
  buffer_load_dwordx4 v234, s[28:31], s59 offen  lds
  s_add_u32 m0, s67, 84992
  s_nop 0
  buffer_load_dwordx4 v235, s[28:31], s59 offen  lds
  s_add_u32 m0, s60, 16384
  s_nop 0
  buffer_load_dwordx4 v1, s[8:11], s54 offen offset:0 sc1 lds
  s_add_u32 s7, s7, 2
  s_cmp_ge_u32 s7, 50
  s_cselect_b32 s3, 393216, 0
  s_cselect_b32 s4, 50, 0
  s_sub_u32 s7, s7, s4
  s_add_u32 s59, s59, s3
  s_add_u32 s59, s59, 131072
  s_cmp_ge_u32 s59, s66
  s_cselect_b32 s3, 3670016, 0
  s_sub_u32 s59, s59, s3
  buffer_load_dwordx4 v1, s[8:11], s54 offen offset:1024 sc1 lds
  buffer_load_dwordx4 v1, s[8:11], s54 offen offset:2048 sc1 lds
  buffer_load_dwordx4 v1, s[8:11], s54 offen offset:3072 sc1 lds
  s_nop 0
  s_add_u32 m0, s67, 98304
  s_nop 0
  buffer_load_dwordx4 v232, s[28:31], s59 offen  lds
  s_add_u32 s56, s56, 2
  s_cmp_ge_u32 s56, 50
  s_cselect_b32 s3, 49152, 0
  s_cselect_b32 s4, 50, 0
  s_sub_u32 s56, s56, s4
  s_add_u32 s54, s54, s3
  s_add_u32 s54, s54, 16384
  s_cmp_ge_u32 s54, s55
  s_nop 0
  s_cselect_b32 s3, 458752, 0
  s_sub_u32 s54, s54, s3
  s_add_u32 m0, s67, 99328
  s_nop 0
  buffer_load_dwordx4 v233, s[28:31], s59 offen  lds
  s_add_u32 m0, s67, 100352
  s_nop 0
  buffer_load_dwordx4 v234, s[28:31], s59 offen  lds
  s_add_u32 m0, s67, 101376
  s_nop 0
  buffer_load_dwordx4 v235, s[28:31], s59 offen  lds
  s_waitcnt vmcnt(16)
  s_barrier
  s_add_u32 m0, s60, 32768
  s_nop 0
  buffer_load_dwordx4 v1, s[8:11], s54 offen offset:0 sc1 lds
  s_add_u32 s7, s7, 2
  s_cmp_ge_u32 s7, 50
  s_cselect_b32 s3, 393216, 0
  s_cselect_b32 s4, 50, 0
  s_sub_u32 s7, s7, s4
  s_add_u32 s59, s59, s3
  s_add_u32 s59, s59, 131072
  s_cmp_ge_u32 s59, s66
  s_cselect_b32 s3, 3670016, 0
  s_sub_u32 s59, s59, s3
  buffer_load_dwordx4 v1, s[8:11], s54 offen offset:1024 sc1 lds
  buffer_load_dwordx4 v1, s[8:11], s54 offen offset:2048 sc1 lds
  buffer_load_dwordx4 v1, s[8:11], s54 offen offset:3072 sc1 lds
  s_add_u32 m0, s67, 114688
  s_nop 0
  s_nop 0
  buffer_load_dwordx4 v232, s[28:31], s59 offen  lds
  s_add_u32 s56, s56, 2
  s_cmp_ge_u32 s56, 50
  s_cselect_b32 s3, 49152, 0
  s_cselect_b32 s4, 50, 0
  s_sub_u32 s56, s56, s4
  s_add_u32 s54, s54, s3
  s_add_u32 s54, s54, 16384
  s_cmp_ge_u32 s54, s55
  s_cselect_b32 s3, 458752, 0
  s_sub_u32 s54, s54, s3
  s_nop 0
  s_add_u32 m0, s67, 115712
  s_nop 0
  buffer_load_dwordx4 v233, s[28:31], s59 offen  lds
  s_add_u32 m0, s67, 116736
  s_nop 0
  buffer_load_dwordx4 v234, s[28:31], s59 offen  lds
  s_add_u32 m0, s67, 117760
  s_nop 0
  buffer_load_dwordx4 v235, s[28:31], s59 offen  lds
  s_nop 0
  s_add_u32 m0, s60, 49152
  s_nop 0
  buffer_load_dwordx4 v1, s[8:11], s54 offen offset:0 sc1 lds
  s_add_u32 s7, s7, 2
  s_cmp_ge_u32 s7, 50
  s_cselect_b32 s3, 393216, 0
  s_cselect_b32 s4, 50, 0
  s_sub_u32 s7, s7, s4
  s_add_u32 s59, s59, s3
  s_add_u32 s59, s59, 131072
  s_cmp_ge_u32 s59, s66
  s_nop 0
  s_cselect_b32 s3, 3670016, 0
  s_sub_u32 s59, s59, s3
  buffer_load_dwordx4 v1, s[8:11], s54 offen offset:1024 sc1 lds
  buffer_load_dwordx4 v1, s[8:11], s54 offen offset:2048 sc1 lds
  buffer_load_dwordx4 v1, s[8:11], s54 offen offset:3072 sc1 lds
  s_add_u32 m0, s67, 131072
  s_nop 0
  buffer_load_dwordx4 v232, s[28:31], s59 offen  lds
  s_add_u32 s56, s56, 2
  s_cmp_ge_u32 s56, 50
  s_cselect_b32 s3, 49152, 0
  s_cselect_b32 s4, 50, 0
  s_sub_u32 s56, s56, s4
  s_add_u32 s54, s54, s3
  s_add_u32 s54, s54, 16384
  s_cmp_ge_u32 s54, s55
  s_cselect_b32 s3, 458752, 0
  s_sub_u32 s54, s54, s3
  s_add_u32 m0, s67, 132096
  s_nop 0
  buffer_load_dwordx4 v233, s[28:31], s59 offen  lds
  s_add_u32 m0, s67, 133120
  s_nop 0
  buffer_load_dwordx4 v234, s[28:31], s59 offen  lds
  s_add_u32 m0, s67, 134144
  s_nop 0
  buffer_load_dwordx4 v235, s[28:31], s59 offen  lds
  s_waitcnt vmcnt(24)
  s_barrier
  s_add_u32 m0, s60, 65536
  s_nop 0
  s_nop 0
  buffer_load_dwordx4 v1, s[8:11], s54 offen offset:0 sc1 lds
  s_add_u32 s7, s7, 2
  s_cmp_ge_u32 s7, 50
  s_cselect_b32 s3, 393216, 0
  s_cselect_b32 s4, 50, 0
  s_sub_u32 s7, s7, s4
  s_add_u32 s59, s59, s3
  s_add_u32 s59, s59, 131072
  s_cmp_ge_u32 s59, s66
  s_cselect_b32 s3, 3670016, 0
  s_sub_u32 s59, s59, s3
  s_nop 0
  buffer_load_dwordx4 v1, s[8:11], s54 offen offset:1024 sc1 lds
  buffer_load_dwordx4 v1, s[8:11], s54 offen offset:2048 sc1 lds
  buffer_load_dwordx4 v1, s[8:11], s54 offen offset:3072 sc1 lds
  s_add_u32 m0, s67, 147456
  s_nop 0
  buffer_load_dwordx4 v232, s[28:31], s59 offen  lds
  s_add_u32 s56, s56, 2
  s_cmp_ge_u32 s56, 50
  s_cselect_b32 s3, 49152, 0
  s_cselect_b32 s4, 50, 0
  s_sub_u32 s56, s56, s4
  s_add_u32 s54, s54, s3
  s_add_u32 s54, s54, 16384
  s_cmp_ge_u32 s54, s55
  s_cselect_b32 s3, 458752, 0
  s_sub_u32 s54, s54, s3
  s_add_u32 m0, s67, 148480
  s_nop 0
  buffer_load_dwordx4 v233, s[28:31], s59 offen  lds
  s_add_u32 m0, s67, 149504
  s_nop 0
  buffer_load_dwordx4 v234, s[28:31], s59 offen  lds
  s_add_u32 m0, s67, 150528
  s_nop 0
  buffer_load_dwordx4 v235, s[28:31], s59 offen  lds
  s_waitcnt vmcnt(24)
  s_barrier
  s_add_u32 m0, s60, 0
  s_nop 0
  buffer_load_dwordx4 v1, s[8:11], s54 offen offset:0 sc1 lds
  s_add_u32 s7, s7, 2
  s_cmp_ge_u32 s7, 50
  s_nop 0
  s_cselect_b32 s3, 393216, 0
  s_cselect_b32 s4, 50, 0
  s_sub_u32 s7, s7, s4
  s_add_u32 s59, s59, s3
  s_add_u32 s59, s59, 131072
  s_cmp_ge_u32 s59, s66
  s_cselect_b32 s3, 3670016, 0
  s_sub_u32 s59, s59, s3
  buffer_load_dwordx4 v1, s[8:11], s54 offen offset:1024 sc1 lds
  buffer_load_dwordx4 v1, s[8:11], s54 offen offset:2048 sc1 lds
  s_nop 0
  buffer_load_dwordx4 v1, s[8:11], s54 offen offset:3072 sc1 lds
  s_add_u32 m0, s67, 81920
  s_nop 0
  buffer_load_dwordx4 v232, s[28:31], s59 offen  lds
  s_add_u32 s56, s56, 2
  s_cmp_ge_u32 s56, 50
  s_cselect_b32 s3, 49152, 0
  s_cselect_b32 s4, 50, 0
  s_sub_u32 s56, s56, s4
  s_add_u32 s54, s54, s3
  s_add_u32 s54, s54, 16384
  s_cmp_ge_u32 s54, s55
  s_cselect_b32 s3, 458752, 0
  s_sub_u32 s54, s54, s3
  s_add_u32 m0, s67, 82944
  s_nop 0
  buffer_load_dwordx4 v233, s[28:31], s59 offen  lds
  s_add_u32 m0, s67, 83968
  s_nop 0
  buffer_load_dwordx4 v234, s[28:31], s59 offen  lds
  s_add_u32 m0, s67, 84992
  s_nop 0
  buffer_load_dwordx4 v235, s[28:31], s59 offen  lds
  s_waitcnt vmcnt(24)
  s_barrier
  s_add_u32 m0, s60, 16384
  s_nop 0
  buffer_load_dwordx4 v1, s[8:11], s54 offen offset:0 sc1 lds
  s_add_u32 s7, s7, 2
  s_cmp_ge_u32 s7, 50
  s_cselect_b32 s3, 393216, 0
  s_cselect_b32 s4, 50, 0
  s_sub_u32 s7, s7, s4
  s_add_u32 s59, s59, s3
  s_add_u32 s59, s59, 131072
  s_cmp_ge_u32 s59, s66
  s_cselect_b32 s3, 3670016, 0
  s_sub_u32 s59, s59, s3
  buffer_load_dwordx4 v1, s[8:11], s54 offen offset:1024 sc1 lds
  buffer_load_dwordx4 v1, s[8:11], s54 offen offset:2048 sc1 lds
  buffer_load_dwordx4 v1, s[8:11], s54 offen offset:3072 sc1 lds
  s_add_u32 m0, s67, 98304
  s_nop 0
  buffer_load_dwordx4 v232, s[28:31], s59 offen  lds
  s_add_u32 s56, s56, 2
  s_cmp_ge_u32 s56, 50
  s_cselect_b32 s3, 49152, 0
  s_cselect_b32 s4, 50, 0
  s_sub_u32 s56, s56, s4
  s_add_u32 s54, s54, s3
  s_add_u32 s54, s54, 16384
  s_cmp_ge_u32 s54, s55
  s_cselect_b32 s3, 458752, 0
  s_sub_u32 s54, s54, s3
  s_nop 0
  s_add_u32 m0, s67, 99328
  s_nop 0
  buffer_load_dwordx4 v233, s[28:31], s59 offen  lds
  s_add_u32 m0, s67, 100352
  s_nop 0
  buffer_load_dwordx4 v234, s[28:31], s59 offen  lds
  s_add_u32 m0, s67, 101376
  s_nop 0
  buffer_load_dwordx4 v235, s[28:31], s59 offen  lds
  s_waitcnt vmcnt(24)
  s_barrier
  s_lshl_b32 s3, s48, 4
  s_add_u32 s3, s3, s49
  s_lshl_b32 s3, s3, 10
  s_add_u32 s3, s3, 67109380
  s_mov_b64 exec, 1
  v_mov_b32 v11, 0
  buffer_atomic_add v11, off, s[8:11], s3 sc0 sc1
  s_mov_b64 exec, -1
  s_add_u32 m0, s60, 32768
  s_nop 0
  buffer_load_dwordx4 v1, s[8:11], s54 offen offset:0 sc1 lds
  s_add_u32 s7, s7, 2
  s_cmp_ge_u32 s7, 50
  s_cselect_b32 s3, 393216, 0
  s_cselect_b32 s4, 50, 0
  s_sub_u32 s7, s7, s4
  s_add_u32 s59, s59, s3
  s_add_u32 s59, s59, 131072
  s_cmp_ge_u32 s59, s66
  s_cselect_b32 s3, 3670016, 0
  s_sub_u32 s59, s59, s3
  buffer_load_dwordx4 v1, s[8:11], s54 offen offset:1024 sc1 lds
  s_nop 0
  buffer_load_dwordx4 v1, s[8:11], s54 offen offset:2048 sc1 lds
  buffer_load_dwordx4 v1, s[8:11], s54 offen offset:3072 sc1 lds
  s_add_u32 m0, s67, 114688
  s_nop 0
  buffer_load_dwordx4 v232, s[28:31], s59 offen  lds
  s_add_u32 s56, s56, 2
  s_cmp_ge_u32 s56, 50
  s_cselect_b32 s3, 49152, 0
  s_cselect_b32 s4, 50, 0
  s_sub_u32 s56, s56, s4
  s_add_u32 s54, s54, s3
  s_add_u32 s54, s54, 16384
  s_cmp_ge_u32 s54, s55
  s_cselect_b32 s3, 458752, 0
  s_sub_u32 s54, s54, s3
  s_add_u32 m0, s67, 115712
  s_nop 0
  buffer_load_dwordx4 v233, s[28:31], s59 offen  lds
  s_add_u32 m0, s67, 116736
  s_nop 0
  buffer_load_dwordx4 v234, s[28:31], s59 offen  lds
  s_add_u32 m0, s67, 117760
  s_nop 0
  buffer_load_dwordx4 v235, s[28:31], s59 offen  lds
  s_waitcnt vmcnt(8)
  s_mov_b64 exec, 1
  v_cmp_gt_u32 vcc, 4, v11
  s_mov_b64 exec, -1
  s_cbranch_vccz Lco_1030
  s_lshl_b32 s3, s48, 4
  s_add_u32 s3, s3, s49
  s_lshl_b32 s3, s3, 10
  s_add_u32 s3, s3, 67109380
  s_nop 0
  s_mov_b32 s63, 0
  s_mov_b64 exec, 1
Lcw_1031:
  v_mov_b32 v11, 0
  buffer_atomic_add v11, off, s[8:11], s3 sc0 sc1
  s_add_u32 s63, s63, 1
  s_cmp_gt_u32 s63, 200000
  s_cbranch_scc1 Lcd_1032
  s_waitcnt vmcnt(0)
  v_cmp_gt_u32 vcc, 4, v11
  s_cbranch_vccnz Lcw_1031
Lcd_1032:
  s_mov_b64 exec, -1
Lco_1030:
  s_barrier
  s_add_u32 m0, s60, 49152
  s_nop 0
  buffer_load_dwordx4 v1, s[8:11], s54 offen offset:0 sc1 lds
  s_add_u32 s7, s7, 2
  s_cmp_ge_u32 s7, 50
  s_cselect_b32 s3, 393216, 0
  s_cselect_b32 s4, 50, 0
  s_sub_u32 s7, s7, s4
  s_add_u32 s59, s59, s3
  s_add_u32 s59, s59, 131072
  s_cmp_ge_u32 s59, s66
  s_cselect_b32 s3, 3670016, 0
  s_sub_u32 s59, s59, s3
  buffer_load_dwordx4 v1, s[8:11], s54 offen offset:1024 sc1 lds
  buffer_load_dwordx4 v1, s[8:11], s54 offen offset:2048 sc1 lds
  buffer_load_dwordx4 v1, s[8:11], s54 offen offset:3072 sc1 lds
  s_add_u32 m0, s67, 131072
  s_nop 0
  buffer_load_dwordx4 v232, s[28:31], s59 offen  lds
  s_add_u32 s56, s56, 2
  s_cmp_ge_u32 s56, 50
  s_cselect_b32 s3, 49152, 0
  s_cselect_b32 s4, 50, 0
  s_sub_u32 s56, s56, s4
  s_add_u32 s54, s54, s3
  s_add_u32 s54, s54, 16384
  s_cmp_ge_u32 s54, s55
  s_cselect_b32 s3, 458752, 0
  s_sub_u32 s54, s54, s3
  s_add_u32 m0, s67, 132096
  s_nop 0
  buffer_load_dwordx4 v233, s[28:31], s59 offen  lds
  s_add_u32 m0, s67, 133120
  s_nop 0
  buffer_load_dwordx4 v234, s[28:31], s59 offen  lds
  s_add_u32 m0, s67, 134144
  s_nop 0
  buffer_load_dwordx4 v235, s[28:31], s59 offen  lds
  s_barrier
  s_add_u32 m0, s60, 65536
  s_nop 0
  buffer_load_dwordx4 v1, s[8:11], s54 offen offset:0 sc1 lds
  s_add_u32 s7, s7, 2
  s_cmp_ge_u32 s7, 50
  s_nop 0
  s_cselect_b32 s3, 393216, 0
  s_cselect_b32 s4, 50, 0
  s_sub_u32 s7, s7, s4
  s_add_u32 s59, s59, s3
  s_add_u32 s59, s59, 131072
  s_cmp_ge_u32 s59, s66
  s_cselect_b32 s3, 3670016, 0
  s_sub_u32 s59, s59, s3
  buffer_load_dwordx4 v1, s[8:11], s54 offen offset:1024 sc1 lds
  buffer_load_dwordx4 v1, s[8:11], s54 offen offset:2048 sc1 lds
  s_nop 0
  buffer_load_dwordx4 v1, s[8:11], s54 offen offset:3072 sc1 lds
  s_add_u32 m0, s67, 147456
  s_nop 0
  buffer_load_dwordx4 v232, s[28:31], s59 offen  lds
  s_add_u32 s56, s56, 2
  s_cmp_ge_u32 s56, 50
  s_cselect_b32 s3, 49152, 0
  s_cselect_b32 s4, 50, 0
  s_sub_u32 s56, s56, s4
  s_add_u32 s54, s54, s3
  s_add_u32 s54, s54, 16384
  s_cmp_ge_u32 s54, s55
  s_cselect_b32 s3, 458752, 0
  s_sub_u32 s54, s54, s3
  s_add_u32 m0, s67, 148480
  s_nop 0
  buffer_load_dwordx4 v233, s[28:31], s59 offen  lds
  s_add_u32 m0, s67, 149504
  s_nop 0
  buffer_load_dwordx4 v234, s[28:31], s59 offen  lds
  s_add_u32 m0, s67, 150528
  s_nop 0
  buffer_load_dwordx4 v235, s[28:31], s59 offen  lds
  s_barrier
  s_add_u32 m0, s60, 0
  s_nop 0
  buffer_load_dwordx4 v1, s[8:11], s54 offen offset:0 sc1 lds
  s_add_u32 s7, s7, 2
  s_cmp_ge_u32 s7, 50
  s_cselect_b32 s3, 393216, 0
  s_cselect_b32 s4, 50, 0
  s_sub_u32 s7, s7, s4
  s_add_u32 s59, s59, s3
  s_nop 0
  s_add_u32 s59, s59, 131072
  s_cmp_ge_u32 s59, s66
  s_cselect_b32 s3, 3670016, 0
  s_sub_u32 s59, s59, s3
  buffer_load_dwordx4 v1, s[8:11], s54 offen offset:1024 sc1 lds
  buffer_load_dwordx4 v1, s[8:11], s54 offen offset:2048 sc1 lds
  buffer_load_dwordx4 v1, s[8:11], s54 offen offset:3072 sc1 lds
  s_add_u32 m0, s67, 81920
  s_nop 0
  s_nop 0
  buffer_load_dwordx4 v232, s[28:31], s59 offen  lds
  s_add_u32 s56, s56, 2
  s_cmp_ge_u32 s56, 50
  s_cselect_b32 s3, 49152, 0
  s_cselect_b32 s4, 50, 0
  s_sub_u32 s56, s56, s4
  s_add_u32 s54, s54, s3
  s_add_u32 s54, s54, 16384
  s_cmp_ge_u32 s54, s55
  s_cselect_b32 s3, 458752, 0
  s_sub_u32 s54, s54, s3
  s_nop 0
  s_add_u32 m0, s67, 82944
  s_nop 0
  buffer_load_dwordx4 v233, s[28:31], s59 offen  lds
  s_add_u32 m0, s67, 83968
  s_nop 0
  buffer_load_dwordx4 v234, s[28:31], s59 offen  lds
  s_add_u32 m0, s67, 84992
  s_nop 0
  buffer_load_dwordx4 v235, s[28:31], s59 offen  lds
  s_waitcnt vmcnt(24)
  s_barrier
  s_add_u32 m0, s60, 16384
  s_nop 0
  buffer_load_dwordx4 v1, s[8:11], s54 offen offset:0 sc1 lds
  s_add_u32 s7, s7, 2
  s_cmp_ge_u32 s7, 50
  s_cselect_b32 s3, 393216, 0
  s_cselect_b32 s4, 50, 0
  s_sub_u32 s7, s7, s4
  s_add_u32 s59, s59, s3
  s_add_u32 s59, s59, 131072
  s_cmp_ge_u32 s59, s66
  s_cselect_b32 s3, 3670016, 0
  s_sub_u32 s59, s59, s3
  buffer_load_dwordx4 v1, s[8:11], s54 offen offset:1024 sc1 lds
  buffer_load_dwordx4 v1, s[8:11], s54 offen offset:2048 sc1 lds
  buffer_load_dwordx4 v1, s[8:11], s54 offen offset:3072 sc1 lds
  s_add_u32 m0, s67, 98304
  s_nop 0
  buffer_load_dwordx4 v232, s[28:31], s59 offen  lds
  s_add_u32 s56, s56, 2
  s_cmp_ge_u32 s56, 50
  s_cselect_b32 s3, 49152, 0
  s_cselect_b32 s4, 50, 0
  s_sub_u32 s56, s56, s4
  s_add_u32 s54, s54, s3
  s_add_u32 s54, s54, 16384
  s_cmp_ge_u32 s54, s55
  s_cselect_b32 s3, 458752, 0
  s_sub_u32 s54, s54, s3
  s_add_u32 m0, s67, 99328
  s_nop 0
  buffer_load_dwordx4 v233, s[28:31], s59 offen  lds
  s_add_u32 m0, s67, 100352
  s_nop 0
  buffer_load_dwordx4 v234, s[28:31], s59 offen  lds
  s_add_u32 m0, s67, 101376
  s_nop 0
  buffer_load_dwordx4 v235, s[28:31], s59 offen  lds
  s_waitcnt vmcnt(24)
  s_barrier
  s_add_u32 m0, s60, 32768
  s_nop 0
  s_nop 0
  buffer_load_dwordx4 v1, s[8:11], s54 offen offset:0 sc1 lds
  s_add_u32 s7, s7, 2
  s_cmp_ge_u32 s7, 50
  s_cselect_b32 s3, 393216, 0
  s_cselect_b32 s4, 50, 0
  s_sub_u32 s7, s7, s4
  s_add_u32 s59, s59, s3
  s_add_u32 s59, s59, 131072
  s_cmp_ge_u32 s59, s66
  s_cselect_b32 s3, 3670016, 0
  s_sub_u32 s59, s59, s3
  s_nop 0
  buffer_load_dwordx4 v1, s[8:11], s54 offen offset:1024 sc1 lds
  buffer_load_dwordx4 v1, s[8:11], s54 offen offset:2048 sc1 lds
  buffer_load_dwordx4 v1, s[8:11], s54 offen offset:3072 sc1 lds
  s_add_u32 m0, s67, 114688
  s_nop 0
  buffer_load_dwordx4 v232, s[28:31], s59 offen  lds
  s_add_u32 s56, s56, 2
  s_cmp_ge_u32 s56, 50
  s_cselect_b32 s3, 49152, 0
  s_cselect_b32 s4, 50, 0
  s_sub_u32 s56, s56, s4
  s_add_u32 s54, s54, s3
  s_add_u32 s54, s54, 16384
  s_cmp_ge_u32 s54, s55
  s_cselect_b32 s3, 458752, 0
  s_sub_u32 s54, s54, s3
  s_add_u32 m0, s67, 115712
  s_nop 0
  buffer_load_dwordx4 v233, s[28:31], s59 offen  lds
  s_add_u32 m0, s67, 116736
  s_nop 0
  buffer_load_dwordx4 v234, s[28:31], s59 offen  lds
  s_add_u32 m0, s67, 117760
  s_nop 0
  buffer_load_dwordx4 v235, s[28:31], s59 offen  lds
  s_waitcnt vmcnt(24)
  s_barrier
  s_add_u32 m0, s60, 49152
  s_nop 0
  buffer_load_dwordx4 v1, s[8:11], s54 offen offset:0 sc1 lds
  s_add_u32 s7, s7, 2
  s_cmp_ge_u32 s7, 50
  s_cselect_b32 s3, 393216, 0
  s_cselect_b32 s4, 50, 0
  s_sub_u32 s7, s7, s4
  s_add_u32 s59, s59, s3
  s_add_u32 s59, s59, 131072
  s_cmp_ge_u32 s59, s66
  s_cselect_b32 s3, 3670016, 0
  s_sub_u32 s59, s59, s3
  buffer_load_dwordx4 v1, s[8:11], s54 offen offset:1024 sc1 lds
  buffer_load_dwordx4 v1, s[8:11], s54 offen offset:2048 sc1 lds
  s_nop 0
  buffer_load_dwordx4 v1, s[8:11], s54 offen offset:3072 sc1 lds
  s_add_u32 m0, s67, 131072
  s_nop 0
  buffer_load_dwordx4 v232, s[28:31], s59 offen  lds
  s_add_u32 s56, s56, 2
  s_cmp_ge_u32 s56, 50
  s_cselect_b32 s3, 49152, 0
  s_cselect_b32 s4, 50, 0
  s_sub_u32 s56, s56, s4
  s_add_u32 s54, s54, s3
  s_add_u32 s54, s54, 16384
  s_cmp_ge_u32 s54, s55
  s_cselect_b32 s3, 458752, 0
  s_sub_u32 s54, s54, s3
  s_add_u32 m0, s67, 132096
  s_nop 0
  buffer_load_dwordx4 v233, s[28:31], s59 offen  lds
  s_add_u32 m0, s67, 133120
  s_nop 0
  buffer_load_dwordx4 v234, s[28:31], s59 offen  lds
  s_add_u32 m0, s67, 134144
  s_nop 0
  buffer_load_dwordx4 v235, s[28:31], s59 offen  lds
  s_waitcnt vmcnt(24)
  s_barrier
  s_add_u32 m0, s60, 65536
  s_nop 0
  buffer_load_dwordx4 v1, s[8:11], s54 offen offset:0 sc1 lds
  s_add_u32 s7, s7, 2
  s_cmp_ge_u32 s7, 50
  s_cselect_b32 s3, 393216, 0
  s_cselect_b32 s4, 50, 0
  s_sub_u32 s7, s7, s4
  s_add_u32 s59, s59, s3
  s_add_u32 s59, s59, 131072
  s_cmp_ge_u32 s59, s66
  s_cselect_b32 s3, 3670016, 0
  s_sub_u32 s59, s59, s3
  buffer_load_dwordx4 v1, s[8:11], s54 offen offset:1024 sc1 lds
  buffer_load_dwordx4 v1, s[8:11], s54 offen offset:2048 sc1 lds
  buffer_load_dwordx4 v1, s[8:11], s54 offen offset:3072 sc1 lds
  s_add_u32 m0, s67, 147456
  s_nop 0
  buffer_load_dwordx4 v232, s[28:31], s59 offen  lds
  s_add_u32 s56, s56, 2
  s_cmp_ge_u32 s56, 50
  s_cselect_b32 s3, 49152, 0
  s_cselect_b32 s4, 50, 0
  s_sub_u32 s56, s56, s4
  s_add_u32 s54, s54, s3
  s_add_u32 s54, s54, 16384
  s_cmp_ge_u32 s54, s55
  s_cselect_b32 s3, 458752, 0
  s_sub_u32 s54, s54, s3
  s_nop 0
  s_add_u32 m0, s67, 148480
  s_nop 0
  buffer_load_dwordx4 v233, s[28:31], s59 offen  lds
  s_add_u32 m0, s67, 149504
  s_nop 0
  buffer_load_dwordx4 v234, s[28:31], s59 offen  lds
  s_add_u32 m0, s67, 150528
  s_nop 0
  buffer_load_dwordx4 v235, s[28:31], s59 offen  lds
  s_waitcnt vmcnt(24)
  s_barrier
  s_add_u32 m0, s60, 0
  s_nop 0
  buffer_load_dwordx4 v1, s[8:11], s54 offen offset:0 sc1 lds
  s_add_u32 s7, s7, 2
  s_cmp_ge_u32 s7, 50
  s_cselect_b32 s3, 393216, 0
  s_cselect_b32 s4, 50, 0
  s_sub_u32 s7, s7, s4
  s_add_u32 s59, s59, s3
  s_add_u32 s59, s59, 131072
  s_cmp_ge_u32 s59, s66
  s_nop 0
  s_cselect_b32 s3, 3670016, 0
  s_sub_u32 s59, s59, s3
  buffer_load_dwordx4 v1, s[8:11], s54 offen offset:1024 sc1 lds
  buffer_load_dwordx4 v1, s[8:11], s54 offen offset:2048 sc1 lds
  buffer_load_dwordx4 v1, s[8:11], s54 offen offset:3072 sc1 lds
  s_add_u32 m0, s67, 81920
  s_nop 0
  buffer_load_dwordx4 v232, s[28:31], s59 offen  lds
  s_add_u32 s56, s56, 2
  s_cmp_ge_u32 s56, 50
  s_cselect_b32 s3, 49152, 0
  s_cselect_b32 s4, 50, 0
  s_sub_u32 s56, s56, s4
  s_add_u32 s54, s54, s3
  s_add_u32 s54, s54, 16384
  s_cmp_ge_u32 s54, s55
  s_cselect_b32 s3, 458752, 0
  s_sub_u32 s54, s54, s3
  s_add_u32 m0, s67, 82944
  s_nop 0
  buffer_load_dwordx4 v233, s[28:31], s59 offen  lds
  s_add_u32 m0, s67, 83968
  s_nop 0
  buffer_load_dwordx4 v234, s[28:31], s59 offen  lds
  s_add_u32 m0, s67, 84992
  s_nop 0
  buffer_load_dwordx4 v235, s[28:31], s59 offen  lds
  s_waitcnt vmcnt(24)
  s_barrier
  s_add_u32 m0, s60, 16384
  s_nop 0
  s_nop 0
  buffer_load_dwordx4 v1, s[8:11], s54 offen offset:0 sc1 lds
  s_add_u32 s7, s7, 2
  s_cmp_ge_u32 s7, 50
  s_cselect_b32 s3, 393216, 0
  s_cselect_b32 s4, 50, 0
  s_sub_u32 s7, s7, s4
  s_add_u32 s59, s59, s3
  s_add_u32 s59, s59, 131072
  s_cmp_ge_u32 s59, s66
  s_cselect_b32 s3, 3670016, 0
  s_sub_u32 s59, s59, s3
  s_nop 0
  buffer_load_dwordx4 v1, s[8:11], s54 offen offset:1024 sc1 lds
  buffer_load_dwordx4 v1, s[8:11], s54 offen offset:2048 sc1 lds
  buffer_load_dwordx4 v1, s[8:11], s54 offen offset:3072 sc1 lds
  s_add_u32 m0, s67, 98304
  s_nop 0
  buffer_load_dwordx4 v232, s[28:31], s59 offen  lds
  s_add_u32 s56, s56, 2
  s_cmp_ge_u32 s56, 50
  s_cselect_b32 s3, 49152, 0
  s_cselect_b32 s4, 50, 0
  s_sub_u32 s56, s56, s4
  s_add_u32 s54, s54, s3
  s_add_u32 s54, s54, 16384
  s_cmp_ge_u32 s54, s55
  s_cselect_b32 s3, 458752, 0
  s_sub_u32 s54, s54, s3
  s_add_u32 m0, s67, 99328
  s_nop 0
  buffer_load_dwordx4 v233, s[28:31], s59 offen  lds
  s_add_u32 m0, s67, 100352
  s_nop 0
  buffer_load_dwordx4 v234, s[28:31], s59 offen  lds
  s_add_u32 m0, s67, 101376
  s_nop 0
  buffer_load_dwordx4 v235, s[28:31], s59 offen  lds
  s_waitcnt vmcnt(24)
  s_barrier
  s_add_u32 m0, s60, 32768
  s_nop 0
  buffer_load_dwordx4 v1, s[8:11], s54 offen offset:0 sc1 lds
  s_add_u32 s7, s7, 2
  s_cmp_ge_u32 s7, 50
  s_cselect_b32 s3, 393216, 0
  s_cselect_b32 s4, 50, 0
  s_sub_u32 s7, s7, s4
  s_add_u32 s59, s59, s3
  s_add_u32 s59, s59, 131072
  s_cmp_ge_u32 s59, s66
  s_cselect_b32 s3, 3670016, 0
  s_sub_u32 s59, s59, s3
  buffer_load_dwordx4 v1, s[8:11], s54 offen offset:1024 sc1 lds
  buffer_load_dwordx4 v1, s[8:11], s54 offen offset:2048 sc1 lds
  s_nop 0
  buffer_load_dwordx4 v1, s[8:11], s54 offen offset:3072 sc1 lds
  s_add_u32 m0, s67, 114688
  s_nop 0
  buffer_load_dwordx4 v232, s[28:31], s59 offen  lds
  s_add_u32 s56, s56, 2
  s_cmp_ge_u32 s56, 50
  s_cselect_b32 s3, 49152, 0
  s_cselect_b32 s4, 50, 0
  s_sub_u32 s56, s56, s4
  s_add_u32 s54, s54, s3
  s_add_u32 s54, s54, 16384
  s_cmp_ge_u32 s54, s55
  s_cselect_b32 s3, 458752, 0
  s_sub_u32 s54, s54, s3
  s_add_u32 m0, s67, 115712
  s_nop 0
  buffer_load_dwordx4 v233, s[28:31], s59 offen  lds
  s_add_u32 m0, s67, 116736
  s_nop 0
  buffer_load_dwordx4 v234, s[28:31], s59 offen  lds
  s_add_u32 m0, s67, 117760
  s_nop 0
  buffer_load_dwordx4 v235, s[28:31], s59 offen  lds
  s_waitcnt vmcnt(24)
  s_barrier
  s_add_u32 m0, s60, 49152
  s_nop 0
  buffer_load_dwordx4 v1, s[8:11], s54 offen offset:0 sc1 lds
  s_add_u32 s7, s7, 2
  s_cmp_ge_u32 s7, 50
  s_cselect_b32 s3, 393216, 0
  s_cselect_b32 s4, 50, 0
  s_sub_u32 s7, s7, s4
  s_add_u32 s59, s59, s3
  s_add_u32 s59, s59, 131072
  s_cmp_ge_u32 s59, s66
  s_cselect_b32 s3, 3670016, 0
  s_sub_u32 s59, s59, s3
  buffer_load_dwordx4 v1, s[8:11], s54 offen offset:1024 sc1 lds
  buffer_load_dwordx4 v1, s[8:11], s54 offen offset:2048 sc1 lds
  buffer_load_dwordx4 v1, s[8:11], s54 offen offset:3072 sc1 lds
  s_add_u32 m0, s67, 131072
  s_nop 0
  buffer_load_dwordx4 v232, s[28:31], s59 offen  lds
  s_add_u32 s56, s56, 2
  s_cmp_ge_u32 s56, 50
  s_cselect_b32 s3, 49152, 0
  s_cselect_b32 s4, 50, 0
  s_sub_u32 s56, s56, s4
  s_add_u32 s54, s54, s3
  s_add_u32 s54, s54, 16384
  s_cmp_ge_u32 s54, s55
  s_cselect_b32 s3, 458752, 0
  s_sub_u32 s54, s54, s3
  s_nop 0
  s_add_u32 m0, s67, 132096
  s_nop 0
  buffer_load_dwordx4 v233, s[28:31], s59 offen  lds
  s_add_u32 m0, s67, 133120
  s_nop 0
  buffer_load_dwordx4 v234, s[28:31], s59 offen  lds
  s_add_u32 m0, s67, 134144
  s_nop 0
  buffer_load_dwordx4 v235, s[28:31], s59 offen  lds
  s_waitcnt vmcnt(24)
  s_barrier
  s_add_u32 m0, s60, 65536
  s_nop 0
  buffer_load_dwordx4 v1, s[8:11], s54 offen offset:0 sc1 lds
  s_add_u32 s7, s7, 2
  s_cmp_ge_u32 s7, 50
  s_cselect_b32 s3, 393216, 0
  s_cselect_b32 s4, 50, 0
  s_sub_u32 s7, s7, s4
  s_add_u32 s59, s59, s3
  s_add_u32 s59, s59, 131072
  s_cmp_ge_u32 s59, s66
  s_cselect_b32 s3, 3670016, 0
  s_sub_u32 s59, s59, s3
  buffer_load_dwordx4 v1, s[8:11], s54 offen offset:1024 sc1 lds
  buffer_load_dwordx4 v1, s[8:11], s54 offen offset:2048 sc1 lds
  buffer_load_dwordx4 v1, s[8:11], s54 offen offset:3072 sc1 lds
  s_add_u32 m0, s67, 147456
  s_nop 0
  buffer_load_dwordx4 v232, s[28:31], s59 offen  lds
  s_add_u32 s56, s56, 2
  s_cmp_ge_u32 s56, 50
  s_cselect_b32 s3, 49152, 0
  s_cselect_b32 s4, 50, 0
  s_sub_u32 s56, s56, s4
  s_add_u32 s54, s54, s3
  s_add_u32 s54, s54, 16384
  s_cmp_ge_u32 s54, s55
  s_cselect_b32 s3, 458752, 0
  s_sub_u32 s54, s54, s3
  s_add_u32 m0, s67, 148480
  s_nop 0
  buffer_load_dwordx4 v233, s[28:31], s59 offen  lds
  s_add_u32 m0, s67, 149504
  s_nop 0
  buffer_load_dwordx4 v234, s[28:31], s59 offen  lds
  s_add_u32 m0, s67, 150528
  s_nop 0
  buffer_load_dwordx4 v235, s[28:31], s59 offen  lds
  s_waitcnt vmcnt(24)
  s_barrier
  s_add_u32 m0, s60, 0
  s_nop 0
  buffer_load_dwordx4 v1, s[8:11], s54 offen offset:0 sc1 lds
  s_add_u32 s7, s7, 2
  s_cmp_ge_u32 s7, 50
  s_cselect_b32 s3, 393216, 0
  s_cselect_b32 s4, 50, 0
  s_sub_u32 s7, s7, s4
  s_add_u32 s59, s59, s3
  s_add_u32 s59, s59, 131072
  s_cmp_ge_u32 s59, s66
  s_cselect_b32 s3, 3670016, 0
  s_sub_u32 s59, s59, s3
  buffer_load_dwordx4 v1, s[8:11], s54 offen offset:1024 sc1 lds
  s_nop 0
  buffer_load_dwordx4 v1, s[8:11], s54 offen offset:2048 sc1 lds
  buffer_load_dwordx4 v1, s[8:11], s54 offen offset:3072 sc1 lds
  s_add_u32 m0, s67, 81920
  s_nop 0
  buffer_load_dwordx4 v232, s[28:31], s59 offen  lds
  s_add_u32 s56, s56, 2
  s_cmp_ge_u32 s56, 50
  s_cselect_b32 s3, 49152, 0
  s_cselect_b32 s4, 50, 0
  s_sub_u32 s56, s56, s4
  s_add_u32 s54, s54, s3
  s_add_u32 s54, s54, 16384
  s_cmp_ge_u32 s54, s55
  s_cselect_b32 s3, 458752, 0
  s_sub_u32 s54, s54, s3
  s_add_u32 m0, s67, 82944
  s_nop 0
  buffer_load_dwordx4 v233, s[28:31], s59 offen  lds
  s_add_u32 m0, s67, 83968
  s_nop 0
  buffer_load_dwordx4 v234, s[28:31], s59 offen  lds
  s_add_u32 m0, s67, 84992
  s_nop 0
  buffer_load_dwordx4 v235, s[28:31], s59 offen  lds
  s_waitcnt vmcnt(24)
  s_barrier
  s_add_u32 m0, s60, 16384
  s_nop 0
  buffer_load_dwordx4 v1, s[8:11], s54 offen offset:0 sc1 lds
  s_add_u32 s7, s7, 2
  s_cmp_ge_u32 s7, 50
  s_cselect_b32 s3, 393216, 0
  s_cselect_b32 s4, 50, 0
  s_sub_u32 s7, s7, s4
  s_add_u32 s59, s59, s3
  s_add_u32 s59, s59, 131072
  s_cmp_ge_u32 s59, s66
  s_cselect_b32 s3, 3670016, 0
  s_sub_u32 s59, s59, s3
  buffer_load_dwordx4 v1, s[8:11], s54 offen offset:1024 sc1 lds
  buffer_load_dwordx4 v1, s[8:11], s54 offen offset:2048 sc1 lds
  buffer_load_dwordx4 v1, s[8:11], s54 offen offset:3072 sc1 lds
  s_nop 0
  s_add_u32 m0, s67, 98304
  s_nop 0
  buffer_load_dwordx4 v232, s[28:31], s59 offen  lds
  s_add_u32 s56, s56, 2
  s_cmp_ge_u32 s56, 50
  s_cselect_b32 s3, 49152, 0
  s_cselect_b32 s4, 50, 0
  s_sub_u32 s56, s56, s4
  s_add_u32 s54, s54, s3
  s_add_u32 s54, s54, 16384
  s_cmp_ge_u32 s54, s55
  s_nop 0
  s_cselect_b32 s3, 458752, 0
  s_sub_u32 s54, s54, s3
  s_add_u32 m0, s67, 99328
  s_nop 0
  buffer_load_dwordx4 v233, s[28:31], s59 offen  lds
  s_add_u32 m0, s67, 100352
  s_nop 0
  buffer_load_dwordx4 v234, s[28:31], s59 offen  lds
  s_add_u32 m0, s67, 101376
  s_nop 0
  buffer_load_dwordx4 v235, s[28:31], s59 offen  lds
  s_waitcnt vmcnt(24)
  s_barrier
  s_add_u32 m0, s60, 32768
  s_nop 0
  buffer_load_dwordx4 v1, s[8:11], s54 offen offset:0 sc1 lds
  s_add_u32 s7, s7, 2
  s_cmp_ge_u32 s7, 50
  s_cselect_b32 s3, 393216, 0
  s_cselect_b32 s4, 50, 0
  s_sub_u32 s7, s7, s4
  s_add_u32 s59, s59, s3
  s_add_u32 s59, s59, 131072
  s_cmp_ge_u32 s59, s66
  s_cselect_b32 s3, 3670016, 0
  s_sub_u32 s59, s59, s3
  buffer_load_dwordx4 v1, s[8:11], s54 offen offset:1024 sc1 lds
  buffer_load_dwordx4 v1, s[8:11], s54 offen offset:2048 sc1 lds
  buffer_load_dwordx4 v1, s[8:11], s54 offen offset:3072 sc1 lds
  s_add_u32 m0, s67, 114688
  s_nop 0
  s_nop 0
  buffer_load_dwordx4 v232, s[28:31], s59 offen  lds
  s_add_u32 m0, s67, 115712
  s_nop 0
  buffer_load_dwordx4 v233, s[28:31], s59 offen  lds
  s_add_u32 m0, s67, 116736
  s_nop 0
  buffer_load_dwordx4 v234, s[28:31], s59 offen  lds
  s_add_u32 m0, s67, 117760
  s_nop 0
  s_nop 0
  buffer_load_dwordx4 v235, s[28:31], s59 offen  lds
  s_getpc_b64 s[4:5]
Lpc_1033:
  s_sub_u32 s4, s4, Lpc_1033-sequential_preLN__sliding_block__dense_activation_gelu__prompt_kernel
  s_subb_u32 s5, s5, 0
  s_lshr_b32 s3, s2, 3
  s_lshl_b32 s3, s3, 2
  s_add_u32 s3, s3, s51
  s_mul_i32 s3, s3, 6
  v_add_u32 v12, s3, v0
  v_lshlrev_b32_e64 v12, 7, v12
  v_min_u32 v12, Lend-sequential_preLN__sliding_block__dense_activation_gelu__prompt_kernel-4, v12
  s_mov_b64 exec, 0x3f
  global_load_dword v13, v12, s[4:5]
  s_mov_b64 exec, -1
  s_waitcnt vmcnt(25)
  s_barrier
  s_waitcnt vmcnt(17)
  s_barrier
  s_waitcnt vmcnt(9)
  s_barrier
  s_waitcnt vmcnt(1)
  s_barrier
  s_endpgm
Lsslow_1015:
  s_waitcnt lgkmcnt(15)
  v_mfma_f32_16x16x32_bf16 v[100:103], v[28:31], v[8:11], v[16:19]
  s_nop 0
  v_mfma_f32_16x16x32_bf16 v[104:107], v[32:35], v[8:11], v[238:241]
  v_mfma_f32_16x16x32_bf16 v[170:173], v[32:35], v[12:15], v[16:19]
  s_cmp_lg_u32 s7, 2
  s_cbranch_scc1 Lcz_1035
  s_nop 3
  v_mov_b32 v238, 0
  v_mov_b32 v239, 0
  v_mov_b32 v240, 0
  v_mov_b32_e64 v241, 0
  s_nop 0
Lcz_1035:
  s_waitcnt lgkmcnt(14)
  v_mfma_f32_16x16x32_bf16 v[108:111], v[36:39], v[8:11], v[238:241]
  v_mfma_f32_16x16x32_bf16 v[174:177], v[36:39], v[12:15], v[238:241]
  v_mfma_f32_16x16x32_bf16 v[112:115], v[40:43], v[8:11], v[238:241]
  s_nop 2
  v_max_f32 v2, v100, v101
  v_max_f32 v3, v102, v103
  v_mfma_f32_16x16x32_bf16 v[178:181], v[40:43], v[12:15], v[238:241]
  s_cmp_lg_u32 s7, 4
  s_cbranch_scc1 Lcz_1036
  s_nop 3
  v_mov_b32 v238, 0
  v_mov_b32 v239, 0
  v_mov_b32 v240, 0
  v_mov_b32 v241, 0
  s_nop 0
Lcz_1036:
  s_waitcnt lgkmcnt(12)
  v_mfma_f32_16x16x32_bf16 v[116:119], v[44:47], v[8:11], v[238:241]
  v_max3_f32 v2, v2, v104, v105
  v_max3_f32 v3, v3, v106, v107
  v_mfma_f32_16x16x32_bf16 v[182:185], v[44:47], v[12:15], v[238:241]
  v_max_f32 v6, v170, v171
  v_max_f32 v7, v172, v173
  v_mfma_f32_16x16x32_bf16 v[120:123], v[48:51], v[8:11], v[238:241]
  v_max3_f32 v2, v2, v108, v109
  v_max3_f32 v3, v3, v110, v111
  v_mfma_f32_16x16x32_bf16 v[186:189], v[48:51], v[12:15], v[238:241]
  v_max3_f32 v6, v6, v174, v175
  v_max3_f32 v7, v7, v176, v177
  s_cmp_lg_u32 s7, 6
  s_cbranch_scc1 Lcz_1037
  s_nop 3
  v_mov_b32 v238, 0
  v_mov_b32 v239, 0
  v_mov_b32 v240, 0
  v_mov_b32 v241, 0
  s_nop 0
Lcz_1037:
  s_waitcnt lgkmcnt(10)
  v_mfma_f32_16x16x32_bf16 v[124:127], v[52:55], v[8:11], v[238:241]
  v_max3_f32 v2, v2, v112, v113
  v_max3_f32 v3, v3, v114, v115
  v_mfma_f32_16x16x32_bf16 v[190:193], v[52:55], v[12:15], v[238:241]
  v_max3_f32 v6, v6, v178, v179
  v_max3_f32 v7, v7, v180, v181
  v_mfma_f32_16x16x32_bf16 v[128:131], v[56:59], v[8:11], v[238:241]
  s_nop 0
  v_max3_f32 v2, v2, v116, v117
  v_max3_f32 v3, v3, v118, v119
  v_mfma_f32_16x16x32_bf16 v[194:197], v[56:59], v[12:15], v[238:241]
  v_max3_f32 v6, v6, v182, v183
  v_max3_f32 v7, v7, v184, v185
  s_cmp_lg_u32 s7, 8
  s_cbranch_scc1 Lcz_1038
  s_nop 3
  v_mov_b32 v238, 0
  v_mov_b32 v239, 0
  v_mov_b32 v240, 0
  v_mov_b32_e64 v241, 0
  s_nop 0
Lcz_1038:
  s_waitcnt vmcnt(0)
  s_barrier
  s_waitcnt lgkmcnt(8)
  v_mfma_f32_16x16x32_bf16 v[132:135], v[60:63], v[8:11], v[238:241]
  v_max3_f32 v2, v2, v120, v121
  v_max3_f32 v3, v3, v122, v123
  v_mfma_f32_16x16x32_bf16 v[198:201], v[60:63], v[12:15], v[238:241]
  v_max3_f32 v6, v6, v186, v187
  v_max3_f32 v7, v7, v188, v189
  v_mfma_f32_16x16x32_bf16 v[136:139], v[64:67], v[8:11], v[238:241]
  v_max3_f32 v2, v2, v124, v125
  v_max3_f32 v3, v3, v126, v127
  v_mfma_f32_16x16x32_bf16 v[202:205], v[64:67], v[12:15], v[238:241]
  v_max3_f32 v6, v6, v190, v191
  v_max3_f32 v7, v7, v192, v193
  s_cmp_lg_u32 s7, 10
  s_cbranch_scc1 Lcz_1039
  s_nop 3
  v_mov_b32 v238, 0
  v_mov_b32 v239, 0
  v_mov_b32 v240, 0
  v_mov_b32_e64 v241, 0
  s_nop 0
Lcz_1039:
  s_waitcnt lgkmcnt(6)
  v_mfma_f32_16x16x32_bf16 v[140:143], v[68:71], v[8:11], v[238:241]
  v_max3_f32 v2, v2, v128, v129
  v_max3_f32 v3, v3, v130, v131
  v_mfma_f32_16x16x32_bf16 v[206:209], v[68:71], v[12:15], v[238:241]
  v_max3_f32 v6, v6, v194, v195
  v_max3_f32 v7, v7, v196, v197
  v_mfma_f32_16x16x32_bf16 v[144:147], v[72:75], v[8:11], v[238:241]
  v_max3_f32 v2, v2, v132, v133
  v_max3_f32 v3, v3, v134, v135
  v_mfma_f32_16x16x32_bf16 v[210:213], v[72:75], v[12:15], v[238:241]
  v_max3_f32 v6, v6, v198, v199
  v_max3_f32 v7, v7, v200, v201
  s_cmp_lg_u32 s7, 12
  s_cbranch_scc1 Lcz_1040
  s_nop 3
  v_mov_b32 v238, 0
  v_mov_b32 v239, 0
  v_mov_b32 v240, 0
  v_mov_b32_e64 v241, 0
  s_nop 0
Lcz_1040:
  s_waitcnt lgkmcnt(4)
  v_mfma_f32_16x16x32_bf16 v[148:151], v[76:79], v[8:11], v[238:241]
  v_max3_f32 v2, v2, v136, v137
  v_max3_f32 v3, v3, v138, v139
  v_mfma_f32_16x16x32_bf16 v[214:217], v[76:79], v[12:15], v[238:241]
  v_max3_f32 v6, v6, v202, v203
  v_max3_f32 v7, v7, v204, v205
  v_mfma_f32_16x16x32_bf16 v[152:155], v[80:83], v[8:11], v[238:241]
  v_max3_f32 v2, v2, v140, v141
  v_max3_f32 v3, v3, v142, v143
  v_mfma_f32_16x16x32_bf16 v[218:221], v[80:83], v[12:15], v[238:241]
  v_max3_f32 v6, v6, v206, v207
  v_max3_f32 v7, v7, v208, v209
  s_cmp_lg_u32 s7, 14
  s_cbranch_scc1 Lcz_1041
  s_nop 3
  v_mov_b32 v238, 0
  v_mov_b32 v239, 0
  v_mov_b32 v240, 0
  v_mov_b32_e64 v241, 0
  s_nop 0
Lcz_1041:
  s_waitcnt lgkmcnt(2)
  v_mfma_f32_16x16x32_bf16 v[156:159], v[84:87], v[8:11], v[238:241]
  v_max3_f32 v2, v2, v144, v145
  v_max3_f32 v3, v3, v146, v147
  v_mfma_f32_16x16x32_bf16 v[222:225], v[84:87], v[12:15], v[238:241]
  v_max3_f32 v6, v6, v210, v211
  v_max3_f32 v7, v7, v212, v213
  v_mfma_f32_16x16x32_bf16 v[160:163], v[88:91], v[8:11], v[238:241]
  v_max3_f32 v2, v2, v148, v149
  v_max3_f32 v3, v3, v150, v151
  v_mfma_f32_16x16x32_bf16 v[226:229], v[88:91], v[12:15], v[238:241]
  v_max3_f32 v6, v6, v214, v215
  v_max3_f32 v7, v7, v216, v217
  s_cmp_lg_u32 s7, 16
  s_cbranch_scc1 Lcz_1042
  s_nop 3
  v_mov_b32 v238, 0
  v_mov_b32 v239, 0
  v_mov_b32 v240, 0
  v_mov_b32_e64 v241, 0
  s_nop 0
Lcz_1042:
  s_waitcnt lgkmcnt(0)
  v_mfma_f32_16x16x32_bf16 v[164:167], v[92:95], v[8:11], v[20:23]
  v_max3_f32 v2, v2, v152, v153
  v_max3_f32 v3, v3, v154, v155
  v_mfma_f32_16x16x32_bf16 v[230:233], v[92:95], v[12:15], v[238:241]
  v_max3_f32 v6, v6, v218, v219
  v_max3_f32 v7, v7, v220, v221
  v_max3_f32 v2, v2, v156, v157
  v_max3_f32 v3, v3, v158, v159
  v_mfma_f32_16x16x32_bf16 v[234:237], v[96:99], v[12:15], v[20:23]
  v_max3_f32 v6, v6, v222, v223
  v_max3_f32 v7, v7, v224, v225
  ds_read_b128 v[28:31], v4 offset:0
  ds_read_b128 v[32:35], v4 offset:1024
  ds_read_b128 v[36:39], v4 offset:2048
  ds_read_b128 v[40:43], v4 offset:3072
  ds_read_b128 v[44:47], v4 offset:4096
  ds_read_b128 v[48:51], v4 offset:5120
  v_max3_f32 v2, v2, v160, v161
  v_max3_f32 v3, v3, v162, v163
  v_max3_f32 v6, v6, v226, v227
  v_max3_f32 v7, v7, v228, v229
  ds_read_b128 v[52:55], v4 offset:6144
  ds_read_b128 v[56:59], v4 offset:7168
  ds_read_b128 v[60:63], v4 offset:8192
  ds_read_b128 v[64:67], v4 offset:9216
  ds_read_b128 v[68:71], v4 offset:10240
  ds_read_b128 v[72:75], v4 offset:11264
  v_max3_f32 v2, v2, v164, v165
  v_max3_f32 v3, v3, v166, v167
  v_max3_f32 v6, v6, v230, v231
  v_max3_f32 v7, v7, v232, v233
  ds_read_b128 v[76:79], v4 offset:12288
  ds_read_b128 v[80:83], v4 offset:13312
  ds_read_b128 v[84:87], v4 offset:14336
  ds_read_b128 v[88:91], v4 offset:15360
  ds_read_b128 v[92:95], v4 offset:16384
  ds_read_b128 v[96:99], v4 offset:17408
  v_max3_f32 v6, v6, v234, v235
  v_max3_f32 v7, v7, v236, v237
  s_branch Lsdone_1016
Lcompute:
  s_waitcnt lgkmcnt(0)
  s_lshl_b32 s67, s48, 4
  s_add_u32 s67, s67, s49
  s_lshl_b32 s67, s67, 10
  s_cmp_lg_u32 s50, 0
  s_cbranch_scc1 Lz_2001
  v_mov_b32 v4, 0
  v_mov_b32 v5, 0
  v_mov_b32 v6, 0
  v_mov_b32 v7, 0
  s_add_u32 s3, s67, 67108864
  buffer_store_dwordx4 v[4:7], v1, s[8:11], s3 offen sc1
Lz_2001:
  s_cmp_lg_u32 s50, 1
  s_cbranch_scc1 Lz_2002
  s_getpc_b64 s[4:5]
Lpc:
  s_sub_u32 s4, s4, Lpc-sequential_preLN__sliding_block__dense_activation_gelu__prompt_kernel
  s_subb_u32 s5, s5, 0
  s_lshr_b32 s3, s2, 3
  s_mul_i32 s3, s3, 24
  v_add_u32 v3, s3, v0
  v_lshlrev_b32 v3, 7, v3
  s_mov_b32 s3, Lend-sequential_preLN__sliding_block__dense_activation_gelu__prompt_kernel
  v_cmp_gt_u32 vcc, s3, v3
  s_nop 1
  s_and_b32 s6, vcc_lo, 0xffffff
  s_mov_b32 s7, 0
  s_mov_b64 exec, s[6:7]
  s_cbranch_execz Lpfskip
  global_load_dword v255, v3, s[4:5]
Lpfskip:
  s_mov_b64 exec, -1
Lz_2002:
  s_cmp_lg_u32 s50, 2
  s_cbranch_scc1 Ltlb_2003
  s_lshr_b32 s3, s2, 3
  s_lshl_b32 s4, s3, 21
  s_add_u32 s4, s4, 8388608
  s_lshl_b32 s3, s3, 20
  s_mov_b64 exec, 1
  buffer_load_dword v254, off, s[8:11], s4
  buffer_load_dword v254, off, s[24:27], s3
  buffer_load_dword v254, off, s[28:31], s3
  s_nop 0
  buffer_load_dword v254, off, s[20:23], s3
  buffer_load_dword v254, off, s[40:43], s3
  buffer_load_dword v254, off, s[32:35], s3
  buffer_load_dword v254, off, s[36:39], s3
  s_mov_b64 exec, -1
Ltlb_2003:
  s_cmp_lg_u32 s50, 3
  s_cbranch_scc1 Lt3_2004
  v_mul_u32_u24 v3, 10923, v0
  v_lshrrev_b32 v3, 16, v3
  v_mul_u32_u24 v4, 6, v3
  v_sub_u32 v4, v0, v4
  v_mul_u32_u24 v3, 6144, v3
  v_lshl_add_u32 v3, v4, 10, v3
  s_mul_i32 s3, s2, 24576
  s_add_u32 s3, s3, 384
  s_mov_b64 exec, 0xffffff
  buffer_load_dword v254, v3, s[16:19], s3 offen
  s_mov_b64 exec, -1
Lt3_2004:
  v_lshrrev_b32 v3, 4, v0
  v_bfe_u32 v4, v0, 2, 2
  v_and_b32 v5, 1, v3
  v_lshl_add_u32 v5, v5, 2, v4
  v_lshrrev_b32 v6, 1, v3
  v_lshlrev_b32 v6, 10, v6
  v_lshl_add_u32 v6, v5, 7, v6
  v_bfe_u32 v7, v0, 1, 1
  v_lshl_add_u32 v6, v7, 4, v6
  v_and_b32 v7, 1, v0
  v_lshl_add_u32 v6, v7, 3, v6
  v_add_u32 v6, 40960, v6
  v_and_b32 v5, 6, v5
  s_lshl_b32 s63, s53, 1
  s_add_u32 s63, s63, 0
  s_mov_b32 s4, s63
  s_lshr_b32 s5, s4, 2
  s_lshl_b32 s5, s5, 11
  s_and_b32 s6, s4, 3
  s_lshl_b32 s6, s6, 1
  v_xor_b32 v7, s6, v5
  v_lshl_add_u32 v194, v7, 4, v6
  v_add_u32 v194, s5, v194
  v_add_u32 v232, 49152, v194
  s_lshl_b32 s63, s53, 1
  s_add_u32 s63, s63, 1
  s_mov_b32 s4, s63
  s_lshr_b32 s5, s4, 2
  s_lshl_b32 s5, s5, 11
  s_and_b32 s6, s4, 3
  s_lshl_b32 s6, s6, 1
  v_xor_b32 v7, s6, v5
  v_lshl_add_u32 v195, v7, 4, v6
  v_add_u32 v195, s5, v195
  v_add_u32 v233, 49152, v195
  s_lshl_b32 s63, s53, 1
  s_add_u32 s63, s63, 4
  s_mov_b32 s4, s63
  s_lshr_b32 s5, s4, 2
  s_lshl_b32 s5, s5, 11
  s_and_b32 s6, s4, 3
  s_lshl_b32 s6, s6, 1
  v_xor_b32 v7, s6, v5
  v_lshl_add_u32 v196, v7, 4, v6
  v_add_u32 v196, s5, v196
  v_add_u32 v234, 49152, v196
  s_lshl_b32 s63, s53, 1
  s_add_u32 s63, s63, 5
  s_mov_b32 s4, s63
  s_lshr_b32 s5, s4, 2
  s_lshl_b32 s5, s5, 11
  s_and_b32 s6, s4, 3
  s_lshl_b32 s6, s6, 1
  v_xor_b32 v7, s6, v5
  v_lshl_add_u32 v197, v7, 4, v6
  v_add_u32 v197, s5, v197
  v_add_u32 v235, 49152, v197
  s_lshl_b32 s63, s53, 1
  s_add_u32 s63, s63, 8
  s_mov_b32 s4, s63
  s_lshr_b32 s5, s4, 2
  s_lshl_b32 s5, s5, 11
  s_and_b32 s6, s4, 3
  s_lshl_b32 s6, s6, 1
  v_xor_b32 v7, s6, v5
  v_lshl_add_u32 v198, v7, 4, v6
  v_add_u32 v198, s5, v198
  v_add_u32 v236, 49152, v198
  s_lshl_b32 s63, s53, 1
  s_add_u32 s63, s63, 9
  s_mov_b32 s4, s63
  s_lshr_b32 s5, s4, 2
  s_lshl_b32 s5, s5, 11
  s_and_b32 s6, s4, 3
  s_lshl_b32 s6, s6, 1
  v_xor_b32 v7, s6, v5
  v_lshl_add_u32 v199, v7, 4, v6
  v_add_u32 v199, s5, v199
  v_add_u32 v237, 49152, v199
  s_lshl_b32 s63, s52, 2
  v_and_b32 v3, 15, v0
  v_lshrrev_b32 v4, 4, v0
  v_lshrrev_b32 v7, 1, v3
  v_xor_b32 v4, v4, v7
  v_lshlrev_b32 v4, 4, v4
  v_lshl_add_u32 v4, v3, 7, v4
  s_lshl_b32 s3, s63, 11
  s_add_u32 s3, s3, 114688
  v_add_u32 v192, s3, v4
  v_xor_b32 v193, 64, v192
  v_and_b32 v3, 15, v0
  v_lshrrev_b32 v4, 4, v0
  s_lshl_b32 s3, s52, 8
  s_add_u32 s3, s3, 0
  v_lshl_add_u32 v228, v3, 2, s3
  v_lshl_add_u32 v229, v4, 4, s3
  s_lshl_b32 s3, s53, 7
  s_add_u32 s3, s3, 1024
  v_lshl_add_u32 v230, v4, 4, s3
  v_lshl_add_u32 v231, v3, 2, s3
  s_waitcnt vmcnt(0)
  s_cmp_eq_u32 s50, 0
  s_cselect_b32 s62, 1, -1
  v_mov_b32 v2, 1
  s_and_b32 s61, s2, 1
  s_lshl_b32 s61, s61, 7
  s_lshl_b32 s3, s49, 1
  s_add_u32 s3, s3, s53
  s_lshl_b32 s3, s3, 7
  s_lshl_b32 s4, s48, 3
  s_add_u32 s3, s3, s4
  s_lshl_b32 s4, s52, 2
  s_add_u32 s3, s3, s4
  s_lshl_b32 s3, s3, 10
  s_add_u32 s5, s3, 8388608
  s_add_u32 s6, s3, 12582912
  s_mul_i32 s3, s53, 24576
  s_lshl_b32 s4, s52, 12
  s_add_u32 s3, s3, s4
  s_add_u32 s3, s3, 65536
  v_add_u32 v3, s3, v1
  s_lshl_b32 s3, s53, 13
  s_add_u32 s3, s3, s4
  s_add_u32 s3, s3, 147456
  v_add_u32_e64 v10, s3, v1
  s_barrier
  s_mov_b32 s54, 0
  ds_read_b128 v[112:115], v192 offset:0
  ds_read_b64_tr_b16 v[128:129], v194 offset:0
  ds_read_b64_tr_b16 v[130:131], v194 offset:6144
  ds_read_b128 v[116:119], v192 offset:2048
  ds_read_b128 v[120:123], v192 offset:4096
  ds_read_b128 v[124:127], v192 offset:6144
  ds_read_b64_tr_b16 v[132:133], v195 offset:0
  ds_read_b64_tr_b16 v[134:135], v195 offset:6144
  ds_read_b64_tr_b16 v[136:137], v196 offset:0
  ds_read_b64_tr_b16 v[138:139], v196 offset:6144
  ds_read_b64_tr_b16 v[140:141], v197 offset:0
  ds_read_b64_tr_b16 v[142:143], v197 offset:6144
  ds_read_b64_tr_b16 v[144:145], v198 offset:0
  ds_read_b64_tr_b16 v[146:147], v198 offset:6144
  ds_read_b64_tr_b16 v[148:149], v199 offset:0
  ds_read_b64_tr_b16 v[150:151], v199 offset:6144
  s_waitcnt lgkmcnt(0)
  v_mfma_f32_16x16x32_bf16 v[16:19], v[128:131], v[112:115], 0
  s_nop 0
  ds_read_b128 v[152:155], v193 offset:0
  v_mfma_f32_16x16x32_bf16 v[20:23], v[128:131], v[116:119], 0
  ds_read_b64_tr_b16 v[168:169], v194 offset:12288
  v_mfma_f32_16x16x32_bf16 v[24:27], v[128:131], v[120:123], 0
  ds_read_b64_tr_b16 v[170:171], v194 offset:18432
  v_mfma_f32_16x16x32_bf16 v[28:31], v[128:131], v[124:127], 0
  ds_read_b128 v[156:159], v193 offset:2048
  v_mfma_f32_16x16x32_bf16 v[44:47], v[132:135], v[124:127], 0
  ds_read_b128 v[160:163], v193 offset:4096
  v_mfma_f32_16x16x32_bf16 v[40:43], v[132:135], v[120:123], 0
  ds_read_b128 v[164:167], v193 offset:6144
  v_mfma_f32_16x16x32_bf16 v[36:39], v[132:135], v[116:119], 0
  ds_read_b64_tr_b16 v[172:173], v195 offset:12288
  v_mfma_f32_16x16x32_bf16 v[32:35], v[132:135], v[112:115], 0
  ds_read_b64_tr_b16 v[174:175], v195 offset:18432
  v_mfma_f32_16x16x32_bf16 v[48:51], v[136:139], v[112:115], 0
  ds_read_b64_tr_b16 v[176:177], v196 offset:12288
  v_mfma_f32_16x16x32_bf16 v[52:55], v[136:139], v[116:119], 0
  ds_read_b64_tr_b16 v[178:179], v196 offset:18432
  v_mfma_f32_16x16x32_bf16 v[56:59], v[136:139], v[120:123], 0
  ds_read_b64_tr_b16 v[180:181], v197 offset:12288
  v_mfma_f32_16x16x32_bf16 v[60:63], v[136:139], v[124:127], 0
  ds_read_b64_tr_b16 v[182:183], v197 offset:18432
  v_mfma_f32_16x16x32_bf16 v[76:79], v[140:143], v[124:127], 0
  ds_read_b64_tr_b16 v[184:185], v198 offset:12288
  v_mfma_f32_16x16x32_bf16 v[72:75], v[140:143], v[120:123], 0
  ds_read_b64_tr_b16 v[186:187], v198 offset:18432
  v_mfma_f32_16x16x32_bf16 v[68:71], v[140:143], v[116:119], 0
  ds_read_b64_tr_b16 v[188:189], v199 offset:12288
  v_mfma_f32_16x16x32_bf16 v[64:67], v[140:143], v[112:115], 0
  ds_read_b64_tr_b16 v[190:191], v199 offset:18432
  v_mfma_f32_16x16x32_bf16 v[80:83], v[112:115], v[144:147], 0
  v_mfma_f32_16x16x32_bf16 v[84:87], v[116:119], v[144:147], 0
  v_mfma_f32_16x16x32_bf16 v[88:91], v[120:123], v[144:147], 0
  v_mfma_f32_16x16x32_bf16 v[92:95], v[124:127], v[144:147], 0
  v_mfma_f32_16x16x32_bf16 v[108:111], v[124:127], v[148:151], 0
  v_mfma_f32_16x16x32_bf16 v[104:107], v[120:123], v[148:151], 0
  v_mfma_f32_16x16x32_bf16 v[100:103], v[116:119], v[148:151], 0
  v_mfma_f32_16x16x32_bf16 v[96:99], v[112:115], v[148:151], 0
  s_waitcnt lgkmcnt(0)
.p2align 6
Lc_2005:
  s_barrier
  v_mfma_f32_16x16x32_bf16 v[16:19], v[168:171], v[152:155], v[16:19]
  ds_read_b128 v[112:115], v192 offset:16384
  v_mfma_f32_16x16x32_bf16 v[20:23], v[168:171], v[156:159], v[20:23]
  ds_read_b64_tr_b16 v[128:129], v194 offset:24576
  v_mfma_f32_16x16x32_bf16 v[24:27], v[168:171], v[160:163], v[24:27]
  ds_read_b64_tr_b16 v[130:131], v194 offset:30720
  v_mfma_f32_16x16x32_bf16 v[28:31], v[168:171], v[164:167], v[28:31]
  s_nop 0
  ds_read_b128 v[116:119], v192 offset:18432
  v_mfma_f32_16x16x32_bf16 v[44:47], v[172:175], v[164:167], v[44:47]
  ds_read_b128 v[120:123], v192 offset:20480
  v_mfma_f32_16x16x32_bf16 v[40:43], v[172:175], v[160:163], v[40:43]
  ds_read_b128 v[124:127], v192 offset:22528
  v_mfma_f32_16x16x32_bf16 v[36:39], v[172:175], v[156:159], v[36:39]
  ds_read_b64_tr_b16 v[132:133], v195 offset:24576
  v_mfma_f32_16x16x32_bf16 v[32:35], v[172:175], v[152:155], v[32:35]
  ds_read_b64_tr_b16 v[134:135], v195 offset:30720
  v_mfma_f32_16x16x32_bf16 v[48:51], v[176:179], v[152:155], v[48:51]
  ds_read_b64_tr_b16 v[136:137], v196 offset:24576
  v_mfma_f32_16x16x32_bf16 v[52:55], v[176:179], v[156:159], v[52:55]
  ds_read_b64_tr_b16 v[138:139], v196 offset:30720
  v_mfma_f32_16x16x32_bf16 v[56:59], v[176:179], v[160:163], v[56:59]
  ds_read_b64_tr_b16 v[140:141], v197 offset:24576
  v_mfma_f32_16x16x32_bf16 v[60:63], v[176:179], v[164:167], v[60:63]
  ds_read_b64_tr_b16 v[142:143], v197 offset:30720
  v_mfma_f32_16x16x32_bf16 v[76:79], v[180:183], v[164:167], v[76:79]
  ds_read_b64_tr_b16 v[144:145], v198 offset:24576
  v_mfma_f32_16x16x32_bf16 v[72:75], v[180:183], v[160:163], v[72:75]
  ds_read_b64_tr_b16 v[146:147], v198 offset:30720
  v_mfma_f32_16x16x32_bf16 v[68:71], v[180:183], v[156:159], v[68:71]
  ds_read_b64_tr_b16 v[148:149], v199 offset:24576
  v_mfma_f32_16x16x32_bf16 v[64:67], v[180:183], v[152:155], v[64:67]
  ds_read_b64_tr_b16 v[150:151], v199 offset:30720
  v_mfma_f32_16x16x32_bf16 v[80:83], v[152:155], v[184:187], v[80:83]
  v_mfma_f32_16x16x32_bf16 v[84:87], v[156:159], v[184:187], v[84:87]
  v_mfma_f32_16x16x32_bf16 v[88:91], v[160:163], v[184:187], v[88:91]
  v_mfma_f32_16x16x32_bf16 v[92:95], v[164:167], v[184:187], v[92:95]
  v_mfma_f32_16x16x32_bf16 v[108:111], v[164:167], v[188:191], v[108:111]
  v_mfma_f32_16x16x32_bf16 v[104:107], v[160:163], v[188:191], v[104:107]
  v_mfma_f32_16x16x32_bf16 v[100:103], v[156:159], v[188:191], v[100:103]
  v_mfma_f32_16x16x32_bf16 v[96:99], v[152:155], v[188:191], v[96:99]
  s_waitcnt lgkmcnt(0)
  v_mfma_f32_16x16x32_bf16 v[16:19], v[128:131], v[112:115], v[16:19]
  ds_read_b128 v[152:155], v193 offset:16384
  v_mfma_f32_16x16x32_bf16 v[20:23], v[128:131], v[116:119], v[20:23]
  ds_read_b64_tr_b16 v[168:169], v194 offset:36864
  v_mfma_f32_16x16x32_bf16 v[24:27], v[128:131], v[120:123], v[24:27]
  ds_read_b64_tr_b16 v[170:171], v194 offset:43008
  s_nop 0
  v_mfma_f32_16x16x32_bf16 v[28:31], v[128:131], v[124:127], v[28:31]
  ds_read_b128 v[156:159], v193 offset:18432
  v_mfma_f32_16x16x32_bf16 v[44:47], v[132:135], v[124:127], v[44:47]
  ds_read_b128 v[160:163], v193 offset:20480
  v_mfma_f32_16x16x32_bf16 v[40:43], v[132:135], v[120:123], v[40:43]
  ds_read_b128 v[164:167], v193 offset:22528
  v_mfma_f32_16x16x32_bf16 v[36:39], v[132:135], v[116:119], v[36:39]
  ds_read_b64_tr_b16 v[172:173], v195 offset:36864
  v_mfma_f32_16x16x32_bf16 v[32:35], v[132:135], v[112:115], v[32:35]
  ds_read_b64_tr_b16 v[174:175], v195 offset:43008
  v_mfma_f32_16x16x32_bf16 v[48:51], v[136:139], v[112:115], v[48:51]
  ds_read_b64_tr_b16 v[176:177], v196 offset:36864
  v_mfma_f32_16x16x32_bf16 v[52:55], v[136:139], v[116:119], v[52:55]
  ds_read_b64_tr_b16 v[178:179], v196 offset:43008
  v_mfma_f32_16x16x32_bf16 v[56:59], v[136:139], v[120:123], v[56:59]
  ds_read_b64_tr_b16 v[180:181], v197 offset:36864
  v_mfma_f32_16x16x32_bf16 v[60:63], v[136:139], v[124:127], v[60:63]
  ds_read_b64_tr_b16 v[182:183], v197 offset:43008
  v_mfma_f32_16x16x32_bf16 v[76:79], v[140:143], v[124:127], v[76:79]
  ds_read_b64_tr_b16 v[184:185], v198 offset:36864
  v_mfma_f32_16x16x32_bf16 v[72:75], v[140:143], v[120:123], v[72:75]
  ds_read_b64_tr_b16 v[186:187], v198 offset:43008
  v_mfma_f32_16x16x32_bf16 v[68:71], v[140:143], v[116:119], v[68:71]
  ds_read_b64_tr_b16 v[188:189], v199 offset:36864
  v_mfma_f32_16x16x32_bf16 v[64:67], v[140:143], v[112:115], v[64:67]
  ds_read_b64_tr_b16 v[190:191], v199 offset:43008
  v_mfma_f32_16x16x32_bf16 v[80:83], v[112:115], v[144:147], v[80:83]
  v_mfma_f32_16x16x32_bf16 v[84:87], v[116:119], v[144:147], v[84:87]
  v_mfma_f32_16x16x32_bf16 v[88:91], v[120:123], v[144:147], v[88:91]
  v_mfma_f32_16x16x32_bf16 v[92:95], v[124:127], v[144:147], v[92:95]
  v_mfma_f32_16x16x32_bf16 v[108:111], v[124:127], v[148:151], v[108:111]
  v_mfma_f32_16x16x32_bf16 v[104:107], v[120:123], v[148:151], v[104:107]
  v_mfma_f32_16x16x32_bf16 v[100:103], v[116:119], v[148:151], v[100:103]
  v_mfma_f32_16x16x32_bf16 v[96:99], v[112:115], v[148:151], v[96:99]
  s_waitcnt lgkmcnt(0)
  s_barrier
  v_mfma_f32_16x16x32_bf16 v[16:19], v[168:171], v[152:155], v[16:19]
  ds_read_b128 v[112:115], v192 offset:32768
  v_mfma_f32_16x16x32_bf16 v[20:23], v[168:171], v[156:159], v[20:23]
  ds_read_b64_tr_b16 v[128:129], v232 offset:0
  v_mfma_f32_16x16x32_bf16 v[24:27], v[168:171], v[160:163], v[24:27]
  ds_read_b64_tr_b16 v[130:131], v232 offset:6144
  v_mfma_f32_16x16x32_bf16 v[28:31], v[168:171], v[164:167], v[28:31]
  ds_read_b128 v[116:119], v192 offset:34816
  v_mfma_f32_16x16x32_bf16 v[44:47], v[172:175], v[164:167], v[44:47]
  ds_read_b128 v[120:123], v192 offset:36864
  v_mfma_f32_16x16x32_bf16 v[40:43], v[172:175], v[160:163], v[40:43]
  ds_read_b128 v[124:127], v192 offset:38912
  v_mfma_f32_16x16x32_bf16 v[36:39], v[172:175], v[156:159], v[36:39]
  ds_read_b64_tr_b16 v[132:133], v233 offset:0
  v_mfma_f32_16x16x32_bf16 v[32:35], v[172:175], v[152:155], v[32:35]
  ds_read_b64_tr_b16 v[134:135], v233 offset:6144
  v_mfma_f32_16x16x32_bf16 v[48:51], v[176:179], v[152:155], v[48:51]
  ds_read_b64_tr_b16 v[136:137], v234 offset:0
  v_mfma_f32_16x16x32_bf16 v[52:55], v[176:179], v[156:159], v[52:55]
  ds_read_b64_tr_b16 v[138:139], v234 offset:6144
  v_mfma_f32_16x16x32_bf16 v[56:59], v[176:179], v[160:163], v[56:59]
  ds_read_b64_tr_b16 v[140:141], v235 offset:0
  v_mfma_f32_16x16x32_bf16 v[60:63], v[176:179], v[164:167], v[60:63]
  ds_read_b64_tr_b16 v[142:143], v235 offset:6144
  v_mfma_f32_16x16x32_bf16 v[76:79], v[180:183], v[164:167], v[76:79]
  ds_read_b64_tr_b16 v[144:145], v236 offset:0
  v_mfma_f32_16x16x32_bf16 v[72:75], v[180:183], v[160:163], v[72:75]
  ds_read_b64_tr_b16 v[146:147], v236 offset:6144
  v_mfma_f32_16x16x32_bf16 v[68:71], v[180:183], v[156:159], v[68:71]
  ds_read_b64_tr_b16 v[148:149], v237 offset:0
  v_mfma_f32_16x16x32_bf16 v[64:67], v[180:183], v[152:155], v[64:67]
  ds_read_b64_tr_b16 v[150:151], v237 offset:6144
  v_mfma_f32_16x16x32_bf16 v[80:83], v[152:155], v[184:187], v[80:83]
  v_mfma_f32_16x16x32_bf16 v[84:87], v[156:159], v[184:187], v[84:87]
  v_mfma_f32_16x16x32_bf16 v[88:91], v[160:163], v[184:187], v[88:91]
  v_mfma_f32_16x16x32_bf16 v[92:95], v[164:167], v[184:187], v[92:95]
  v_mfma_f32_16x16x32_bf16 v[108:111], v[164:167], v[188:191], v[108:111]
  v_mfma_f32_16x16x32_bf16 v[104:107], v[160:163], v[188:191], v[104:107]
  v_mfma_f32_16x16x32_bf16 v[100:103], v[156:159], v[188:191], v[100:103]
  v_mfma_f32_16x16x32_bf16 v[96:99], v[152:155], v[188:191], v[96:99]
  s_waitcnt lgkmcnt(0)
  v_mfma_f32_16x16x32_bf16 v[16:19], v[128:131], v[112:115], v[16:19]
  ds_read_b128 v[152:155], v193 offset:32768
  v_mfma_f32_16x16x32_bf16 v[20:23], v[128:131], v[116:119], v[20:23]
  ds_read_b64_tr_b16 v[168:169], v232 offset:12288
  s_nop 0
  v_mfma_f32_16x16x32_bf16 v[24:27], v[128:131], v[120:123], v[24:27]
  ds_read_b64_tr_b16 v[170:171], v232 offset:18432
  v_mfma_f32_16x16x32_bf16 v[28:31], v[128:131], v[124:127], v[28:31]
  ds_read_b128 v[156:159], v193 offset:34816
  v_mfma_f32_16x16x32_bf16 v[44:47], v[132:135], v[124:127], v[44:47]
  ds_read_b128 v[160:163], v193 offset:36864
  v_mfma_f32_16x16x32_bf16 v[40:43], v[132:135], v[120:123], v[40:43]
  ds_read_b128 v[164:167], v193 offset:38912
  v_mfma_f32_16x16x32_bf16 v[36:39], v[132:135], v[116:119], v[36:39]
  ds_read_b64_tr_b16 v[172:173], v233 offset:12288
  v_mfma_f32_16x16x32_bf16 v[32:35], v[132:135], v[112:115], v[32:35]
  ds_read_b64_tr_b16 v[174:175], v233 offset:18432
  v_mfma_f32_16x16x32_bf16 v[48:51], v[136:139], v[112:115], v[48:51]
  ds_read_b64_tr_b16 v[176:177], v234 offset:12288
  v_mfma_f32_16x16x32_bf16 v[52:55], v[136:139], v[116:119], v[52:55]
  ds_read_b64_tr_b16 v[178:179], v234 offset:18432
  v_mfma_f32_16x16x32_bf16 v[56:59], v[136:139], v[120:123], v[56:59]
  ds_read_b64_tr_b16 v[180:181], v235 offset:12288
  v_mfma_f32_16x16x32_bf16 v[60:63], v[136:139], v[124:127], v[60:63]
  ds_read_b64_tr_b16 v[182:183], v235 offset:18432
  v_mfma_f32_16x16x32_bf16 v[76:79], v[140:143], v[124:127], v[76:79]
  ds_read_b64_tr_b16 v[184:185], v236 offset:12288
  v_mfma_f32_16x16x32_bf16 v[72:75], v[140:143], v[120:123], v[72:75]
  ds_read_b64_tr_b16 v[186:187], v236 offset:18432
  v_mfma_f32_16x16x32_bf16 v[68:71], v[140:143], v[116:119], v[68:71]
  ds_read_b64_tr_b16 v[188:189], v237 offset:12288
  v_mfma_f32_16x16x32_bf16 v[64:67], v[140:143], v[112:115], v[64:67]
  ds_read_b64_tr_b16 v[190:191], v237 offset:18432
  v_mfma_f32_16x16x32_bf16 v[80:83], v[112:115], v[144:147], v[80:83]
  v_mfma_f32_16x16x32_bf16 v[84:87], v[116:119], v[144:147], v[84:87]
  v_mfma_f32_16x16x32_bf16 v[88:91], v[120:123], v[144:147], v[88:91]
  v_mfma_f32_16x16x32_bf16 v[92:95], v[124:127], v[144:147], v[92:95]
  v_mfma_f32_16x16x32_bf16 v[108:111], v[124:127], v[148:151], v[108:111]
  v_mfma_f32_16x16x32_bf16 v[104:107], v[120:123], v[148:151], v[104:107]
  v_mfma_f32_16x16x32_bf16 v[100:103], v[116:119], v[148:151], v[100:103]
  v_mfma_f32_16x16x32_bf16 v[96:99], v[112:115], v[148:151], v[96:99]
  s_waitcnt lgkmcnt(0)
  s_barrier
  s_cmp_eq_u32 s54, s62
  s_cbranch_scc0 Lrare_q
  s_mov_b64 exec, 1
  buffer_atomic_add v2, off, s[44:47], s61 sc1
  s_mov_b64 exec, -1
Lrare_q:
  v_mfma_f32_16x16x32_bf16 v[16:19], v[168:171], v[152:155], v[16:19]
  ds_read_b128 v[112:115], v192 offset:0
  v_mfma_f32_16x16x32_bf16 v[20:23], v[168:171], v[156:159], v[20:23]
  ds_read_b64_tr_b16 v[128:129], v194 offset:0
  v_mfma_f32_16x16x32_bf16 v[24:27], v[168:171], v[160:163], v[24:27]
  ds_read_b64_tr_b16 v[130:131], v194 offset:6144
  v_mfma_f32_16x16x32_bf16 v[28:31], v[168:171], v[164:167], v[28:31]
  ds_read_b128 v[116:119], v192 offset:2048
  v_mfma_f32_16x16x32_bf16 v[44:47], v[172:175], v[164:167], v[44:47]
  ds_read_b128 v[120:123], v192 offset:4096
  v_mfma_f32_16x16x32_bf16 v[40:43], v[172:175], v[160:163], v[40:43]
  ds_read_b128 v[124:127], v192 offset:6144
  v_mfma_f32_16x16x32_bf16 v[36:39], v[172:175], v[156:159], v[36:39]
  ds_read_b64_tr_b16 v[132:133], v195 offset:0
  v_mfma_f32_16x16x32_bf16 v[32:35], v[172:175], v[152:155], v[32:35]
  ds_read_b64_tr_b16 v[134:135], v195 offset:6144
  v_mfma_f32_16x16x32_bf16 v[48:51], v[176:179], v[152:155], v[48:51]
  ds_read_b64_tr_b16 v[136:137], v196 offset:0
  v_mfma_f32_16x16x32_bf16 v[52:55], v[176:179], v[156:159], v[52:55]
  ds_read_b64_tr_b16 v[138:139], v196 offset:6144
  v_mfma_f32_16x16x32_bf16 v[56:59], v[176:179], v[160:163], v[56:59]
  ds_read_b64_tr_b16 v[140:141], v197 offset:0
  v_mfma_f32_16x16x32_bf16 v[60:63], v[176:179], v[164:167], v[60:63]
  ds_read_b64_tr_b16 v[142:143], v197 offset:6144
  v_mfma_f32_16x16x32_bf16 v[76:79], v[180:183], v[164:167], v[76:79]
  ds_read_b64_tr_b16 v[144:145], v198 offset:0
  v_mfma_f32_16x16x32_bf16 v[72:75], v[180:183], v[160:163], v[72:75]
  ds_read_b64_tr_b16 v[146:147], v198 offset:6144
  v_mfma_f32_16x16x32_bf16 v[68:71], v[180:183], v[156:159], v[68:71]
  ds_read_b64_tr_b16 v[148:149], v199 offset:0
  v_mfma_f32_16x16x32_bf16 v[64:67], v[180:183], v[152:155], v[64:67]
  ds_read_b64_tr_b16 v[150:151], v199 offset:6144
  v_mfma_f32_16x16x32_bf16 v[80:83], v[152:155], v[184:187], v[80:83]
  v_mfma_f32_16x16x32_bf16 v[84:87], v[156:159], v[184:187], v[84:87]
  v_mfma_f32_16x16x32_bf16 v[88:91], v[160:163], v[184:187], v[88:91]
  v_mfma_f32_16x16x32_bf16 v[92:95], v[164:167], v[184:187], v[92:95]
  v_mfma_f32_16x16x32_bf16 v[108:111], v[164:167], v[188:191], v[108:111]
  v_mfma_f32_16x16x32_bf16 v[104:107], v[160:163], v[188:191], v[104:107]
  v_mfma_f32_16x16x32_bf16 v[100:103], v[156:159], v[188:191], v[100:103]
  v_mfma_f32_16x16x32_bf16 v[96:99], v[152:155], v[188:191], v[96:99]
  s_waitcnt lgkmcnt(0)
  v_mfma_f32_16x16x32_bf16 v[16:19], v[128:131], v[112:115], v[16:19]
  ds_read_b128 v[152:155], v193 offset:0
  v_mfma_f32_16x16x32_bf16 v[20:23], v[128:131], v[116:119], v[20:23]
  ds_read_b64_tr_b16 v[168:169], v194 offset:12288
  v_mfma_f32_16x16x32_bf16 v[24:27], v[128:131], v[120:123], v[24:27]
  ds_read_b64_tr_b16 v[170:171], v194 offset:18432
  v_mfma_f32_16x16x32_bf16 v[28:31], v[128:131], v[124:127], v[28:31]
  s_nop 0
  ds_read_b128 v[156:159], v193 offset:2048
  v_mfma_f32_16x16x32_bf16 v[44:47], v[132:135], v[124:127], v[44:47]
  ds_read_b128 v[160:163], v193 offset:4096
  v_mfma_f32_16x16x32_bf16 v[40:43], v[132:135], v[120:123], v[40:43]
  ds_read_b128 v[164:167], v193 offset:6144
  v_mfma_f32_16x16x32_bf16 v[36:39], v[132:135], v[116:119], v[36:39]
  ds_read_b64_tr_b16 v[172:173], v195 offset:12288
  v_mfma_f32_16x16x32_bf16 v[32:35], v[132:135], v[112:115], v[32:35]
  ds_read_b64_tr_b16 v[174:175], v195 offset:18432
  v_mfma_f32_16x16x32_bf16 v[48:51], v[136:139], v[112:115], v[48:51]
  ds_read_b64_tr_b16 v[176:177], v196 offset:12288
  v_mfma_f32_16x16x32_bf16 v[52:55], v[136:139], v[116:119], v[52:55]
  ds_read_b64_tr_b16 v[178:179], v196 offset:18432
  v_mfma_f32_16x16x32_bf16 v[56:59], v[136:139], v[120:123], v[56:59]
  ds_read_b64_tr_b16 v[180:181], v197 offset:12288
  v_mfma_f32_16x16x32_bf16 v[60:63], v[136:139], v[124:127], v[60:63]
  ds_read_b64_tr_b16 v[182:183], v197 offset:18432
  v_mfma_f32_16x16x32_bf16 v[76:79], v[140:143], v[124:127], v[76:79]
  ds_read_b64_tr_b16 v[184:185], v198 offset:12288
  v_mfma_f32_16x16x32_bf16 v[72:75], v[140:143], v[120:123], v[72:75]
  ds_read_b64_tr_b16 v[186:187], v198 offset:18432
  v_mfma_f32_16x16x32_bf16 v[68:71], v[140:143], v[116:119], v[68:71]
  ds_read_b64_tr_b16 v[188:189], v199 offset:12288
  v_mfma_f32_16x16x32_bf16 v[64:67], v[140:143], v[112:115], v[64:67]
  ds_read_b64_tr_b16 v[190:191], v199 offset:18432
  v_mfma_f32_16x16x32_bf16 v[80:83], v[112:115], v[144:147], v[80:83]
  s_add_u32 s54, s54, 1
  s_cmp_lt_u32 s54, 5
  v_mfma_f32_16x16x32_bf16 v[84:87], v[116:119], v[144:147], v[84:87]
  v_mfma_f32_16x16x32_bf16 v[88:91], v[120:123], v[144:147], v[88:91]
  v_mfma_f32_16x16x32_bf16 v[92:95], v[124:127], v[144:147], v[92:95]
  v_mfma_f32_16x16x32_bf16 v[108:111], v[124:127], v[148:151], v[108:111]
  v_mfma_f32_16x16x32_bf16 v[104:107], v[120:123], v[148:151], v[104:107]
  v_mfma_f32_16x16x32_bf16 v[100:103], v[116:119], v[148:151], v[100:103]
  v_mfma_f32_16x16x32_bf16 v[96:99], v[112:115], v[148:151], v[96:99]
  s_waitcnt lgkmcnt(0)
  s_cbranch_scc1 Lc_2005
  s_barrier
  v_mfma_f32_16x16x32_bf16 v[16:19], v[168:171], v[152:155], v[16:19]
  ds_read_b32 v200, v228 offset:0
  v_mfma_f32_16x16x32_bf16 v[20:23], v[168:171], v[156:159], v[20:23]
  ds_read_b32 v244, v228 offset:512
  s_nop 0
  v_mfma_f32_16x16x32_bf16 v[24:27], v[168:171], v[160:163], v[24:27]
  ds_read_b32 v202, v228 offset:64
  v_mfma_f32_16x16x32_bf16 v[28:31], v[168:171], v[164:167], v[28:31]
  ds_read_b32 v246, v228 offset:576
  v_mfma_f32_16x16x32_bf16 v[44:47], v[172:175], v[164:167], v[44:47]
  ds_read_b32 v204, v228 offset:128
  v_mfma_f32_16x16x32_bf16 v[40:43], v[172:175], v[160:163], v[40:43]
  ds_read_b32 v248, v228 offset:640
  v_mfma_f32_16x16x32_bf16 v[36:39], v[172:175], v[156:159], v[36:39]
  ds_read_b32 v206, v228 offset:192
  v_mfma_f32_16x16x32_bf16 v[32:35], v[172:175], v[152:155], v[32:35]
  ds_read_b32 v250, v228 offset:704
  v_mfma_f32_16x16x32_bf16 v[48:51], v[176:179], v[152:155], v[48:51]
  ds_read_b128 v[216:219], v230 offset:256
  v_mfma_f32_16x16x32_bf16 v[52:55], v[176:179], v[156:159], v[52:55]
  ds_read_b128 v[220:223], v230 offset:320
  v_mfma_f32_16x16x32_bf16 v[56:59], v[176:179], v[160:163], v[56:59]
  ds_read_b128 v[208:211], v230 offset:0
  v_mfma_f32_16x16x32_bf16 v[60:63], v[176:179], v[164:167], v[60:63]
  ds_read_b128 v[212:215], v230 offset:64
  v_mfma_f32_16x16x32_bf16 v[76:79], v[180:183], v[164:167], v[76:79]
  ds_read_b32 v224, v231 offset:512
  v_mfma_f32_16x16x32_bf16 v[72:75], v[180:183], v[160:163], v[72:75]
  ds_read_b32 v226, v231 offset:576
  v_mfma_f32_16x16x32_bf16 v[68:71], v[180:183], v[156:159], v[68:71]
  ds_read_b128 v[112:115], v229 offset:0
  v_mfma_f32_16x16x32_bf16 v[64:67], v[180:183], v[152:155], v[64:67]
  ds_read_b128 v[116:119], v229 offset:512
  v_mfma_f32_16x16x32_bf16 v[80:83], v[152:155], v[184:187], v[80:83]
  ds_read_b128 v[120:123], v229 offset:64
  v_mfma_f32_16x16x32_bf16 v[84:87], v[156:159], v[184:187], v[84:87]
  ds_read_b128 v[124:127], v229 offset:576
  v_mfma_f32_16x16x32_bf16 v[88:91], v[160:163], v[184:187], v[88:91]
  ds_read_b128 v[128:131], v229 offset:128
  v_mfma_f32_16x16x32_bf16 v[92:95], v[164:167], v[184:187], v[92:95]
  ds_read_b128 v[132:135], v229 offset:640
  v_mfma_f32_16x16x32_bf16 v[108:111], v[164:167], v[188:191], v[108:111]
  ds_read_b128 v[136:139], v229 offset:192
  v_mfma_f32_16x16x32_bf16 v[104:107], v[160:163], v[188:191], v[104:107]
  ds_read_b128 v[140:143], v229 offset:704
  v_mfma_f32_16x16x32_bf16 v[100:103], v[156:159], v[188:191], v[100:103]
  v_mfma_f32_16x16x32_bf16 v[96:99], v[152:155], v[188:191], v[96:99]
  s_nop 7
  s_waitcnt lgkmcnt(0)
  v_pk_mul_f32 v[4:5], v[216:217], v[244:245] op_sel_hi:[1,0]
  v_pk_mul_f32 v[6:7], v[218:219], v[244:245] op_sel_hi:[1,0]
  v_pk_fma_f32 v[4:5], v[48:49], v[200:201], v[4:5] op_sel_hi:[1,0,1]
  v_pk_fma_f32 v[6:7], v[50:51], v[200:201], v[6:7] op_sel_hi:[1,0,1]
  v_cvt_pk_bf16_f32 v152, v4, v5
  v_cvt_pk_bf16_f32 v153, v6, v7
  v_pk_mul_f32 v[4:5], v[220:221], v[244:245] op_sel_hi:[1,0]
  v_pk_mul_f32 v[6:7], v[222:223], v[244:245] op_sel_hi:[1,0]
  v_pk_fma_f32 v[4:5], v[64:65], v[200:201], v[4:5] op_sel_hi:[1,0,1]
  v_pk_fma_f32 v[6:7], v[66:67], v[200:201], v[6:7] op_sel_hi:[1,0,1]
  v_cvt_pk_bf16_f32 v154, v4, v5
  v_cvt_pk_bf16_f32 v155, v6, v7
  buffer_store_dwordx4 v[152:155], v1, s[8:11], s5 offen offset:0 sc1
  ds_write_b128 v3, v[152:155] offset:0
  v_pk_mul_f32 v[4:5], v[216:217], v[246:247] op_sel_hi:[1,0]
  v_pk_mul_f32 v[6:7], v[218:219], v[246:247] op_sel_hi:[1,0]
  v_pk_fma_f32 v[4:5], v[52:53], v[202:203], v[4:5] op_sel_hi:[1,0,1]
  v_pk_fma_f32 v[6:7], v[54:55], v[202:203], v[6:7] op_sel_hi:[1,0,1]
  v_cvt_pk_bf16_f32 v156, v4, v5
  v_cvt_pk_bf16_f32 v157, v6, v7
  v_pk_mul_f32 v[4:5], v[220:221], v[246:247] op_sel_hi:[1,0]
  v_pk_mul_f32 v[6:7], v[222:223], v[246:247] op_sel_hi:[1,0]
  v_pk_fma_f32 v[4:5], v[68:69], v[202:203], v[4:5] op_sel_hi:[1,0,1]
  v_pk_fma_f32 v[6:7], v[70:71], v[202:203], v[6:7] op_sel_hi:[1,0,1]
  v_cvt_pk_bf16_f32 v158, v4, v5
  v_cvt_pk_bf16_f32 v159, v6, v7
  buffer_store_dwordx4 v[156:159], v1, s[8:11], s5 offen offset:1024 sc1
  ds_write_b128 v3, v[156:159] offset:1024
  v_pk_mul_f32 v[4:5], v[216:217], v[248:249] op_sel_hi:[1,0]
  v_pk_mul_f32 v[6:7], v[218:219], v[248:249] op_sel_hi:[1,0]
  v_pk_fma_f32 v[4:5], v[56:57], v[204:205], v[4:5] op_sel_hi:[1,0,1]
  v_pk_fma_f32 v[6:7], v[58:59], v[204:205], v[6:7] op_sel_hi:[1,0,1]
  v_cvt_pk_bf16_f32 v160, v4, v5
  v_cvt_pk_bf16_f32 v161, v6, v7
  v_pk_mul_f32 v[4:5], v[220:221], v[248:249] op_sel_hi:[1,0]
  v_pk_mul_f32 v[6:7], v[222:223], v[248:249] op_sel_hi:[1,0]
  v_pk_fma_f32 v[4:5], v[72:73], v[204:205], v[4:5] op_sel_hi:[1,0,1]
  v_pk_fma_f32 v[6:7], v[74:75], v[204:205], v[6:7] op_sel_hi:[1,0,1]
  v_cvt_pk_bf16_f32 v162, v4, v5
  v_cvt_pk_bf16_f32 v163, v6, v7
  buffer_store_dwordx4 v[160:163], v1, s[8:11], s5 offen offset:2048 sc1
  ds_write_b128 v3, v[160:163] offset:2048
  v_pk_mul_f32 v[4:5], v[216:217], v[250:251] op_sel_hi:[1,0]
  v_pk_mul_f32 v[6:7], v[218:219], v[250:251] op_sel_hi:[1,0]
  v_pk_fma_f32 v[4:5], v[60:61], v[206:207], v[4:5] op_sel_hi:[1,0,1]
  v_pk_fma_f32 v[6:7], v[62:63], v[206:207], v[6:7] op_sel_hi:[1,0,1]
  v_cvt_pk_bf16_f32 v164, v4, v5
  v_cvt_pk_bf16_f32 v165, v6, v7
  v_pk_mul_f32 v[4:5], v[220:221], v[250:251] op_sel_hi:[1,0]
  v_pk_mul_f32 v[6:7], v[222:223], v[250:251] op_sel_hi:[1,0]
  v_pk_fma_f32 v[4:5], v[76:77], v[206:207], v[4:5] op_sel_hi:[1,0,1]
  v_pk_fma_f32 v[6:7], v[78:79], v[206:207], v[6:7] op_sel_hi:[1,0,1]
  v_cvt_pk_bf16_f32 v166, v4, v5
  v_cvt_pk_bf16_f32 v167, v6, v7
  buffer_store_dwordx4 v[164:167], v1, s[8:11], s5 offen offset:3072 sc1
  ds_write_b128 v3, v[164:167] offset:3072
  v_pk_mul_f32 v[4:5], v[116:117], v[224:225] op_sel_hi:[1,0]
  v_pk_mul_f32 v[6:7], v[118:119], v[224:225] op_sel_hi:[1,0]
  v_pk_fma_f32 v[4:5], v[80:81], v[112:113], v[4:5]
  v_pk_fma_f32 v[6:7], v[82:83], v[114:115], v[6:7]
  v_cvt_pk_bf16_f32 v168, v4, v5
  v_cvt_pk_bf16_f32 v169, v6, v7
  v_pk_mul_f32 v[4:5], v[124:125], v[224:225] op_sel_hi:[1,0]
  v_pk_mul_f32 v[6:7], v[126:127], v[224:225] op_sel_hi:[1,0]
  v_pk_fma_f32 v[4:5], v[84:85], v[120:121], v[4:5]
  v_pk_fma_f32 v[6:7], v[86:87], v[122:123], v[6:7]
  v_cvt_pk_bf16_f32 v170, v4, v5
  v_cvt_pk_bf16_f32 v171, v6, v7
  buffer_store_dwordx4 v[168:171], v1, s[8:11], s6 offen offset:0 sc1
  ds_write_b128 v3, v[168:171] offset:49152
  v_pk_mul_f32 v[4:5], v[116:117], v[226:227] op_sel_hi:[1,0]
  v_pk_mul_f32 v[6:7], v[118:119], v[226:227] op_sel_hi:[1,0]
  v_pk_fma_f32 v[4:5], v[96:97], v[112:113], v[4:5]
  v_pk_fma_f32 v[6:7], v[98:99], v[114:115], v[6:7]
  v_cvt_pk_bf16_f32 v172, v4, v5
  v_cvt_pk_bf16_f32 v173, v6, v7
  v_pk_mul_f32 v[4:5], v[124:125], v[226:227] op_sel_hi:[1,0]
  v_pk_mul_f32 v[6:7], v[126:127], v[226:227] op_sel_hi:[1,0]
  v_pk_fma_f32 v[4:5], v[100:101], v[120:121], v[4:5]
  v_pk_fma_f32 v[6:7], v[102:103], v[122:123], v[6:7]
  v_cvt_pk_bf16_f32 v174, v4, v5
  v_cvt_pk_bf16_f32 v175, v6, v7
  buffer_store_dwordx4 v[172:175], v1, s[8:11], s6 offen offset:1024 sc1
  ds_write_b128 v3, v[172:175] offset:50176
  v_pk_mul_f32 v[4:5], v[132:133], v[224:225] op_sel_hi:[1,0]
  v_pk_mul_f32 v[6:7], v[134:135], v[224:225] op_sel_hi:[1,0]
  v_pk_fma_f32 v[4:5], v[88:89], v[128:129], v[4:5]
  v_pk_fma_f32 v[6:7], v[90:91], v[130:131], v[6:7]
  v_cvt_pk_bf16_f32 v176, v4, v5
  v_cvt_pk_bf16_f32 v177, v6, v7
  v_pk_mul_f32 v[4:5], v[140:141], v[224:225] op_sel_hi:[1,0]
  v_pk_mul_f32 v[6:7], v[142:143], v[224:225] op_sel_hi:[1,0]
  v_pk_fma_f32 v[4:5], v[92:93], v[136:137], v[4:5]
  v_pk_fma_f32 v[6:7], v[94:95], v[138:139], v[6:7]
  v_cvt_pk_bf16_f32 v178, v4, v5
  v_cvt_pk_bf16_f32 v179, v6, v7
  buffer_store_dwordx4 v[176:179], v1, s[8:11], s6 offen offset:2048 sc1
  ds_write_b128 v3, v[176:179] offset:51200
  v_pk_mul_f32 v[4:5], v[132:133], v[226:227] op_sel_hi:[1,0]
  v_pk_mul_f32 v[6:7], v[134:135], v[226:227] op_sel_hi:[1,0]
  v_pk_fma_f32 v[4:5], v[104:105], v[128:129], v[4:5]
  v_pk_fma_f32 v[6:7], v[106:107], v[130:131], v[6:7]
  v_cvt_pk_bf16_f32 v180, v4, v5
  v_cvt_pk_bf16_f32 v181, v6, v7
  v_pk_mul_f32 v[4:5], v[140:141], v[226:227] op_sel_hi:[1,0]
  v_pk_mul_f32 v[6:7], v[142:143], v[226:227] op_sel_hi:[1,0]
  v_pk_fma_f32 v[4:5], v[108:109], v[136:137], v[4:5]
  v_pk_fma_f32 v[6:7], v[110:111], v[138:139], v[6:7]
  v_cvt_pk_bf16_f32 v182, v4, v5
  v_cvt_pk_bf16_f32 v183, v6, v7
  buffer_store_dwordx4 v[180:183], v1, s[8:11], s6 offen offset:3072 sc1
  ds_write_b128 v3, v[180:183] offset:52224
  v_mul_f32 v200, 0x3e8293ee, v200
  v_mul_f32 v202, 0x3e8293ee, v202
  v_mul_f32 v204, 0x3e8293ee, v204
  v_mul_f32 v206, 0x3e8293ee, v206
  v_mul_f32 v244, 0x3e8293ee, v244
  v_mul_f32 v246, 0x3e8293ee, v246
  v_mul_f32 v248, 0x3e8293ee, v248
  v_mul_f32 v250, 0x3e8293ee, v250
  v_pk_mul_f32 v[4:5], v[208:209], v[244:245] op_sel_hi:[1,0]
  v_pk_mul_f32 v[6:7], v[210:211], v[244:245] op_sel_hi:[1,0]
  v_pk_fma_f32 v[4:5], v[16:17], v[200:201], v[4:5] op_sel_hi:[1,0,1]
  v_pk_fma_f32 v[6:7], v[18:19], v[200:201], v[6:7] op_sel_hi:[1,0,1]
  v_cvt_pk_bf16_f32 v112, v4, v5
  v_cvt_pk_bf16_f32 v113, v6, v7
  v_pk_mul_f32 v[4:5], v[212:213], v[244:245] op_sel_hi:[1,0]
  v_pk_mul_f32 v[6:7], v[214:215], v[244:245] op_sel_hi:[1,0]
  v_pk_fma_f32 v[4:5], v[32:33], v[200:201], v[4:5] op_sel_hi:[1,0,1]
  v_pk_fma_f32 v[6:7], v[34:35], v[200:201], v[6:7] op_sel_hi:[1,0,1]
  v_cvt_pk_bf16_f32 v114, v4, v5
  v_cvt_pk_bf16_f32 v115, v6, v7
  ds_write_b128 v10, v[112:115] offset:0
  v_pk_mul_f32 v[4:5], v[208:209], v[246:247] op_sel_hi:[1,0]
  v_pk_mul_f32 v[6:7], v[210:211], v[246:247] op_sel_hi:[1,0]
  v_pk_fma_f32 v[4:5], v[20:21], v[202:203], v[4:5] op_sel_hi:[1,0,1]
  v_pk_fma_f32 v[6:7], v[22:23], v[202:203], v[6:7] op_sel_hi:[1,0,1]
  v_cvt_pk_bf16_f32 v116, v4, v5
  v_cvt_pk_bf16_f32 v117, v6, v7
  v_pk_mul_f32 v[4:5], v[212:213], v[246:247] op_sel_hi:[1,0]
  v_pk_mul_f32 v[6:7], v[214:215], v[246:247] op_sel_hi:[1,0]
  v_pk_fma_f32 v[4:5], v[36:37], v[202:203], v[4:5] op_sel_hi:[1,0,1]
  v_pk_fma_f32 v[6:7], v[38:39], v[202:203], v[6:7] op_sel_hi:[1,0,1]
  v_cvt_pk_bf16_f32 v118, v4, v5
  v_cvt_pk_bf16_f32 v119, v6, v7
  ds_write_b128 v10, v[116:119] offset:1024
  v_pk_mul_f32 v[4:5], v[208:209], v[248:249] op_sel_hi:[1,0]
  v_pk_mul_f32 v[6:7], v[210:211], v[248:249] op_sel_hi:[1,0]
  v_pk_fma_f32 v[4:5], v[24:25], v[204:205], v[4:5] op_sel_hi:[1,0,1]
  v_pk_fma_f32 v[6:7], v[26:27], v[204:205], v[6:7] op_sel_hi:[1,0,1]
  v_cvt_pk_bf16_f32 v120, v4, v5
  v_cvt_pk_bf16_f32 v121, v6, v7
  v_pk_mul_f32 v[4:5], v[212:213], v[248:249] op_sel_hi:[1,0]
  v_pk_mul_f32 v[6:7], v[214:215], v[248:249] op_sel_hi:[1,0]
  v_pk_fma_f32 v[4:5], v[40:41], v[204:205], v[4:5] op_sel_hi:[1,0,1]
  v_pk_fma_f32 v[6:7], v[42:43], v[204:205], v[6:7] op_sel_hi:[1,0,1]
  v_cvt_pk_bf16_f32 v122, v4, v5
  v_cvt_pk_bf16_f32 v123, v6, v7
  ds_write_b128 v10, v[120:123] offset:2048
  v_pk_mul_f32 v[4:5], v[208:209], v[250:251] op_sel_hi:[1,0]
  v_pk_mul_f32 v[6:7], v[210:211], v[250:251] op_sel_hi:[1,0]
  v_pk_fma_f32 v[4:5], v[28:29], v[206:207], v[4:5] op_sel_hi:[1,0,1]
  v_pk_fma_f32 v[6:7], v[30:31], v[206:207], v[6:7] op_sel_hi:[1,0,1]
  v_cvt_pk_bf16_f32 v124, v4, v5
  v_cvt_pk_bf16_f32 v125, v6, v7
  v_pk_mul_f32 v[4:5], v[212:213], v[250:251] op_sel_hi:[1,0]
  v_pk_mul_f32 v[6:7], v[214:215], v[250:251] op_sel_hi:[1,0]
  v_pk_fma_f32 v[4:5], v[44:45], v[206:207], v[4:5] op_sel_hi:[1,0,1]
  v_pk_fma_f32 v[6:7], v[46:47], v[206:207], v[6:7] op_sel_hi:[1,0,1]
  v_cvt_pk_bf16_f32 v126, v4, v5
  v_cvt_pk_bf16_f32 v127, v6, v7
  ds_write_b128 v10, v[124:127] offset:3072
  s_waitcnt lgkmcnt(0)
  s_nop 0
  s_add_u32 s3, s67, 67125248
  v_lshl_add_u32 v3, v0, 14, s3
  s_sub_u32 s4, 15, s48
  s_min_u32 s4, s4, 2
  s_lshl_b32 s4, 1, s4
  s_sub_u32 s4, s4, 1
  s_mov_b32 s5, 0
  v_mov_b32 v2, 1
  s_cmp_eq_u32 s50, 0
  s_cselect_b64 s[64:65], s[4:5], 0
  s_waitcnt vmcnt(0)
  s_barrier
  s_mov_b64 exec, s[64:65]
  s_cbranch_execz Lsf_2006
  buffer_atomic_add v2, v3, s[8:11], 0 offen sc1
Lsf_2006:
  s_mov_b64 exec, -1
  s_and_b32 s54, s50, 1
  s_lshr_b32 s55, s51, 1
  s_sub_u32 s55, 3, s55
  s_mul_i32 s3, s54, 24576
  s_lshl_b32 s4, s55, 11
  s_add_u32 s3, s3, s4
  s_add_u32 s3, s3, 49152
  v_add_u32_e64 v4, s3, v1
  s_lshl_b32 s3, s54, 13
  s_add_u32 s3, s3, s4
  s_add_u32 s3, s3, 147456
  v_add_u32 v2, s3, v1
  s_lshl_b32 s3, s55, 1
  s_lshl_b32 s4, s48, 3
  s_add_u32 s3, s3, s4
  s_sub_u32 s7, 16, s3
  s_cmp_gt_i32 s7, 0
  s_cselect_b32 s5, 0xf149f2ca, 0
  v_and_b32 v3, 15, v0
  v_lshrrev_b32 v5, 4, v0
  v_lshlrev_b32 v5, 2, v5
  v_mov_b32 v6, 0xf149f2ca
  v_mov_b32 v8, s5
  v_add_u32 v7, 0, v5
  v_cmp_gt_u32 vcc, v7, v3
  v_mov_b32 v24, 0x3f803f80
  s_nop 0
  v_cndmask_b32 v16, v6, v8, vcc
  v_cndmask_b32 v20, 0, v6, vcc
  v_add_u32 v7, 1, v5
  v_cmp_gt_u32 vcc, v7, v3
  v_mov_b32 v25, 0x3f803f80
  s_nop 0
  v_cndmask_b32 v17, v6, v8, vcc
  v_cndmask_b32 v21, 0, v6, vcc
  v_add_u32 v7, 2, v5
  v_cmp_gt_u32 vcc, v7, v3
  v_mov_b32 v26, 0x3f803f80
  s_nop 0
  v_cndmask_b32 v18, v6, v8, vcc
  v_cndmask_b32 v22, 0, v6, vcc
  v_add_u32 v7, 3, v5
  v_cmp_gt_u32 vcc, v7, v3
  v_mov_b32 v27, 0x3f803f80
  s_nop 0
  v_cndmask_b32 v19, v6, v8, vcc
  v_cndmask_b32 v23, 0, v6, vcc
  s_lshl_b32 s3, s2, 3
  s_add_u32 s3, s3, s50
  s_mul_i32 s62, s3, 3584
  s_lshl_b32 s3, s48, 4
  s_add_u32 s3, s3, s49
  s_lshl_b32 s3, s3, 1
  s_add_u32 s3, s3, s54
  s_lshl_b32 s3, s3, 2
  s_add_u32 s3, s3, s55
  s_lshl_b32 s3, s3, 11
  s_add_u32 s6, s3, 16777216
  v_mov_b32 v168, 0
  v_mov_b32_e64 v169, 0
  ds_read_b128 v[8:11], v2
  ds_read_b128 v[12:15], v2 offset:1024
  v_add_u32 v5, 49152, v4
  ds_read_b128 v[28:31], v4 offset:12288
  ds_read_b128 v[32:35], v4 offset:13312
  ds_read_b128 v[36:39], v4 offset:14336
  ds_read_b128 v[40:43], v4 offset:15360
  ds_read_b128 v[44:47], v4 offset:16384
  ds_read_b128 v[48:51], v4 offset:17408
  ds_read_b128 v[52:55], v5 offset:12288
  ds_read_b128 v[56:59], v5 offset:13312
  ds_read_b128 v[60:63], v5 offset:14336
  ds_read_b128 v[64:67], v5 offset:15360
  ds_read_b128 v[68:71], v5 offset:16384
  ds_read_b128 v[72:75], v5 offset:17408
  s_waitcnt lgkmcnt(10)
  v_mfma_f32_16x16x32_bf16 v[148:151], v[28:31], v[8:11], 0
  v_mfma_f32_16x16x32_bf16 v[214:217], v[28:31], v[12:15], 0
  s_nop 0
  v_mfma_f32_16x16x32_bf16 v[152:155], v[32:35], v[8:11], 0
  v_mfma_f32_16x16x32_bf16 v[218:221], v[32:35], v[12:15], 0
  s_waitcnt lgkmcnt(8)
  v_mfma_f32_16x16x32_bf16 v[156:159], v[36:39], v[8:11], 0
  v_mfma_f32_16x16x32_bf16 v[222:225], v[36:39], v[12:15], 0
  v_mfma_f32_16x16x32_bf16 v[160:163], v[40:43], v[8:11], 0
  s_nop 2
  v_max_f32 v2, v148, v149
  v_max_f32 v3, v150, v151
  v_mfma_f32_16x16x32_bf16 v[226:229], v[40:43], v[12:15], 0
  v_max_f32 v6, v214, v215
  v_max_f32_e64 v7, v216, v217
  s_waitcnt lgkmcnt(6)
  v_mfma_f32_16x16x32_bf16 v[164:167], v[44:47], v[8:11], v[20:23]
  v_max3_f32 v2, v2, v152, v153
  v_max3_f32 v3, v3, v154, v155
  v_mfma_f32_16x16x32_bf16 v[230:233], v[44:47], v[12:15], 0
  v_max3_f32 v6, v6, v218, v219
  v_max3_f32 v7, v7, v220, v221
  v_max3_f32 v2, v2, v156, v157
  v_max3_f32 v3, v3, v158, v159
  v_mfma_f32_16x16x32_bf16 v[234:237], v[48:51], v[12:15], v[20:23]
  v_max3_f32 v6, v6, v222, v223
  v_max3_f32 v7, v7, v224, v225
  s_nop 3
  v_max3_f32 v2, v2, v160, v161
  v_max3_f32 v3, v3, v162, v163
  s_nop 0
  v_max3_f32 v6, v6, v226, v227
  v_max3_f32 v7, v7, v228, v229
  s_nop 3
  v_max3_f32 v2, v2, v164, v165
  v_max3_f32 v3, v3, v166, v167
  v_max3_f32 v6, v6, v230, v231
  v_max3_f32 v7, v7, v232, v233
  s_nop 3
  v_max3_f32 v6, v6, v234, v235
  v_max3_f32 v7, v7, v236, v237
  v_max_f32 v2, v2, v3
  v_max_f32 v6, v6, v7
  v_mov_b32 v3, v2
  v_mov_b32 v7, v6
  s_nop 0
  v_permlane32_swap_b32 v2, v3
  v_permlane32_swap_b32 v6, v7
  s_nop 0
  v_max_f32 v2, v2, v3
  v_max_f32 v6, v6, v7
  v_mov_b32 v3, v2
  v_mov_b32 v7, v6
  s_nop 0
  v_permlane16_swap_b32 v2, v3
  v_permlane16_swap_b32 v6, v7
  s_nop 0
  v_max_f32 v2, v2, v3
  v_max_f32 v6, v6, v7
  v_pk_add_f32 v[148:149], v[148:149], v[2:3] op_sel_hi:[1,0] neg_lo:[0,1] neg_hi:[0,1]
  v_pk_add_f32 v[150:151], v[150:151], v[2:3] op_sel_hi:[1,0] neg_lo:[0,1] neg_hi:[0,1]
  v_pk_add_f32 v[152:153], v[152:153], v[2:3] op_sel_hi:[1,0] neg_lo:[0,1] neg_hi:[0,1]
  v_pk_add_f32 v[154:155], v[154:155], v[2:3] op_sel_hi:[1,0] neg_lo:[0,1] neg_hi:[0,1]
  v_exp_f32 v148, v148
  v_exp_f32 v149, v149
  v_exp_f32 v150, v150
  v_exp_f32 v151, v151
  v_exp_f32 v152, v152
  v_exp_f32 v153, v153
  v_exp_f32 v154, v154
  v_exp_f32 v155, v155
  v_cvt_pk_bf16_f32 v124, v148, v149
  v_cvt_pk_bf16_f32 v125, v150, v151
  v_cvt_pk_bf16_f32 v126, v152, v153
  v_cvt_pk_bf16_f32 v127, v154, v155
  v_pk_add_f32 v[156:157], v[156:157], v[2:3] op_sel_hi:[1,0] neg_lo:[0,1] neg_hi:[0,1]
  v_pk_add_f32 v[158:159], v[158:159], v[2:3] op_sel_hi:[1,0] neg_lo:[0,1] neg_hi:[0,1]
  v_pk_add_f32 v[160:161], v[160:161], v[2:3] op_sel_hi:[1,0] neg_lo:[0,1] neg_hi:[0,1]
  v_pk_add_f32 v[162:163], v[162:163], v[2:3] op_sel_hi:[1,0] neg_lo:[0,1] neg_hi:[0,1]
  s_waitcnt lgkmcnt(0)
  v_exp_f32 v156, v156
  v_exp_f32 v157, v157
  v_mfma_f32_16x16x32_bf16 v[238:241], v[52:55], v[124:127], 0
  v_exp_f32 v158, v158
  v_exp_f32 v159, v159
  v_mfma_f32_16x16x32_bf16 v[242:245], v[56:59], v[124:127], 0
  v_exp_f32 v160, v160
  v_exp_f32_e64 v161, v161
  v_mfma_f32_16x16x32_bf16 v[246:249], v[24:27], v[124:127], 0
  v_exp_f32 v162, v162
  v_exp_f32 v163, v163
  v_cvt_pk_bf16_f32 v128, v156, v157
  v_cvt_pk_bf16_f32 v129, v158, v159
  v_cvt_pk_bf16_f32 v130, v160, v161
  v_cvt_pk_bf16_f32 v131, v162, v163
  v_pk_add_f32 v[164:165], v[164:165], v[2:3] op_sel_hi:[1,0] neg_lo:[0,1] neg_hi:[0,1]
  v_pk_add_f32 v[166:167], v[166:167], v[2:3] op_sel_hi:[1,0] neg_lo:[0,1] neg_hi:[0,1]
  v_exp_f32 v164, v164
  v_exp_f32 v165, v165
  v_mfma_f32_16x16x32_bf16 v[238:241], v[60:63], v[128:131], v[238:241]
  v_exp_f32 v166, v166
  v_exp_f32 v167, v167
  v_mfma_f32_16x16x32_bf16 v[242:245], v[64:67], v[128:131], v[242:245]
  v_mfma_f32_16x16x32_bf16 v[246:249], v[24:27], v[128:131], v[246:249]
  s_nop 0
  v_cvt_pk_bf16_f32 v132, v164, v165
  v_cvt_pk_bf16_f32 v133, v166, v167
  v_mov_b32 v134, 0
  v_mov_b32 v135, 0
  v_pk_add_f32 v[214:215], v[214:215], v[6:7] op_sel_hi:[1,0] neg_lo:[0,1] neg_hi:[0,1]
  v_pk_add_f32 v[216:217], v[216:217], v[6:7] op_sel_hi:[1,0] neg_lo:[0,1] neg_hi:[0,1]
  v_pk_add_f32 v[218:219], v[218:219], v[6:7] op_sel_hi:[1,0] neg_lo:[0,1] neg_hi:[0,1]
  v_pk_add_f32 v[220:221], v[220:221], v[6:7] op_sel_hi:[1,0] neg_lo:[0,1] neg_hi:[0,1]
  v_exp_f32 v214, v214
  v_exp_f32 v215, v215
  v_mfma_f32_16x16x32_bf16 v[238:241], v[68:71], v[132:135], v[238:241]
  v_exp_f32 v216, v216
  v_exp_f32_e64 v217, v217
  v_mfma_f32_16x16x32_bf16 v[242:245], v[72:75], v[132:135], v[242:245]
  v_exp_f32 v218, v218
  v_exp_f32 v219, v219
  v_mfma_f32_16x16x32_bf16 v[246:249], v[24:27], v[132:135], v[246:249]
  v_exp_f32 v220, v220
  v_exp_f32 v221, v221
  v_cvt_pk_bf16_f32 v192, v214, v215
  v_cvt_pk_bf16_f32 v193, v216, v217
  v_cvt_pk_bf16_f32 v194, v218, v219
  v_cvt_pk_bf16_f32 v195, v220, v221
  v_pk_add_f32 v[222:223], v[222:223], v[6:7] op_sel_hi:[1,0] neg_lo:[0,1] neg_hi:[0,1]
  v_pk_add_f32 v[224:225], v[224:225], v[6:7] op_sel_hi:[1,0] neg_lo:[0,1] neg_hi:[0,1]
  v_pk_add_f32 v[226:227], v[226:227], v[6:7] op_sel_hi:[1,0] neg_lo:[0,1] neg_hi:[0,1]
  v_pk_add_f32 v[228:229], v[228:229], v[6:7] op_sel_hi:[1,0] neg_lo:[0,1] neg_hi:[0,1]
  v_exp_f32 v222, v222
  v_exp_f32 v223, v223
  v_mfma_f32_16x16x32_bf16 v[156:159], v[52:55], v[192:195], 0
  v_exp_f32 v224, v224
  v_exp_f32 v225, v225
  v_mfma_f32_16x16x32_bf16 v[160:163], v[56:59], v[192:195], 0
  v_exp_f32 v226, v226
  v_exp_f32 v227, v227
  v_mfma_f32_16x16x32_bf16 v[164:167], v[24:27], v[192:195], 0
  v_exp_f32 v228, v228
  v_exp_f32 v229, v229
  v_cvt_pk_bf16_f32 v196, v222, v223
  v_cvt_pk_bf16_f32 v197, v224, v225
  v_cvt_pk_bf16_f32 v198, v226, v227
  v_cvt_pk_bf16_f32 v199, v228, v229
  v_pk_add_f32 v[230:231], v[230:231], v[6:7] op_sel_hi:[1,0] neg_lo:[0,1] neg_hi:[0,1]
  v_pk_add_f32 v[232:233], v[232:233], v[6:7] op_sel_hi:[1,0] neg_lo:[0,1] neg_hi:[0,1]
  v_pk_add_f32 v[234:235], v[234:235], v[6:7] op_sel_hi:[1,0] neg_lo:[0,1] neg_hi:[0,1]
  v_pk_add_f32 v[236:237], v[236:237], v[6:7] op_sel_hi:[1,0] neg_lo:[0,1] neg_hi:[0,1]
  v_exp_f32 v230, v230
  v_exp_f32 v231, v231
  v_mfma_f32_16x16x32_bf16 v[156:159], v[60:63], v[196:199], v[156:159]
  v_exp_f32 v232, v232
  v_exp_f32 v233, v233
  v_mfma_f32_16x16x32_bf16 v[160:163], v[64:67], v[196:199], v[160:163]
  v_exp_f32 v234, v234
  v_exp_f32 v235, v235
  v_mfma_f32_16x16x32_bf16 v[164:167], v[24:27], v[196:199], v[164:167]
  v_exp_f32 v236, v236
  v_exp_f32_e64 v237, v237
  v_cvt_pk_bf16_f32 v200, v230, v231
  v_cvt_pk_bf16_f32 v201, v232, v233
  v_cvt_pk_bf16_f32 v202, v234, v235
  v_cvt_pk_bf16_f32 v203, v236, v237
  s_nop 1
  v_mfma_f32_16x16x32_bf16 v[156:159], v[68:71], v[200:203], v[156:159]
  v_mfma_f32_16x16x32_bf16 v[160:163], v[72:75], v[200:203], v[160:163]
  v_mfma_f32_16x16x32_bf16 v[164:167], v[24:27], v[200:203], v[164:167]
  v_mov_b32 v234, v2
  v_mov_b32 v236, v6
  v_mov_b32 v230, s5
  v_mov_b32 v231, s5
  v_mov_b32 v232, s5
  v_mov_b32 v233, s5
  s_waitcnt lgkmcnt(0)
  s_barrier
  ds_read_b128 v[28:31], v4 offset:0
  ds_read_b128 v[32:35], v4 offset:1024
  ds_read_b128 v[36:39], v4 offset:2048
  ds_read_b128 v[40:43], v4 offset:3072
  ds_read_b128 v[44:47], v4 offset:4096
  ds_read_b128 v[48:51], v4 offset:5120
  ds_read_b128 v[52:55], v4 offset:6144
  ds_read_b128 v[56:59], v4 offset:7168
  ds_read_b128 v[60:63], v4 offset:8192
  ds_read_b128 v[64:67], v4 offset:9216
  ds_read_b128 v[68:71], v4 offset:10240
  ds_read_b128 v[72:75], v4 offset:11264
  v_add_u32 v4, 49152, v4
  s_cmp_gt_i32 s7, 0
  s_cbranch_scc1 Lsslow_2007
  s_waitcnt lgkmcnt(10)
  v_mfma_f32_16x16x32_bf16 v[100:103], v[28:31], v[8:11], v[16:19]
  v_mfma_f32_16x16x32_bf16 v[104:107], v[32:35], v[8:11], 0
  v_mfma_f32_16x16x32_bf16 v[170:173], v[32:35], v[12:15], v[16:19]
  s_waitcnt lgkmcnt(8)
  v_mfma_f32_16x16x32_bf16 v[108:111], v[36:39], v[8:11], 0
  v_mfma_f32_16x16x32_bf16 v[174:177], v[36:39], v[12:15], 0
  v_mfma_f32_16x16x32_bf16 v[112:115], v[40:43], v[8:11], 0
  s_nop 2
  v_max3_f32 v2, v2, v100, v101
  v_max_f32_e64 v3, v102, v103
  v_mfma_f32_16x16x32_bf16 v[178:181], v[40:43], v[12:15], 0
  s_waitcnt lgkmcnt(6)
  v_mfma_f32_16x16x32_bf16 v[116:119], v[44:47], v[8:11], 0
  v_max3_f32 v2, v2, v104, v105
  v_max3_f32 v3, v3, v106, v107
  v_mfma_f32_16x16x32_bf16 v[182:185], v[44:47], v[12:15], 0
  v_max3_f32 v6, v6, v170, v171
  v_max_f32_e64 v7, v172, v173
  v_mfma_f32_16x16x32_bf16 v[120:123], v[48:51], v[8:11], 0
  v_max3_f32 v2, v2, v108, v109
  v_max3_f32 v3, v3, v110, v111
  v_mfma_f32_16x16x32_bf16 v[186:189], v[48:51], v[12:15], 0
  v_max3_f32 v6, v6, v174, v175
  v_max3_f32 v7, v7, v176, v177
  s_waitcnt vmcnt(0)
  s_barrier
  s_waitcnt lgkmcnt(4)
  v_mfma_f32_16x16x32_bf16 v[124:127], v[52:55], v[8:11], 0
  v_max3_f32 v2, v2, v112, v113
  v_max3_f32 v3, v3, v114, v115
  s_nop 0
  v_mfma_f32_16x16x32_bf16 v[190:193], v[52:55], v[12:15], 0
  v_max3_f32 v6, v6, v178, v179
  v_max3_f32 v7, v7, v180, v181
  v_mfma_f32_16x16x32_bf16 v[128:131], v[56:59], v[8:11], 0
  v_max3_f32 v2, v2, v116, v117
  v_max3_f32 v3, v3, v118, v119
  v_mfma_f32_16x16x32_bf16 v[194:197], v[56:59], v[12:15], 0
  v_max3_f32 v6, v6, v182, v183
  v_max3_f32 v7, v7, v184, v185
  s_waitcnt lgkmcnt(2)
  v_mfma_f32_16x16x32_bf16 v[132:135], v[60:63], v[8:11], 0
  v_max3_f32 v2, v2, v120, v121
  v_max3_f32 v3, v3, v122, v123
  v_mfma_f32_16x16x32_bf16 v[198:201], v[60:63], v[12:15], 0
  v_max3_f32 v6, v6, v186, v187
  v_max3_f32 v7, v7, v188, v189
  s_nop 0
  v_mfma_f32_16x16x32_bf16 v[136:139], v[64:67], v[8:11], 0
  v_max3_f32 v2, v2, v124, v125
  v_max3_f32 v3, v3, v126, v127
  v_mfma_f32_16x16x32_bf16 v[202:205], v[64:67], v[12:15], 0
  v_max3_f32 v6, v6, v190, v191
  v_max3_f32 v7, v7, v192, v193
  s_waitcnt lgkmcnt(0)
  v_mfma_f32_16x16x32_bf16 v[140:143], v[68:71], v[8:11], 0
  s_nop 0
  v_max3_f32 v2, v2, v128, v129
  v_max3_f32 v3, v3, v130, v131
  v_mfma_f32_16x16x32_bf16 v[206:209], v[68:71], v[12:15], 0
  v_max3_f32 v6, v6, v194, v195
  v_max3_f32 v7, v7, v196, v197
  v_mfma_f32_16x16x32_bf16 v[144:147], v[72:75], v[8:11], 0
  v_max3_f32 v2, v2, v132, v133
  v_max3_f32 v3, v3, v134, v135
  v_mfma_f32_16x16x32_bf16 v[210:213], v[72:75], v[12:15], 0
  v_max3_f32 v6, v6, v198, v199
  v_max3_f32 v7, v7, v200, v201
  ds_read_b128 v[28:31], v4 offset:0
  ds_read_b128 v[32:35], v4 offset:1024
  ds_read_b128 v[36:39], v4 offset:2048
  ds_read_b128 v[40:43], v4 offset:3072
  v_max3_f32 v2, v2, v136, v137
  v_max3_f32 v3, v3, v138, v139
  v_max3_f32 v6, v6, v202, v203
  v_max3_f32 v7, v7, v204, v205
  ds_read_b128 v[44:47], v4 offset:4096
  ds_read_b128 v[48:51], v4 offset:5120
  ds_read_b128 v[52:55], v4 offset:6144
  ds_read_b128 v[56:59], v4 offset:7168
  v_max3_f32 v2, v2, v140, v141
  v_max3_f32 v3, v3, v142, v143
  v_max3_f32 v6, v6, v206, v207
  v_max3_f32 v7, v7, v208, v209
  ds_read_b128 v[60:63], v4 offset:8192
  ds_read_b128 v[64:67], v4 offset:9216
  ds_read_b128 v[68:71], v4 offset:10240
  ds_read_b128 v[72:75], v4 offset:11264
  v_max3_f32 v2, v2, v144, v145
  v_max3_f32 v3, v3, v146, v147
  v_max3_f32 v6, v6, v210, v211
  v_max3_f32 v7, v7, v212, v213
Lsdone_2008:
  v_max_f32 v2, v2, v3
  v_max_f32 v6, v6, v7
  v_mov_b32 v3, v2
  v_mov_b32 v7, v6
  s_nop 0
  v_permlane32_swap_b32 v2, v3
  v_permlane32_swap_b32 v6, v7
  s_nop 0
  v_max_f32 v2, v2, v3
  v_max_f32 v6, v6, v7
  v_mov_b32 v3, v2
  v_mov_b32 v7, v6
  s_nop 0
  v_permlane16_swap_b32 v2, v3
  v_permlane16_swap_b32 v6, v7
  s_nop 0
  v_max_f32 v2, v2, v3
  v_max_f32 v6, v6, v7
  v_sub_f32 v234, v234, v2
  v_sub_f32 v236, v236, v6
  v_exp_f32 v234, v234
  v_exp_f32_e64 v236, v236
  s_nop 0
  v_pk_mul_f32 v[238:239], v[238:239], v[234:235] op_sel_hi:[1,0]
  v_pk_mul_f32 v[240:241], v[240:241], v[234:235] op_sel_hi:[1,0]
  v_pk_mul_f32 v[242:243], v[242:243], v[234:235] op_sel_hi:[1,0]
  v_pk_mul_f32 v[244:245], v[244:245], v[234:235] op_sel_hi:[1,0]
  v_pk_mul_f32 v[246:247], v[246:247], v[234:235] op_sel_hi:[1,0]
  v_pk_mul_f32 v[248:249], v[248:249], v[234:235] op_sel_hi:[1,0]
  v_pk_mul_f32 v[156:157], v[156:157], v[236:237] op_sel_hi:[1,0]
  v_pk_mul_f32 v[158:159], v[158:159], v[236:237] op_sel_hi:[1,0]
  v_pk_mul_f32 v[160:161], v[160:161], v[236:237] op_sel_hi:[1,0]
  v_pk_mul_f32 v[162:163], v[162:163], v[236:237] op_sel_hi:[1,0]
  v_pk_mul_f32 v[164:165], v[164:165], v[236:237] op_sel_hi:[1,0]
  v_pk_mul_f32 v[166:167], v[166:167], v[236:237] op_sel_hi:[1,0]
  v_pk_add_f32 v[100:101], v[100:101], v[2:3] op_sel_hi:[1,0] neg_lo:[0,1] neg_hi:[0,1]
  v_pk_add_f32 v[102:103], v[102:103], v[2:3] op_sel_hi:[1,0] neg_lo:[0,1] neg_hi:[0,1]
  v_pk_add_f32 v[104:105], v[104:105], v[2:3] op_sel_hi:[1,0] neg_lo:[0,1] neg_hi:[0,1]
  v_pk_add_f32 v[106:107], v[106:107], v[2:3] op_sel_hi:[1,0] neg_lo:[0,1] neg_hi:[0,1]
  v_exp_f32 v100, v100
  v_exp_f32 v101, v101
  v_exp_f32 v102, v102
  v_exp_f32 v103, v103
  v_exp_f32 v104, v104
  v_exp_f32 v105, v105
  v_exp_f32 v106, v106
  v_exp_f32 v107, v107
  v_cvt_pk_bf16_f32 v100, v100, v101
  v_cvt_pk_bf16_f32 v101, v102, v103
  v_cvt_pk_bf16_f32 v102, v104, v105
  v_cvt_pk_bf16_f32 v103, v106, v107
  v_pk_add_f32 v[108:109], v[108:109], v[2:3] op_sel_hi:[1,0] neg_lo:[0,1] neg_hi:[0,1]
  v_pk_add_f32 v[110:111], v[110:111], v[2:3] op_sel_hi:[1,0] neg_lo:[0,1] neg_hi:[0,1]
  v_pk_add_f32 v[112:113], v[112:113], v[2:3] op_sel_hi:[1,0] neg_lo:[0,1] neg_hi:[0,1]
  v_pk_add_f32 v[114:115], v[114:115], v[2:3] op_sel_hi:[1,0] neg_lo:[0,1] neg_hi:[0,1]
  s_waitcnt lgkmcnt(0)
  v_exp_f32 v108, v108
  v_exp_f32 v109, v109
  v_mfma_f32_16x16x32_bf16 v[238:241], v[28:31], v[100:103], v[238:241]
  v_exp_f32 v110, v110
  v_exp_f32 v111, v111
  v_mfma_f32_16x16x32_bf16 v[242:245], v[32:35], v[100:103], v[242:245]
  v_exp_f32 v112, v112
  v_exp_f32 v113, v113
  v_mfma_f32_16x16x32_bf16 v[246:249], v[24:27], v[100:103], v[246:249]
  v_exp_f32 v114, v114
  v_exp_f32_e64 v115, v115
  v_cvt_pk_bf16_f32 v104, v108, v109
  v_cvt_pk_bf16_f32 v105, v110, v111
  v_cvt_pk_bf16_f32 v106, v112, v113
  v_cvt_pk_bf16_f32 v107, v114, v115
  v_pk_add_f32 v[116:117], v[116:117], v[2:3] op_sel_hi:[1,0] neg_lo:[0,1] neg_hi:[0,1]
  v_pk_add_f32 v[118:119], v[118:119], v[2:3] op_sel_hi:[1,0] neg_lo:[0,1] neg_hi:[0,1]
  v_pk_add_f32 v[120:121], v[120:121], v[2:3] op_sel_hi:[1,0] neg_lo:[0,1] neg_hi:[0,1]
  v_pk_add_f32 v[122:123], v[122:123], v[2:3] op_sel_hi:[1,0] neg_lo:[0,1] neg_hi:[0,1]
  v_exp_f32 v116, v116
  v_exp_f32 v117, v117
  v_mfma_f32_16x16x32_bf16 v[238:241], v[36:39], v[104:107], v[238:241]
  v_exp_f32 v118, v118
  v_exp_f32 v119, v119
  v_mfma_f32_16x16x32_bf16 v[242:245], v[40:43], v[104:107], v[242:245]
  v_exp_f32 v120, v120
  v_exp_f32 v121, v121
  v_mfma_f32_16x16x32_bf16 v[246:249], v[24:27], v[104:107], v[246:249]
  v_exp_f32 v122, v122
  v_exp_f32 v123, v123
  v_cvt_pk_bf16_f32 v108, v116, v117
  v_cvt_pk_bf16_f32 v109, v118, v119
  v_cvt_pk_bf16_f32 v110, v120, v121
  v_cvt_pk_bf16_f32 v111, v122, v123
  v_pk_add_f32 v[124:125], v[124:125], v[2:3] op_sel_hi:[1,0] neg_lo:[0,1] neg_hi:[0,1]
  v_pk_add_f32 v[126:127], v[126:127], v[2:3] op_sel_hi:[1,0] neg_lo:[0,1] neg_hi:[0,1]
  v_pk_add_f32 v[128:129], v[128:129], v[2:3] op_sel_hi:[1,0] neg_lo:[0,1] neg_hi:[0,1]
  v_pk_add_f32 v[130:131], v[130:131], v[2:3] op_sel_hi:[1,0] neg_lo:[0,1] neg_hi:[0,1]
  v_exp_f32 v124, v124
  v_exp_f32 v125, v125
  v_mfma_f32_16x16x32_bf16 v[238:241], v[44:47], v[108:111], v[238:241]
  v_exp_f32 v126, v126
  v_exp_f32 v127, v127
  v_mfma_f32_16x16x32_bf16 v[242:245], v[48:51], v[108:111], v[242:245]
  v_exp_f32 v128, v128
  v_exp_f32 v129, v129
  v_mfma_f32_16x16x32_bf16 v[246:249], v[24:27], v[108:111], v[246:249]
  v_exp_f32 v130, v130
  v_exp_f32 v131, v131
  v_cvt_pk_bf16_f32 v112, v124, v125
  v_cvt_pk_bf16_f32 v113, v126, v127
  v_cvt_pk_bf16_f32 v114, v128, v129
  v_cvt_pk_bf16_f32 v115, v130, v131
  v_pk_add_f32 v[132:133], v[132:133], v[2:3] op_sel_hi:[1,0] neg_lo:[0,1] neg_hi:[0,1]
  v_pk_add_f32 v[134:135], v[134:135], v[2:3] op_sel_hi:[1,0] neg_lo:[0,1] neg_hi:[0,1]
  v_pk_add_f32 v[136:137], v[136:137], v[2:3] op_sel_hi:[1,0] neg_lo:[0,1] neg_hi:[0,1]
  v_pk_add_f32 v[138:139], v[138:139], v[2:3] op_sel_hi:[1,0] neg_lo:[0,1] neg_hi:[0,1]
  v_exp_f32 v132, v132
  v_exp_f32 v133, v133
  v_mfma_f32_16x16x32_bf16 v[238:241], v[52:55], v[112:115], v[238:241]
  v_exp_f32 v134, v134
  v_exp_f32 v135, v135
  v_mfma_f32_16x16x32_bf16 v[242:245], v[56:59], v[112:115], v[242:245]
  v_exp_f32 v136, v136
  v_exp_f32 v137, v137
  v_mfma_f32_16x16x32_bf16 v[246:249], v[24:27], v[112:115], v[246:249]
  v_exp_f32 v138, v138
  v_exp_f32 v139, v139
  v_cvt_pk_bf16_f32 v116, v132, v133
  v_cvt_pk_bf16_f32 v117, v134, v135
  v_cvt_pk_bf16_f32 v118, v136, v137
  v_cvt_pk_bf16_f32 v119, v138, v139
  v_pk_add_f32 v[140:141], v[140:141], v[2:3] op_sel_hi:[1,0] neg_lo:[0,1] neg_hi:[0,1]
  v_pk_add_f32 v[142:143], v[142:143], v[2:3] op_sel_hi:[1,0] neg_lo:[0,1] neg_hi:[0,1]
  v_pk_add_f32 v[144:145], v[144:145], v[2:3] op_sel_hi:[1,0] neg_lo:[0,1] neg_hi:[0,1]
  v_pk_add_f32 v[146:147], v[146:147], v[2:3] op_sel_hi:[1,0] neg_lo:[0,1] neg_hi:[0,1]
  v_exp_f32 v140, v140
  v_exp_f32 v141, v141
  v_mfma_f32_16x16x32_bf16 v[238:241], v[60:63], v[116:119], v[238:241]
  v_exp_f32 v142, v142
  v_exp_f32 v143, v143
  v_mfma_f32_16x16x32_bf16 v[242:245], v[64:67], v[116:119], v[242:245]
  v_exp_f32 v144, v144
  v_exp_f32 v145, v145
  v_mfma_f32_16x16x32_bf16 v[246:249], v[24:27], v[116:119], v[246:249]
  v_exp_f32 v146, v146
  v_exp_f32 v147, v147
  v_cvt_pk_bf16_f32 v120, v140, v141
  v_cvt_pk_bf16_f32 v121, v142, v143
  v_cvt_pk_bf16_f32 v122, v144, v145
  v_cvt_pk_bf16_f32 v123, v146, v147
  v_pk_add_f32 v[170:171], v[170:171], v[6:7] op_sel_hi:[1,0] neg_lo:[0,1] neg_hi:[0,1]
  v_pk_add_f32 v[172:173], v[172:173], v[6:7] op_sel_hi:[1,0] neg_lo:[0,1] neg_hi:[0,1]
  v_exp_f32 v170, v170
  v_exp_f32 v171, v171
  v_mfma_f32_16x16x32_bf16 v[238:241], v[68:71], v[120:123], v[238:241]
  v_exp_f32 v172, v172
  v_exp_f32 v173, v173
  v_mfma_f32_16x16x32_bf16 v[242:245], v[72:75], v[120:123], v[242:245]
  v_mfma_f32_16x16x32_bf16 v[246:249], v[24:27], v[120:123], v[246:249]
  s_nop 0
  v_cvt_pk_bf16_f32 v170, v170, v171
  v_cvt_pk_bf16_f32 v171, v172, v173
  v_pk_add_f32 v[174:175], v[174:175], v[6:7] op_sel_hi:[1,0] neg_lo:[0,1] neg_hi:[0,1]
  v_pk_add_f32 v[176:177], v[176:177], v[6:7] op_sel_hi:[1,0] neg_lo:[0,1] neg_hi:[0,1]
  v_pk_add_f32 v[178:179], v[178:179], v[6:7] op_sel_hi:[1,0] neg_lo:[0,1] neg_hi:[0,1]
  s_nop 0
  v_pk_add_f32 v[180:181], v[180:181], v[6:7] op_sel_hi:[1,0] neg_lo:[0,1] neg_hi:[0,1]
  v_exp_f32 v174, v174
  v_exp_f32 v175, v175
  v_mfma_f32_16x16x32_bf16 v[156:159], v[28:31], v[168:171], v[156:159]
  v_exp_f32 v176, v176
  v_exp_f32 v177, v177
  v_mfma_f32_16x16x32_bf16 v[160:163], v[32:35], v[168:171], v[160:163]
  v_exp_f32 v178, v178
  v_exp_f32 v179, v179
  v_mfma_f32_16x16x32_bf16 v[164:167], v[24:27], v[168:171], v[164:167]
  v_exp_f32 v180, v180
  v_exp_f32 v181, v181
  v_cvt_pk_bf16_f32 v172, v174, v175
  v_cvt_pk_bf16_f32 v173, v176, v177
  v_cvt_pk_bf16_f32 v174, v178, v179
  v_cvt_pk_bf16_f32 v175, v180, v181
  v_pk_add_f32 v[182:183], v[182:183], v[6:7] op_sel_hi:[1,0] neg_lo:[0,1] neg_hi:[0,1]
  v_pk_add_f32 v[184:185], v[184:185], v[6:7] op_sel_hi:[1,0] neg_lo:[0,1] neg_hi:[0,1]
  v_pk_add_f32 v[186:187], v[186:187], v[6:7] op_sel_hi:[1,0] neg_lo:[0,1] neg_hi:[0,1]
  v_pk_add_f32 v[188:189], v[188:189], v[6:7] op_sel_hi:[1,0] neg_lo:[0,1] neg_hi:[0,1]
  v_exp_f32 v182, v182
  v_exp_f32 v183, v183
  v_mfma_f32_16x16x32_bf16 v[156:159], v[36:39], v[172:175], v[156:159]
  v_exp_f32 v184, v184
  v_exp_f32 v185, v185
  v_mfma_f32_16x16x32_bf16 v[160:163], v[40:43], v[172:175], v[160:163]
  v_exp_f32 v186, v186
  v_exp_f32 v187, v187
  v_mfma_f32_16x16x32_bf16 v[164:167], v[24:27], v[172:175], v[164:167]
  v_exp_f32 v188, v188
  v_exp_f32 v189, v189
  v_cvt_pk_bf16_f32 v176, v182, v183
  v_cvt_pk_bf16_f32 v177, v184, v185
  v_cvt_pk_bf16_f32 v178, v186, v187
  v_cvt_pk_bf16_f32 v179, v188, v189
  v_rcp_f32 v2, v246
  s_nop 0
  v_pk_mul_f32 v[238:239], v[238:239], v[2:3] op_sel_hi:[1,0]
  v_pk_mul_f32 v[240:241], v[240:241], v[2:3] op_sel_hi:[1,0]
  v_pk_mul_f32 v[242:243], v[242:243], v[2:3] op_sel_hi:[1,0]
  v_pk_mul_f32 v[244:245], v[244:245], v[2:3] op_sel_hi:[1,0]
  v_cvt_pk_bf16_f32 v136, v238, v239
  v_cvt_pk_bf16_f32 v137, v240, v241
  v_cvt_pk_bf16_f32 v138, v242, v243
  v_cvt_pk_bf16_f32 v139, v244, v245
  buffer_store_dwordx4 v[136:139], v1, s[8:11], s6 offen offset:0 sc1
  s_lshl_b32 s3, s54, 2
  s_add_u32 s3, s3, s55
  s_lshl_b32 s3, s3, 11
  s_add_u32 s3, s3, 147456
  v_add_u32 v3, s3, v1
  ds_write_b128 v3, v[136:139] offset:0
  v_and_b32 v3, 15, v0
  v_lshlrev_b32 v3, 11, v3
  v_bfe_u32 v4, v0, 4, 1
  v_lshl_add_u32 v3, v4, 5, v3
  v_lshrrev_b32 v4, 5, v0
  v_lshl_add_u32 v3, v4, 4, v3
  s_lshl_b32 s3, s48, 18
  s_lshl_b32 s4, s52, 17
  s_add_u32 s3, s3, s4
  s_lshl_b32 s4, s49, 7
  s_add_u32 s3, s3, s4
  s_lshl_b32 s4, s53, 6
  s_add_u32 s3, s3, s4
  buffer_load_dwordx4 v[140:143], v3, s[12:15], s3 offen
  s_add_u32 s3, s3, 32768
  buffer_load_dwordx4 v[144:147], v3, s[12:15], s3 offen
  s_add_u32 s3, s3, 32768
  buffer_load_dwordx4 v[148:151], v3, s[12:15], s3 offen
  s_add_u32 s3, s3, 32768
  buffer_load_dwordx4 v[152:155], v3, s[12:15], s3 offen
  v_pk_add_f32 v[190:191], v[190:191], v[6:7] op_sel_hi:[1,0] neg_lo:[0,1] neg_hi:[0,1]
  v_pk_add_f32 v[192:193], v[192:193], v[6:7] op_sel_hi:[1,0] neg_lo:[0,1] neg_hi:[0,1]
  v_pk_add_f32 v[194:195], v[194:195], v[6:7] op_sel_hi:[1,0] neg_lo:[0,1] neg_hi:[0,1]
  v_pk_add_f32 v[196:197], v[196:197], v[6:7] op_sel_hi:[1,0] neg_lo:[0,1] neg_hi:[0,1]
  v_exp_f32 v190, v190
  v_exp_f32 v191, v191
  v_mfma_f32_16x16x32_bf16 v[156:159], v[44:47], v[176:179], v[156:159]
  v_exp_f32 v192, v192
  v_exp_f32 v193, v193
  v_mfma_f32_16x16x32_bf16 v[160:163], v[48:51], v[176:179], v[160:163]
  v_exp_f32 v194, v194
  v_exp_f32 v195, v195
  v_mfma_f32_16x16x32_bf16 v[164:167], v[24:27], v[176:179], v[164:167]
  v_exp_f32 v196, v196
  v_exp_f32 v197, v197
  v_cvt_pk_bf16_f32 v180, v190, v191
  v_cvt_pk_bf16_f32 v181, v192, v193
  v_cvt_pk_bf16_f32 v182, v194, v195
  v_cvt_pk_bf16_f32 v183, v196, v197
  v_pk_add_f32 v[198:199], v[198:199], v[6:7] op_sel_hi:[1,0] neg_lo:[0,1] neg_hi:[0,1]
  v_pk_add_f32 v[200:201], v[200:201], v[6:7] op_sel_hi:[1,0] neg_lo:[0,1] neg_hi:[0,1]
  v_pk_add_f32 v[202:203], v[202:203], v[6:7] op_sel_hi:[1,0] neg_lo:[0,1] neg_hi:[0,1]
  v_pk_add_f32 v[204:205], v[204:205], v[6:7] op_sel_hi:[1,0] neg_lo:[0,1] neg_hi:[0,1]
  v_exp_f32 v198, v198
  v_exp_f32 v199, v199
  v_mfma_f32_16x16x32_bf16 v[156:159], v[52:55], v[180:183], v[156:159]
  v_exp_f32 v200, v200
  v_exp_f32 v201, v201
  v_mfma_f32_16x16x32_bf16 v[160:163], v[56:59], v[180:183], v[160:163]
  v_exp_f32 v202, v202
  v_exp_f32 v203, v203
  v_mfma_f32_16x16x32_bf16 v[164:167], v[24:27], v[180:183], v[164:167]
  v_exp_f32 v204, v204
  v_exp_f32 v205, v205
  v_cvt_pk_bf16_f32 v184, v198, v199
  v_cvt_pk_bf16_f32 v185, v200, v201
  v_cvt_pk_bf16_f32 v186, v202, v203
  v_cvt_pk_bf16_f32 v187, v204, v205
  v_pk_add_f32 v[206:207], v[206:207], v[6:7] op_sel_hi:[1,0] neg_lo:[0,1] neg_hi:[0,1]
  v_pk_add_f32 v[208:209], v[208:209], v[6:7] op_sel_hi:[1,0] neg_lo:[0,1] neg_hi:[0,1]
  v_pk_add_f32 v[210:211], v[210:211], v[6:7] op_sel_hi:[1,0] neg_lo:[0,1] neg_hi:[0,1]
  v_pk_add_f32 v[212:213], v[212:213], v[6:7] op_sel_hi:[1,0] neg_lo:[0,1] neg_hi:[0,1]
  v_exp_f32 v206, v206
  v_exp_f32 v207, v207
  v_mfma_f32_16x16x32_bf16 v[156:159], v[60:63], v[184:187], v[156:159]
  v_exp_f32 v208, v208
  v_exp_f32 v209, v209
  v_mfma_f32_16x16x32_bf16 v[160:163], v[64:67], v[184:187], v[160:163]
  v_exp_f32 v210, v210
  v_exp_f32 v211, v211
  v_mfma_f32_16x16x32_bf16 v[164:167], v[24:27], v[184:187], v[164:167]
  v_exp_f32 v212, v212
  v_exp_f32_e64 v213, v213
  v_cvt_pk_bf16_f32 v188, v206, v207
  v_cvt_pk_bf16_f32 v189, v208, v209
  v_cvt_pk_bf16_f32 v190, v210, v211
  v_cvt_pk_bf16_f32 v191, v212, v213
  s_nop 1
  v_mfma_f32_16x16x32_bf16 v[156:159], v[68:71], v[188:191], v[156:159]
  v_mfma_f32_16x16x32_bf16 v[160:163], v[72:75], v[188:191], v[160:163]
  v_mfma_f32_16x16x32_bf16 v[164:167], v[24:27], v[188:191], v[164:167]
  s_nop 7
  v_rcp_f32_e64 v2, v164
  s_nop 0
  v_pk_mul_f32 v[156:157], v[156:157], v[2:3] op_sel_hi:[1,0]
  v_pk_mul_f32 v[158:159], v[158:159], v[2:3] op_sel_hi:[1,0]
  v_pk_mul_f32 v[160:161], v[160:161], v[2:3] op_sel_hi:[1,0]
  v_pk_mul_f32 v[162:163], v[162:163], v[2:3] op_sel_hi:[1,0]
  v_cvt_pk_bf16_f32 v210, v156, v157
  v_cvt_pk_bf16_f32 v211, v158, v159
  v_cvt_pk_bf16_f32 v212, v160, v161
  v_cvt_pk_bf16_f32 v213, v162, v163
  buffer_store_dwordx4 v[210:213], v1, s[8:11], s6 offen offset:1024 sc1
  s_lshl_b32 s3, s54, 2
  s_add_u32 s3, s3, s55
  s_lshl_b32 s3, s3, 11
  s_add_u32 s3, s3, 147456
  v_add_u32 v3, s3, v1
  ds_write_b128 v3, v[210:213] offset:1024
  s_waitcnt lgkmcnt(0)
  s_lshl_b32 s3, s48, 14
  s_mul_i32 s4, s49, 0
  s_add_u32 s3, s3, s4
  s_add_u32 s3, s3, 67108992
  v_lshl_add_u32 v3, v0, 10, s3
  v_mov_b32 v2, 1
  s_cmp_eq_u32 s50, 0
  s_cselect_b64 s[64:65], 0xffff, 0
  s_waitcnt vmcnt(0) lgkmcnt(0)
  s_barrier
  s_mov_b64 exec, s[64:65]
  s_cbranch_execz Lsf_2009
  buffer_atomic_add v2, v3, s[8:11], 0 offen sc1
Lsf_2009:
  s_mov_b64 exec, -1
  v_permlane16_swap_b32 v140, v142
  v_permlane16_swap_b32 v141, v143
  v_permlane16_swap_b32 v144, v146
  v_permlane16_swap_b32 v145, v147
  v_permlane16_swap_b32 v148, v150
  v_permlane16_swap_b32 v149, v151
  v_permlane16_swap_b32 v152, v154
  v_permlane16_swap_b32 v153, v155
  v_lshrrev_b32 v3, 4, v0
  v_bfe_u32 v4, v0, 2, 2
  v_and_b32_e64 v5, 1, v3
  v_lshl_add_u32 v5, v5, 2, v4
  v_lshrrev_b32 v6, 1, v3
  v_lshlrev_b32 v6, 10, v6
  v_lshl_add_u32 v6, v5, 7, v6
  v_bfe_u32 v7, v0, 1, 1
  v_lshl_add_u32 v6, v7, 4, v6
  v_and_b32 v7, 1, v0
  v_lshl_add_u32 v6, v7, 3, v6
  v_add_u32 v6, 0, v6
  v_and_b32 v5, 6, v5
  s_lshl_b32 s63, s53, 1
  s_add_u32 s63, s63, 0
  s_mov_b32 s4, s63
  s_lshr_b32 s5, s4, 2
  s_lshl_b32 s5, s5, 11
  s_and_b32 s6, s4, 3
  s_lshl_b32 s6, s6, 1
  v_xor_b32 v7, s6, v5
  v_lshl_add_u32 v97, v7, 4, v6
  v_add_u32 v97, s5, v97
  v_add_u32 v99, 65536, v97
  s_lshl_b32 s63, s53, 1
  s_add_u32 s63, s63, 1
  s_mov_b32 s4, s63
  s_lshr_b32 s5, s4, 2
  s_lshl_b32 s5, s5, 11
  s_and_b32 s6, s4, 3
  s_lshl_b32 s6, s6, 1
  v_xor_b32 v7, s6, v5
  v_lshl_add_u32 v98, v7, 4, v6
  v_add_u32 v98, s5, v98
  v_add_u32 v100, 65536, v98
  s_lshl_b32 s63, s52, 2
  s_lshl_b32 s3, s63, 10
  s_add_u32 s3, s3, 98304
  v_add_u32 v96, s3, v1
  v_lshrrev_b32_e64 v3, 4, v0
  v_bfe_u32 v4, v0, 2, 2
  v_and_b32 v5, 1, v3
  v_lshl_add_u32 v5, v5, 2, v4
  v_lshrrev_b32 v6, 1, v3
  v_lshlrev_b32 v6, 10, v6
  v_lshl_add_u32 v6, v5, 7, v6
  v_bfe_u32 v7, v0, 1, 1
  v_lshl_add_u32 v6, v7, 4, v6
  v_and_b32 v7, 1, v0
  v_lshl_add_u32 v6, v7, 3, v6
  v_add_u32 v6, 49152, v6
  v_and_b32 v5, 6, v5
  v_lshl_add_u32 v8, v3, 2, v4
  v_lshlrev_b32 v9, 6, v8
  v_bfe_u32 v7, v0, 1, 1
  v_lshl_add_u32 v9, v7, 4, v9
  v_and_b32 v7, 1, v0
  v_lshl_add_u32 v9, v7, 3, v9
  v_add_u32 v9, 55296, v9
  v_lshrrev_b32 v8, 1, v8
  v_and_b32 v8, 2, v8
  s_lshl_b32 s63, s53, 3
  s_add_u32 s63, s63, 0
  s_and_b32 s3, s49, 1
  s_lshl_b32 s3, s3, 1
  s_sub_u32 s4, s63, s3
  s_lshr_b32 s5, s4, 2
  s_lshl_b32 s5, s5, 11
  s_and_b32 s6, s4, 3
  s_lshl_b32 s6, s6, 1
  v_xor_b32 v7, s6, v5
  v_lshl_add_u32 v213, v7, 4, v6
  v_add_u32 v213, s5, v213
  s_and_b32 s3, s63, 1
  s_lshl_b32 s3, s3, 1
  s_cmp_ge_u32 s4, 12
  s_cselect_b64 vcc, -1, 0
  v_xor_b32 v7, s3, v8
  v_lshl_add_u32 v7, v7, 4, v9
  v_cndmask_b32 v213, v213, v7, vcc
  v_add_u32 v220, 57344, v213
  s_lshl_b32 s63, s53, 3
  s_add_u32 s63, s63, 1
  s_and_b32 s3, s49, 1
  s_lshl_b32 s3, s3, 1
  s_sub_u32 s4, s63, s3
  s_lshr_b32 s5, s4, 2
  s_lshl_b32 s5, s5, 11
  s_and_b32 s6, s4, 3
  s_lshl_b32 s6, s6, 1
  v_xor_b32 v7, s6, v5
  v_lshl_add_u32 v214, v7, 4, v6
  v_add_u32 v214, s5, v214
  s_and_b32 s3, s63, 1
  s_lshl_b32 s3, s3, 1
  s_cmp_ge_u32 s4, 12
  s_cselect_b64 vcc, -1, 0
  v_xor_b32 v7, s3, v8
  v_lshl_add_u32 v7, v7, 4, v9
  v_cndmask_b32 v214, v214, v7, vcc
  v_add_u32 v221, 57344, v214
  s_lshl_b32 s63, s53, 3
  s_add_u32 s63, s63, 2
  s_and_b32 s3, s49, 1
  s_lshl_b32 s3, s3, 1
  s_sub_u32 s4, s63, s3
  s_lshr_b32 s5, s4, 2
  s_lshl_b32 s5, s5, 11
  s_and_b32 s6, s4, 3
  s_lshl_b32 s6, s6, 1
  v_xor_b32 v7, s6, v5
  v_lshl_add_u32 v215, v7, 4, v6
  v_add_u32 v215, s5, v215
  s_and_b32 s3, s63, 1
  s_lshl_b32 s3, s3, 1
  s_cmp_ge_u32 s4, 12
  s_cselect_b64 vcc, -1, 0
  v_xor_b32 v7, s3, v8
  v_lshl_add_u32 v7, v7, 4, v9
  v_cndmask_b32 v215, v215, v7, vcc
  v_add_u32 v222, 57344, v215
  s_lshl_b32 s63, s53, 3
  s_add_u32 s63, s63, 3
  s_and_b32 s3, s49, 1
  s_lshl_b32 s3, s3, 1
  s_sub_u32 s4, s63, s3
  s_lshr_b32 s5, s4, 2
  s_lshl_b32 s5, s5, 11
  s_and_b32 s6, s4, 3
  s_lshl_b32 s6, s6, 1
  v_xor_b32 v7, s6, v5
  v_lshl_add_u32 v216, v7, 4, v6
  v_add_u32 v216, s5, v216
  s_and_b32 s3, s63, 1
  s_lshl_b32 s3, s3, 1
  s_cmp_ge_u32 s4, 12
  s_cselect_b64 vcc, -1, 0
  v_xor_b32 v7, s3, v8
  v_lshl_add_u32 v7, v7, 4, v9
  v_cndmask_b32 v216, v216, v7, vcc
  v_add_u32 v223, 57344, v216
  s_lshl_b32 s63, s53, 3
  s_add_u32 s63, s63, 4
  s_and_b32 s3, s49, 1
  s_lshl_b32 s3, s3, 1
  s_sub_u32 s4, s63, s3
  s_lshr_b32 s5, s4, 2
  s_lshl_b32 s5, s5, 11
  s_and_b32 s6, s4, 3
  s_lshl_b32 s6, s6, 1
  v_xor_b32 v7, s6, v5
  v_lshl_add_u32 v217, v7, 4, v6
  v_add_u32 v217, s5, v217
  s_and_b32 s3, s63, 1
  s_lshl_b32 s3, s3, 1
  s_cmp_ge_u32 s4, 12
  s_cselect_b64 vcc, -1, 0
  v_xor_b32_e64 v7, s3, v8
  v_lshl_add_u32 v7, v7, 4, v9
  v_cndmask_b32 v217, v217, v7, vcc
  v_add_u32 v224, 57344, v217
  s_lshl_b32 s63, s53, 3
  s_add_u32 s63, s63, 5
  s_and_b32 s3, s49, 1
  s_lshl_b32 s3, s3, 1
  s_sub_u32 s4, s63, s3
  s_lshr_b32 s5, s4, 2
  s_lshl_b32 s5, s5, 11
  s_and_b32 s6, s4, 3
  s_lshl_b32 s6, s6, 1
  v_xor_b32_e64 v7, s6, v5
  v_lshl_add_u32 v218, v7, 4, v6
  v_add_u32 v218, s5, v218
  s_and_b32 s3, s63, 1
  s_lshl_b32 s3, s3, 1
  s_cmp_ge_u32 s4, 12
  s_cselect_b64 vcc, -1, 0
  v_xor_b32 v7, s3, v8
  v_lshl_add_u32 v7, v7, 4, v9
  v_cndmask_b32 v218, v218, v7, vcc
  v_add_u32 v225, 57344, v218
  s_lshl_b32 s63, s53, 0
  s_add_u32 s63, s63, 6
  s_and_b32 s3, s49, 1
  s_lshl_b32 s3, s3, 1
  s_sub_u32 s4, s63, s3
  s_lshr_b32 s5, s4, 2
  s_lshl_b32 s5, s5, 11
  s_and_b32 s6, s4, 3
  s_lshl_b32 s6, s6, 1
  v_xor_b32 v7, s6, v5
  v_lshl_add_u32 v219, v7, 4, v6
  v_add_u32 v219, s5, v219
  s_and_b32 s3, s63, 1
  s_lshl_b32 s3, s3, 1
  s_cmp_ge_u32 s4, 12
  s_cselect_b64 vcc, -1, 0
  v_xor_b32_e64 v7, s3, v8
  v_lshl_add_u32 v7, v7, 4, v9
  v_cndmask_b32 v219, v219, v7, vcc
  v_add_u32 v226, 57344, v219
  s_lshl_b32 s63, s52, 2
  s_lshl_b32 s3, s63, 10
  s_add_u32 s3, s3, 0
  v_add_u32 v212, s3, v1
  v_and_b32 v3, 15, v0
  v_lshrrev_b32 v4, 4, v0
  s_lshl_b32 s3, s52, 8
  s_add_u32 s3, s3, 77824
  v_lshl_add_u32 v10, v3, 2, s3
  s_lshl_b32 s3, s53, 9
  s_add_u32 s3, s3, 78848
  v_lshl_add_u32 v11, v4, 4, s3
  s_lshl_b32 s3, s53, 6
  s_add_u32 s3, s3, 78848
  v_lshl_add_u32 v9, v4, 4, s3
  s_cmp_lg_u32 s50, 0
  s_cbranch_scc1 Lsg_2010
  s_lshl_b32 s3, s49, 10
  s_lshl_b32 s4, s48, 2
  s_add_u32 s3, s3, s4
  s_nop 0
  s_add_u32 s3, s3, 67109632
  v_lshl_add_u32 v3, v0, 14, s3
  v_mov_b32 v2, 1
  s_mov_b64 exec, 0xffff
  buffer_store_dword v2, v3, s[8:11], 0 offen sc1
  s_mov_b64 exec, -1
Lsg_2010:
  s_lshl_b32 s3, s48, 4
  s_add_u32 s3, s3, s49
  s_lshl_b32 s3, s3, 1
  s_add_u32 s3, s3, s53
  s_lshl_b32 s3, s3, 1
  s_add_u32 s3, s3, s52
  s_lshl_b32 s3, s3, 12
  s_add_u32 s3, s3, 20971520
  s_lshl_b32 s4, s53, 1
  s_add_u32 s4, s4, s52
  s_lshl_b32 s4, s4, 12
  v_add_u32 v3, s4, v1
  s_mov_b32 s54, 0
  ds_read_b128 v[48:51], v96 offset:49152
  ds_read_b64_tr_b16 v[64:65], v97 offset:0
  ds_read_b64_tr_b16 v[66:67], v97 offset:2048
  ds_read_b128 v[52:55], v96 offset:50176
  ds_read_b128 v[56:59], v96 offset:51200
  ds_read_b128 v[60:63], v96 offset:52224
  ds_read_b64_tr_b16 v[68:69], v98 offset:0
  ds_read_b64_tr_b16 v[70:71], v98 offset:2048
  s_waitcnt lgkmcnt(0)
  v_mfma_f32_16x16x32_bf16 v[16:19], v[64:67], v[48:51], 0
  ds_read_b128 v[72:75], v96 offset:57344
  v_mfma_f32_16x16x32_bf16 v[20:23], v[64:67], v[52:55], 0
  s_nop 0
  ds_read_b64_tr_b16 v[88:89], v97 offset:4096
  v_mfma_f32_16x16x32_bf16 v[24:27], v[64:67], v[56:59], 0
  ds_read_b64_tr_b16 v[90:91], v97 offset:6144
  v_mfma_f32_16x16x32_bf16 v[28:31], v[64:67], v[60:63], 0
  ds_read_b128 v[76:79], v96 offset:58368
  v_mfma_f32_16x16x32_bf16 v[44:47], v[68:71], v[60:63], 0
  ds_read_b128 v[80:83], v96 offset:59392
  v_mfma_f32_16x16x32_bf16 v[40:43], v[68:71], v[56:59], 0
  ds_read_b128 v[84:87], v96 offset:60416
  v_mfma_f32_16x16x32_bf16 v[36:39], v[68:71], v[52:55], 0
  ds_read_b64_tr_b16 v[92:93], v98 offset:4096
  v_mfma_f32_16x16x32_bf16 v[32:35], v[68:71], v[48:51], 0
  ds_read_b64_tr_b16 v[94:95], v98 offset:6144
  s_waitcnt lgkmcnt(0)
  s_barrier
  v_mfma_f32_16x16x32_bf16 v[16:19], v[88:91], v[72:75], v[16:19]
  ds_read_b128 v[48:51], v96 offset:0
  v_mfma_f32_16x16x32_bf16 v[20:23], v[88:91], v[76:79], v[20:23]
  ds_read_b64_tr_b16 v[64:65], v97 offset:8192
  v_mfma_f32_16x16x32_bf16 v[24:27], v[88:91], v[80:83], v[24:27]
  ds_read_b64_tr_b16 v[66:67], v97 offset:10240
  v_mfma_f32_16x16x32_bf16 v[28:31], v[88:91], v[84:87], v[28:31]
  ds_read_b128 v[52:55], v96 offset:1024
  v_mfma_f32_16x16x32_bf16 v[44:47], v[92:95], v[84:87], v[44:47]
  ds_read_b128 v[56:59], v96 offset:2048
  v_mfma_f32_16x16x32_bf16 v[40:43], v[92:95], v[80:83], v[40:43]
  ds_read_b128 v[60:63], v96 offset:3072
  v_mfma_f32_16x16x32_bf16 v[36:39], v[92:95], v[76:79], v[36:39]
  ds_read_b64_tr_b16 v[68:69], v98 offset:8192
  v_mfma_f32_16x16x32_bf16 v[32:35], v[92:95], v[72:75], v[32:35]
  ds_read_b64_tr_b16 v[70:71], v98 offset:10240
  s_waitcnt lgkmcnt(0)
  v_mfma_f32_16x16x32_bf16 v[16:19], v[64:67], v[48:51], v[16:19]
  s_nop 0
  ds_read_b128 v[72:75], v96 offset:8192
  v_mfma_f32_16x16x32_bf16 v[20:23], v[64:67], v[52:55], v[20:23]
  ds_read_b64_tr_b16 v[88:89], v97 offset:12288
  v_mfma_f32_16x16x32_bf16 v[24:27], v[64:67], v[56:59], v[24:27]
  ds_read_b64_tr_b16 v[90:91], v97 offset:14336
  v_mfma_f32_16x16x32_bf16 v[28:31], v[64:67], v[60:63], v[28:31]
  ds_read_b128 v[76:79], v96 offset:9216
  v_mfma_f32_16x16x32_bf16 v[44:47], v[68:71], v[60:63], v[44:47]
  ds_read_b128 v[80:83], v96 offset:10240
  v_mfma_f32_16x16x32_bf16 v[40:43], v[68:71], v[56:59], v[40:43]
  ds_read_b128 v[84:87], v96 offset:11264
  v_mfma_f32_16x16x32_bf16 v[36:39], v[68:71], v[52:55], v[36:39]
  ds_read_b64_tr_b16 v[92:93], v98 offset:12288
  v_mfma_f32_16x16x32_bf16 v[32:35], v[68:71], v[48:51], v[32:35]
  ds_read_b64_tr_b16 v[94:95], v98 offset:14336
  s_waitcnt lgkmcnt(0)
  s_barrier
  v_mfma_f32_16x16x32_bf16 v[16:19], v[88:91], v[72:75], v[16:19]
  ds_read_b128 v[48:51], v96 offset:16384
  v_mfma_f32_16x16x32_bf16 v[20:23], v[88:91], v[76:79], v[20:23]
  ds_read_b64_tr_b16 v[64:65], v97 offset:16384
  v_mfma_f32_16x16x32_bf16 v[24:27], v[88:91], v[80:83], v[24:27]
  ds_read_b64_tr_b16 v[66:67], v97 offset:18432
  v_mfma_f32_16x16x32_bf16 v[28:31], v[88:91], v[84:87], v[28:31]
  ds_read_b128 v[52:55], v96 offset:17408
  v_mfma_f32_16x16x32_bf16 v[44:47], v[92:95], v[84:87], v[44:47]
  ds_read_b128 v[56:59], v96 offset:18432
  v_mfma_f32_16x16x32_bf16 v[40:43], v[92:95], v[80:83], v[40:43]
  ds_read_b128 v[60:63], v96 offset:19456
  v_mfma_f32_16x16x32_bf16 v[36:39], v[92:95], v[76:79], v[36:39]
  ds_read_b64_tr_b16 v[68:69], v98 offset:16384
  v_mfma_f32_16x16x32_bf16 v[32:35], v[92:95], v[72:75], v[32:35]
  ds_read_b64_tr_b16 v[70:71], v98 offset:18432
  s_waitcnt lgkmcnt(0)
  v_mfma_f32_16x16x32_bf16 v[16:19], v[64:67], v[48:51], v[16:19]
  ds_read_b128 v[72:75], v96 offset:24576
  v_mfma_f32_16x16x32_bf16 v[20:23], v[64:67], v[52:55], v[20:23]
  ds_read_b64_tr_b16 v[88:89], v97 offset:20480
  v_mfma_f32_16x16x32_bf16 v[24:27], v[64:67], v[56:59], v[24:27]
  ds_read_b64_tr_b16 v[90:91], v97 offset:22528
  v_mfma_f32_16x16x32_bf16 v[28:31], v[64:67], v[60:63], v[28:31]
  s_nop 0
  ds_read_b128 v[76:79], v96 offset:25600
  v_mfma_f32_16x16x32_bf16 v[44:47], v[68:71], v[60:63], v[44:47]
  ds_read_b128 v[80:83], v96 offset:26624
  v_mfma_f32_16x16x32_bf16 v[40:43], v[68:71], v[56:59], v[40:43]
  ds_read_b128 v[84:87], v96 offset:27648
  v_mfma_f32_16x16x32_bf16 v[36:39], v[68:71], v[52:55], v[36:39]
  ds_read_b64_tr_b16 v[92:93], v98 offset:20480
  v_mfma_f32_16x16x32_bf16 v[32:35], v[68:71], v[48:51], v[32:35]
  ds_read_b64_tr_b16 v[94:95], v98 offset:22528
  s_waitcnt lgkmcnt(0)
  s_barrier
  v_mfma_f32_16x16x32_bf16 v[16:19], v[88:91], v[72:75], v[16:19]
  ds_read_b128 v[48:51], v96 offset:32768
  v_mfma_f32_16x16x32_bf16 v[20:23], v[88:91], v[76:79], v[20:23]
  ds_read_b64_tr_b16 v[64:65], v97 offset:24576
  v_mfma_f32_16x16x32_bf16 v[24:27], v[88:91], v[80:83], v[24:27]
  ds_read_b64_tr_b16 v[66:67], v97 offset:26624
  v_mfma_f32_16x16x32_bf16 v[28:31], v[88:91], v[84:87], v[28:31]
  ds_read_b128 v[52:55], v96 offset:33792
  v_mfma_f32_16x16x32_bf16 v[44:47], v[92:95], v[84:87], v[44:47]
  ds_read_b128 v[56:59], v96 offset:34816
  v_mfma_f32_16x16x32_bf16 v[40:43], v[92:95], v[80:83], v[40:43]
  ds_read_b128 v[60:63], v96 offset:35840
  v_mfma_f32_16x16x32_bf16 v[36:39], v[92:95], v[76:79], v[36:39]
  ds_read_b64_tr_b16 v[68:69], v98 offset:24576
  v_mfma_f32_16x16x32_bf16 v[32:35], v[92:95], v[72:75], v[32:35]
  ds_read_b64_tr_b16 v[70:71], v98 offset:26624
  s_waitcnt lgkmcnt(0)
  v_mfma_f32_16x16x32_bf16 v[16:19], v[64:67], v[48:51], v[16:19]
  ds_read_b128 v[72:75], v96 offset:40960
  v_mfma_f32_16x16x32_bf16 v[20:23], v[64:67], v[52:55], v[20:23]
  ds_read_b64_tr_b16 v[88:89], v97 offset:28672
  v_mfma_f32_16x16x32_bf16 v[24:27], v[64:67], v[56:59], v[24:27]
  s_nop 0
  ds_read_b64_tr_b16 v[90:91], v97 offset:30720
  v_mfma_f32_16x16x32_bf16 v[28:31], v[64:67], v[60:63], v[28:31]
  ds_read_b128 v[76:79], v96 offset:41984
  v_mfma_f32_16x16x32_bf16 v[44:47], v[68:71], v[60:63], v[44:47]
  ds_read_b128 v[80:83], v96 offset:43008
  v_mfma_f32_16x16x32_bf16 v[40:43], v[68:71], v[56:59], v[40:43]
  ds_read_b128 v[84:87], v96 offset:44032
  v_mfma_f32_16x16x32_bf16 v[36:39], v[68:71], v[52:55], v[36:39]
  ds_read_b64_tr_b16 v[92:93], v98 offset:28672
  v_mfma_f32_16x16x32_bf16 v[32:35], v[68:71], v[48:51], v[32:35]
  ds_read_b64_tr_b16 v[94:95], v98 offset:30720
  s_waitcnt lgkmcnt(0)
  s_barrier
  v_mfma_f32_16x16x32_bf16 v[16:19], v[88:91], v[72:75], v[16:19]
  ds_read_b128 v[48:51], v96 offset:49152
  v_mfma_f32_16x16x32_bf16 v[20:23], v[88:91], v[76:79], v[20:23]
  ds_read_b64_tr_b16 v[64:65], v97 offset:32768
  v_mfma_f32_16x16x32_bf16 v[24:27], v[88:91], v[80:83], v[24:27]
  ds_read_b64_tr_b16 v[66:67], v97 offset:34816
  v_mfma_f32_16x16x32_bf16 v[28:31], v[88:91], v[84:87], v[28:31]
  ds_read_b128 v[52:55], v96 offset:50176
  v_mfma_f32_16x16x32_bf16 v[44:47], v[92:95], v[84:87], v[44:47]
  ds_read_b128 v[56:59], v96 offset:51200
  v_mfma_f32_16x16x32_bf16 v[40:43], v[92:95], v[80:83], v[40:43]
  ds_read_b128 v[60:63], v96 offset:52224
  v_mfma_f32_16x16x32_bf16 v[36:39], v[92:95], v[76:79], v[36:39]
  ds_read_b64_tr_b16 v[68:69], v98 offset:32768
  v_mfma_f32_16x16x32_bf16 v[32:35], v[92:95], v[72:75], v[32:35]
  ds_read_b64_tr_b16 v[70:71], v98 offset:34816
  s_waitcnt lgkmcnt(0)
  v_mfma_f32_16x16x32_bf16 v[16:19], v[64:67], v[48:51], v[16:19]
  ds_read_b128 v[72:75], v96 offset:57344
  v_mfma_f32_16x16x32_bf16 v[20:23], v[64:67], v[52:55], v[20:23]
  s_nop 0
  ds_read_b64_tr_b16 v[88:89], v97 offset:36864
  v_mfma_f32_16x16x32_bf16 v[24:27], v[64:67], v[56:59], v[24:27]
  ds_read_b64_tr_b16 v[90:91], v97 offset:38912
  v_mfma_f32_16x16x32_bf16 v[28:31], v[64:67], v[60:63], v[28:31]
  ds_read_b128 v[76:79], v96 offset:58368
  v_mfma_f32_16x16x32_bf16 v[44:47], v[68:71], v[60:63], v[44:47]
  ds_read_b128 v[80:83], v96 offset:59392
  v_mfma_f32_16x16x32_bf16 v[40:43], v[68:71], v[56:59], v[40:43]
  ds_read_b128 v[84:87], v96 offset:60416
  v_mfma_f32_16x16x32_bf16 v[36:39], v[68:71], v[52:55], v[36:39]
  ds_read_b64_tr_b16 v[92:93], v98 offset:36864
  v_mfma_f32_16x16x32_bf16 v[32:35], v[68:71], v[48:51], v[32:35]
  ds_read_b64_tr_b16 v[94:95], v98 offset:38912
  s_waitcnt lgkmcnt(0)
  s_barrier
  v_mfma_f32_16x16x32_bf16 v[16:19], v[88:91], v[72:75], v[16:19]
  ds_read_b128 v[48:51], v96 offset:0
  v_mfma_f32_16x16x32_bf16 v[20:23], v[88:91], v[76:79], v[20:23]
  ds_read_b64_tr_b16 v[64:65], v97 offset:40960
  v_mfma_f32_16x16x32_bf16 v[24:27], v[88:91], v[80:83], v[24:27]
  ds_read_b64_tr_b16 v[66:67], v97 offset:43008
  v_mfma_f32_16x16x32_bf16 v[28:31], v[88:91], v[84:87], v[28:31]
  ds_read_b128 v[52:55], v96 offset:1024
  v_mfma_f32_16x16x32_bf16 v[44:47], v[92:95], v[84:87], v[44:47]
  ds_read_b128 v[56:59], v96 offset:2048
  v_mfma_f32_16x16x32_bf16 v[40:43], v[92:95], v[80:83], v[40:43]
  ds_read_b128 v[60:63], v96 offset:3072
  v_mfma_f32_16x16x32_bf16 v[36:39], v[92:95], v[76:79], v[36:39]
  ds_read_b64_tr_b16 v[68:69], v98 offset:40960
  v_mfma_f32_16x16x32_bf16 v[32:35], v[92:95], v[72:75], v[32:35]
  ds_read_b64_tr_b16 v[70:71], v98 offset:43008
  s_waitcnt lgkmcnt(0)
  v_mfma_f32_16x16x32_bf16 v[16:19], v[64:67], v[48:51], v[16:19]
  s_nop 0
  ds_read_b128 v[72:75], v96 offset:8192
  v_mfma_f32_16x16x32_bf16 v[20:23], v[64:67], v[52:55], v[20:23]
  ds_read_b64_tr_b16 v[88:89], v97 offset:45056
  v_mfma_f32_16x16x32_bf16 v[24:27], v[64:67], v[56:59], v[24:27]
  ds_read_b64_tr_b16 v[90:91], v97 offset:47104
  v_mfma_f32_16x16x32_bf16 v[28:31], v[64:67], v[60:63], v[28:31]
  ds_read_b128 v[76:79], v96 offset:9216
  v_mfma_f32_16x16x32_bf16 v[44:47], v[68:71], v[60:63], v[44:47]
  ds_read_b128 v[80:83], v96 offset:10240
  v_mfma_f32_16x16x32_bf16 v[40:43], v[68:71], v[56:59], v[40:43]
  ds_read_b128 v[84:87], v96 offset:11264
  v_mfma_f32_16x16x32_bf16 v[36:39], v[68:71], v[52:55], v[36:39]
  ds_read_b64_tr_b16 v[92:93], v98 offset:45056
  v_mfma_f32_16x16x32_bf16 v[32:35], v[68:71], v[48:51], v[32:35]
  ds_read_b64_tr_b16 v[94:95], v98 offset:47104
  s_waitcnt lgkmcnt(0)
  s_barrier
  v_mfma_f32_16x16x32_bf16 v[16:19], v[88:91], v[72:75], v[16:19]
  ds_read_b128 v[48:51], v96 offset:16384
  v_mfma_f32_16x16x32_bf16 v[20:23], v[88:91], v[76:79], v[20:23]
  ds_read_b64_tr_b16 v[64:65], v97 offset:49152
  v_mfma_f32_16x16x32_bf16 v[24:27], v[88:91], v[80:83], v[24:27]
  ds_read_b64_tr_b16 v[66:67], v97 offset:51200
  v_mfma_f32_16x16x32_bf16 v[28:31], v[88:91], v[84:87], v[28:31]
  ds_read_b128 v[52:55], v96 offset:17408
  v_mfma_f32_16x16x32_bf16 v[44:47], v[92:95], v[84:87], v[44:47]
  ds_read_b128 v[56:59], v96 offset:18432
  v_mfma_f32_16x16x32_bf16 v[40:43], v[92:95], v[80:83], v[40:43]
  ds_read_b128 v[60:63], v96 offset:19456
  v_mfma_f32_16x16x32_bf16 v[36:39], v[92:95], v[76:79], v[36:39]
  ds_read_b64_tr_b16 v[68:69], v98 offset:49152
  v_mfma_f32_16x16x32_bf16 v[32:35], v[92:95], v[72:75], v[32:35]
  ds_read_b64_tr_b16 v[70:71], v98 offset:51200
  s_waitcnt lgkmcnt(0)
  v_mfma_f32_16x16x32_bf16 v[16:19], v[64:67], v[48:51], v[16:19]
  ds_read_b128 v[72:75], v96 offset:24576
  v_mfma_f32_16x16x32_bf16 v[20:23], v[64:67], v[52:55], v[20:23]
  ds_read_b64_tr_b16 v[88:89], v97 offset:53248
  v_mfma_f32_16x16x32_bf16 v[24:27], v[64:67], v[56:59], v[24:27]
  ds_read_b64_tr_b16 v[90:91], v97 offset:55296
  v_mfma_f32_16x16x32_bf16 v[28:31], v[64:67], v[60:63], v[28:31]
  s_nop 0
  ds_read_b128 v[76:79], v96 offset:25600
  v_mfma_f32_16x16x32_bf16 v[44:47], v[68:71], v[60:63], v[44:47]
  ds_read_b128 v[80:83], v96 offset:26624
  v_mfma_f32_16x16x32_bf16 v[40:43], v[68:71], v[56:59], v[40:43]
  ds_read_b128 v[84:87], v96 offset:27648
  v_mfma_f32_16x16x32_bf16 v[36:39], v[68:71], v[52:55], v[36:39]
  ds_read_b64_tr_b16 v[92:93], v98 offset:53248
  v_mfma_f32_16x16x32_bf16 v[32:35], v[68:71], v[48:51], v[32:35]
  ds_read_b64_tr_b16 v[94:95], v98 offset:55296
  s_waitcnt lgkmcnt(0)
  s_barrier
  v_mfma_f32_16x16x32_bf16 v[16:19], v[88:91], v[72:75], v[16:19]
  ds_read_b128 v[48:51], v96 offset:32768
  v_mfma_f32_16x16x32_bf16 v[20:23], v[88:91], v[76:79], v[20:23]
  ds_read_b64_tr_b16 v[64:65], v97 offset:57344
  v_mfma_f32_16x16x32_bf16 v[24:27], v[88:91], v[80:83], v[24:27]
  ds_read_b64_tr_b16 v[66:67], v97 offset:59392
  v_mfma_f32_16x16x32_bf16 v[28:31], v[88:91], v[84:87], v[28:31]
  ds_read_b128 v[52:55], v96 offset:33792
  v_mfma_f32_16x16x32_bf16 v[44:47], v[92:95], v[84:87], v[44:47]
  ds_read_b128 v[56:59], v96 offset:34816
  v_mfma_f32_16x16x32_bf16 v[40:43], v[92:95], v[80:83], v[40:43]
  ds_read_b128 v[60:63], v96 offset:35840
  v_mfma_f32_16x16x32_bf16 v[36:39], v[92:95], v[76:79], v[36:39]
  ds_read_b64_tr_b16 v[68:69], v98 offset:57344
  v_mfma_f32_16x16x32_bf16 v[32:35], v[92:95], v[72:75], v[32:35]
  ds_read_b64_tr_b16 v[70:71], v98 offset:59392
  s_waitcnt lgkmcnt(0)
  v_mfma_f32_16x16x32_bf16 v[16:19], v[64:67], v[48:51], v[16:19]
  ds_read_b128 v[72:75], v96 offset:40960
  v_mfma_f32_16x16x32_bf16 v[20:23], v[64:67], v[52:55], v[20:23]
  ds_read_b64_tr_b16 v[88:89], v97 offset:61440
  v_mfma_f32_16x16x32_bf16 v[24:27], v[64:67], v[56:59], v[24:27]
  s_nop 0
  ds_read_b64_tr_b16 v[90:91], v97 offset:63488
  v_mfma_f32_16x16x32_bf16 v[28:31], v[64:67], v[60:63], v[28:31]
  ds_read_b128 v[76:79], v96 offset:41984
  v_mfma_f32_16x16x32_bf16 v[44:47], v[68:71], v[60:63], v[44:47]
  ds_read_b128 v[80:83], v96 offset:43008
  v_mfma_f32_16x16x32_bf16 v[40:43], v[68:71], v[56:59], v[40:43]
  ds_read_b128 v[84:87], v96 offset:44032
  v_mfma_f32_16x16x32_bf16 v[36:39], v[68:71], v[52:55], v[36:39]
  ds_read_b64_tr_b16 v[92:93], v98 offset:61440
  v_mfma_f32_16x16x32_bf16 v[32:35], v[68:71], v[48:51], v[32:35]
  ds_read_b64_tr_b16 v[94:95], v98 offset:63488
  s_waitcnt lgkmcnt(0)
  s_barrier
  v_mfma_f32_16x16x32_bf16 v[16:19], v[88:91], v[72:75], v[16:19]
  ds_read_b128 v[48:51], v96 offset:49152
  v_mfma_f32_16x16x32_bf16 v[20:23], v[88:91], v[76:79], v[20:23]
  ds_read_b64_tr_b16 v[64:65], v99 offset:0
  v_mfma_f32_16x16x32_bf16 v[24:27], v[88:91], v[80:83], v[24:27]
  ds_read_b64_tr_b16 v[66:67], v99 offset:2048
  v_mfma_f32_16x16x32_bf16 v[28:31], v[88:91], v[84:87], v[28:31]
  ds_read_b128 v[52:55], v96 offset:50176
  v_mfma_f32_16x16x32_bf16 v[44:47], v[92:95], v[84:87], v[44:47]
  ds_read_b128 v[56:59], v96 offset:51200
  v_mfma_f32_16x16x32_bf16 v[40:43], v[92:95], v[80:83], v[40:43]
  ds_read_b128 v[60:63], v96 offset:52224
  v_mfma_f32_16x16x32_bf16 v[36:39], v[92:95], v[76:79], v[36:39]
  ds_read_b64_tr_b16 v[68:69], v100 offset:0
  v_mfma_f32_16x16x32_bf16 v[32:35], v[92:95], v[72:75], v[32:35]
  ds_read_b64_tr_b16 v[70:71], v100 offset:2048
  s_waitcnt lgkmcnt(0)
  v_mfma_f32_16x16x32_bf16 v[16:19], v[64:67], v[48:51], v[16:19]
  ds_read_b128 v[72:75], v96 offset:57344
  v_mfma_f32_16x16x32_bf16 v[20:23], v[64:67], v[52:55], v[20:23]
  s_nop 0
  ds_read_b64_tr_b16 v[88:89], v99 offset:4096
  v_mfma_f32_16x16x32_bf16 v[24:27], v[64:67], v[56:59], v[24:27]
  ds_read_b64_tr_b16 v[90:91], v99 offset:6144
  v_mfma_f32_16x16x32_bf16 v[28:31], v[64:67], v[60:63], v[28:31]
  ds_read_b128 v[76:79], v96 offset:58368
  v_mfma_f32_16x16x32_bf16 v[44:47], v[68:71], v[60:63], v[44:47]
  ds_read_b128 v[80:83], v96 offset:59392
  v_mfma_f32_16x16x32_bf16 v[40:43], v[68:71], v[56:59], v[40:43]
  ds_read_b128 v[84:87], v96 offset:60416
  v_mfma_f32_16x16x32_bf16 v[36:39], v[68:71], v[52:55], v[36:39]
  ds_read_b64_tr_b16 v[92:93], v100 offset:4096
  v_mfma_f32_16x16x32_bf16 v[32:35], v[68:71], v[48:51], v[32:35]
  ds_read_b64_tr_b16 v[94:95], v100 offset:6144
  s_waitcnt lgkmcnt(0)
  s_barrier
  v_mfma_f32_16x16x32_bf16 v[16:19], v[88:91], v[72:75], v[16:19]
  ds_read_b128 v[48:51], v96 offset:0
  v_mfma_f32_16x16x32_bf16 v[20:23], v[88:91], v[76:79], v[20:23]
  ds_read_b64_tr_b16 v[64:65], v99 offset:8192
  v_mfma_f32_16x16x32_bf16 v[24:27], v[88:91], v[80:83], v[24:27]
  ds_read_b64_tr_b16 v[66:67], v99 offset:10240
  v_mfma_f32_16x16x32_bf16 v[28:31], v[88:91], v[84:87], v[28:31]
  ds_read_b128 v[52:55], v96 offset:1024
  v_mfma_f32_16x16x32_bf16 v[44:47], v[92:95], v[84:87], v[44:47]
  ds_read_b128 v[56:59], v96 offset:2048
  v_mfma_f32_16x16x32_bf16 v[40:43], v[92:95], v[80:83], v[40:43]
  ds_read_b128 v[60:63], v96 offset:3072
  v_mfma_f32_16x16x32_bf16 v[36:39], v[92:95], v[76:79], v[36:39]
  ds_read_b64_tr_b16 v[68:69], v100 offset:8192
  v_mfma_f32_16x16x32_bf16 v[32:35], v[92:95], v[72:75], v[32:35]
  ds_read_b64_tr_b16 v[70:71], v100 offset:10240
  s_waitcnt lgkmcnt(0)
  v_mfma_f32_16x16x32_bf16 v[16:19], v[64:67], v[48:51], v[16:19]
  s_nop 0
  ds_read_b128 v[72:75], v96 offset:8192
  v_mfma_f32_16x16x32_bf16 v[20:23], v[64:67], v[52:55], v[20:23]
  ds_read_b64_tr_b16 v[88:89], v99 offset:12288
  v_mfma_f32_16x16x32_bf16 v[24:27], v[64:67], v[56:59], v[24:27]
  ds_read_b64_tr_b16 v[90:91], v99 offset:14336
  v_mfma_f32_16x16x32_bf16 v[28:31], v[64:67], v[60:63], v[28:31]
  ds_read_b128 v[76:79], v96 offset:9216
  v_mfma_f32_16x16x32_bf16 v[44:47], v[68:71], v[60:63], v[44:47]
  ds_read_b128 v[80:83], v96 offset:10240
  v_mfma_f32_16x16x32_bf16 v[40:43], v[68:71], v[56:59], v[40:43]
  ds_read_b128 v[84:87], v96 offset:11264
  v_mfma_f32_16x16x32_bf16 v[36:39], v[68:71], v[52:55], v[36:39]
  ds_read_b64_tr_b16 v[92:93], v100 offset:12288
  v_mfma_f32_16x16x32_bf16 v[32:35], v[68:71], v[48:51], v[32:35]
  ds_read_b64_tr_b16 v[94:95], v100 offset:14336
  s_waitcnt lgkmcnt(0)
  s_barrier
  v_mfma_f32_16x16x32_bf16 v[16:19], v[88:91], v[72:75], v[16:19]
  ds_read_b128 v[48:51], v96 offset:16384
  v_mfma_f32_16x16x32_bf16 v[20:23], v[88:91], v[76:79], v[20:23]
  ds_read_b64_tr_b16 v[64:65], v99 offset:16384
  v_mfma_f32_16x16x32_bf16 v[24:27], v[88:91], v[80:83], v[24:27]
  ds_read_b64_tr_b16 v[66:67], v99 offset:18432
  v_mfma_f32_16x16x32_bf16 v[28:31], v[88:91], v[84:87], v[28:31]
  ds_read_b128 v[52:55], v96 offset:17408
  v_mfma_f32_16x16x32_bf16 v[44:47], v[92:95], v[84:87], v[44:47]
  ds_read_b128 v[56:59], v96 offset:18432
  v_mfma_f32_16x16x32_bf16 v[40:43], v[92:95], v[80:83], v[40:43]
  ds_read_b128 v[60:63], v96 offset:19456
  v_mfma_f32_16x16x32_bf16 v[36:39], v[92:95], v[76:79], v[36:39]
  ds_read_b64_tr_b16 v[68:69], v100 offset:16384
  v_mfma_f32_16x16x32_bf16 v[32:35], v[92:95], v[72:75], v[32:35]
  ds_read_b64_tr_b16 v[70:71], v100 offset:18432
  s_waitcnt lgkmcnt(0)
  v_mfma_f32_16x16x32_bf16 v[16:19], v[64:67], v[48:51], v[16:19]
  ds_read_b128 v[72:75], v96 offset:24576
  v_mfma_f32_16x16x32_bf16 v[20:23], v[64:67], v[52:55], v[20:23]
  ds_read_b64_tr_b16 v[88:89], v99 offset:20480
  v_mfma_f32_16x16x32_bf16 v[24:27], v[64:67], v[56:59], v[24:27]
  ds_read_b64_tr_b16 v[90:91], v99 offset:22528
  v_mfma_f32_16x16x32_bf16 v[28:31], v[64:67], v[60:63], v[28:31]
  s_nop 0
  ds_read_b128 v[76:79], v96 offset:25600
  v_mfma_f32_16x16x32_bf16 v[44:47], v[68:71], v[60:63], v[44:47]
  ds_read_b128 v[80:83], v96 offset:26624
  v_mfma_f32_16x16x32_bf16 v[40:43], v[68:71], v[56:59], v[40:43]
  ds_read_b128 v[84:87], v96 offset:27648
  v_mfma_f32_16x16x32_bf16 v[36:39], v[68:71], v[52:55], v[36:39]
  ds_read_b64_tr_b16 v[92:93], v100 offset:20480
  v_mfma_f32_16x16x32_bf16 v[32:35], v[68:71], v[48:51], v[32:35]
  ds_read_b64_tr_b16 v[94:95], v100 offset:22528
  s_waitcnt lgkmcnt(0)
  s_barrier
  v_mfma_f32_16x16x32_bf16 v[16:19], v[88:91], v[72:75], v[16:19]
  ds_read_b128 v[48:51], v96 offset:32768
  v_mfma_f32_16x16x32_bf16 v[20:23], v[88:91], v[76:79], v[20:23]
  ds_read_b64_tr_b16 v[64:65], v99 offset:24576
  v_mfma_f32_16x16x32_bf16 v[24:27], v[88:91], v[80:83], v[24:27]
  ds_read_b64_tr_b16 v[66:67], v99 offset:26624
  v_mfma_f32_16x16x32_bf16 v[28:31], v[88:91], v[84:87], v[28:31]
  ds_read_b128 v[52:55], v96 offset:33792
  v_mfma_f32_16x16x32_bf16 v[44:47], v[92:95], v[84:87], v[44:47]
  ds_read_b128 v[56:59], v96 offset:34816
  v_mfma_f32_16x16x32_bf16 v[40:43], v[92:95], v[80:83], v[40:43]
  ds_read_b128 v[60:63], v96 offset:35840
  v_mfma_f32_16x16x32_bf16 v[36:39], v[92:95], v[76:79], v[36:39]
  ds_read_b64_tr_b16 v[68:69], v100 offset:24576
  v_mfma_f32_16x16x32_bf16 v[32:35], v[92:95], v[72:75], v[32:35]
  ds_read_b64_tr_b16 v[70:71], v100 offset:26624
  s_waitcnt lgkmcnt(0)
  v_mfma_f32_16x16x32_bf16 v[16:19], v[64:67], v[48:51], v[16:19]
  ds_read_b128 v[72:75], v96 offset:40960
  v_mfma_f32_16x16x32_bf16 v[20:23], v[64:67], v[52:55], v[20:23]
  ds_read_b64_tr_b16 v[88:89], v99 offset:28672
  v_mfma_f32_16x16x32_bf16 v[24:27], v[64:67], v[56:59], v[24:27]
  s_nop 0
  ds_read_b64_tr_b16 v[90:91], v99 offset:30720
  v_mfma_f32_16x16x32_bf16 v[28:31], v[64:67], v[60:63], v[28:31]
  ds_read_b128 v[76:79], v96 offset:41984
  v_mfma_f32_16x16x32_bf16 v[44:47], v[68:71], v[60:63], v[44:47]
  ds_read_b128 v[80:83], v96 offset:43008
  v_mfma_f32_16x16x32_bf16 v[40:43], v[68:71], v[56:59], v[40:43]
  ds_read_b128 v[84:87], v96 offset:44032
  v_mfma_f32_16x16x32_bf16 v[36:39], v[68:71], v[52:55], v[36:39]
  ds_read_b64_tr_b16 v[92:93], v100 offset:28672
  v_mfma_f32_16x16x32_bf16 v[32:35], v[68:71], v[48:51], v[32:35]
  ds_read_b64_tr_b16 v[94:95], v100 offset:30720
  s_waitcnt lgkmcnt(0)
  s_barrier
  v_mfma_f32_16x16x32_bf16 v[16:19], v[88:91], v[72:75], v[16:19]
  ds_read_b128 v[48:51], v96 offset:49152
  v_mfma_f32_16x16x32_bf16 v[20:23], v[88:91], v[76:79], v[20:23]
  ds_read_b64_tr_b16 v[64:65], v97 offset:0
  v_mfma_f32_16x16x32_bf16 v[24:27], v[88:91], v[80:83], v[24:27]
  ds_read_b64_tr_b16 v[66:67], v97 offset:2048
  v_mfma_f32_16x16x32_bf16 v[28:31], v[88:91], v[84:87], v[28:31]
  ds_read_b128 v[52:55], v96 offset:50176
  v_mfma_f32_16x16x32_bf16 v[44:47], v[92:95], v[84:87], v[44:47]
  ds_read_b128 v[56:59], v96 offset:51200
  v_mfma_f32_16x16x32_bf16 v[40:43], v[92:95], v[80:83], v[40:43]
  ds_read_b128 v[60:63], v96 offset:52224
  v_mfma_f32_16x16x32_bf16 v[36:39], v[92:95], v[76:79], v[36:39]
  ds_read_b64_tr_b16 v[68:69], v98 offset:0
  v_mfma_f32_16x16x32_bf16 v[32:35], v[92:95], v[72:75], v[32:35]
  ds_read_b64_tr_b16 v[70:71], v98 offset:2048
  s_waitcnt lgkmcnt(0)
  v_mfma_f32_16x16x32_bf16 v[16:19], v[64:67], v[48:51], v[16:19]
  ds_read_b128 v[72:75], v96 offset:57344
  v_mfma_f32_16x16x32_bf16 v[20:23], v[64:67], v[52:55], v[20:23]
  s_nop 0
  ds_read_b64_tr_b16 v[88:89], v97 offset:4096
  v_mfma_f32_16x16x32_bf16 v[24:27], v[64:67], v[56:59], v[24:27]
  ds_read_b64_tr_b16 v[90:91], v97 offset:6144
  v_mfma_f32_16x16x32_bf16 v[28:31], v[64:67], v[60:63], v[28:31]
  ds_read_b128 v[76:79], v96 offset:58368
  v_mfma_f32_16x16x32_bf16 v[44:47], v[68:71], v[60:63], v[44:47]
  ds_read_b128 v[80:83], v96 offset:59392
  v_mfma_f32_16x16x32_bf16 v[40:43], v[68:71], v[56:59], v[40:43]
  ds_read_b128 v[84:87], v96 offset:60416
  v_mfma_f32_16x16x32_bf16 v[36:39], v[68:71], v[52:55], v[36:39]
  ds_read_b64_tr_b16 v[92:93], v98 offset:4096
  v_mfma_f32_16x16x32_bf16 v[32:35], v[68:71], v[48:51], v[32:35]
  ds_read_b64_tr_b16 v[94:95], v98 offset:6144
  s_waitcnt lgkmcnt(0)
  s_barrier
  v_mfma_f32_16x16x32_bf16 v[16:19], v[88:91], v[72:75], v[16:19]
  ds_read_b128 v[48:51], v96 offset:0
  v_mfma_f32_16x16x32_bf16 v[20:23], v[88:91], v[76:79], v[20:23]
  ds_read_b64_tr_b16 v[64:65], v97 offset:8192
  v_mfma_f32_16x16x32_bf16 v[24:27], v[88:91], v[80:83], v[24:27]
  ds_read_b64_tr_b16 v[66:67], v97 offset:10240
  v_mfma_f32_16x16x32_bf16 v[28:31], v[88:91], v[84:87], v[28:31]
  ds_read_b128 v[52:55], v96 offset:1024
  v_mfma_f32_16x16x32_bf16 v[44:47], v[92:95], v[84:87], v[44:47]
  ds_read_b128 v[56:59], v96 offset:2048
  v_mfma_f32_16x16x32_bf16 v[40:43], v[92:95], v[80:83], v[40:43]
  ds_read_b128 v[60:63], v96 offset:3072
  v_mfma_f32_16x16x32_bf16 v[36:39], v[92:95], v[76:79], v[36:39]
  ds_read_b64_tr_b16 v[68:69], v98 offset:8192
  v_mfma_f32_16x16x32_bf16 v[32:35], v[92:95], v[72:75], v[32:35]
  ds_read_b64_tr_b16 v[70:71], v98 offset:10240
  s_waitcnt lgkmcnt(0)
  v_mfma_f32_16x16x32_bf16 v[16:19], v[64:67], v[48:51], v[16:19]
  s_nop 0
  ds_read_b128 v[72:75], v96 offset:8192
  v_mfma_f32_16x16x32_bf16 v[20:23], v[64:67], v[52:55], v[20:23]
  ds_read_b64_tr_b16 v[88:89], v97 offset:12288
  v_mfma_f32_16x16x32_bf16 v[24:27], v[64:67], v[56:59], v[24:27]
  ds_read_b64_tr_b16 v[90:91], v97 offset:14336
  v_mfma_f32_16x16x32_bf16 v[28:31], v[64:67], v[60:63], v[28:31]
  ds_read_b128 v[76:79], v96 offset:9216
  v_mfma_f32_16x16x32_bf16 v[44:47], v[68:71], v[60:63], v[44:47]
  ds_read_b128 v[80:83], v96 offset:10240
  v_mfma_f32_16x16x32_bf16 v[40:43], v[68:71], v[56:59], v[40:43]
  ds_read_b128 v[84:87], v96 offset:11264
  v_mfma_f32_16x16x32_bf16 v[36:39], v[68:71], v[52:55], v[36:39]
  ds_read_b64_tr_b16 v[92:93], v98 offset:12288
  v_mfma_f32_16x16x32_bf16 v[32:35], v[68:71], v[48:51], v[32:35]
  ds_read_b64_tr_b16 v[94:95], v98 offset:14336
  s_waitcnt lgkmcnt(0)
  s_barrier
  v_mfma_f32_16x16x32_bf16 v[16:19], v[88:91], v[72:75], v[16:19]
  ds_read_b128 v[48:51], v96 offset:16384
  v_mfma_f32_16x16x32_bf16 v[20:23], v[88:91], v[76:79], v[20:23]
  ds_read_b64_tr_b16 v[64:65], v97 offset:16384
  v_mfma_f32_16x16x32_bf16 v[24:27], v[88:91], v[80:83], v[24:27]
  ds_read_b64_tr_b16 v[66:67], v97 offset:18432
  v_mfma_f32_16x16x32_bf16 v[28:31], v[88:91], v[84:87], v[28:31]
  ds_read_b128 v[52:55], v96 offset:17408
  v_mfma_f32_16x16x32_bf16 v[44:47], v[92:95], v[84:87], v[44:47]
  ds_read_b128 v[56:59], v96 offset:18432
  v_mfma_f32_16x16x32_bf16 v[40:43], v[92:95], v[80:83], v[40:43]
  ds_read_b128 v[60:63], v96 offset:19456
  v_mfma_f32_16x16x32_bf16 v[36:39], v[92:95], v[76:79], v[36:39]
  ds_read_b64_tr_b16 v[68:69], v98 offset:16384
  v_mfma_f32_16x16x32_bf16 v[32:35], v[92:95], v[72:75], v[32:35]
  ds_read_b64_tr_b16 v[70:71], v98 offset:18432
  s_waitcnt lgkmcnt(0)
  v_mfma_f32_16x16x32_bf16 v[16:19], v[64:67], v[48:51], v[16:19]
  ds_read_b128 v[72:75], v96 offset:24576
  v_mfma_f32_16x16x32_bf16 v[20:23], v[64:67], v[52:55], v[20:23]
  ds_read_b64_tr_b16 v[88:89], v97 offset:20480
  v_mfma_f32_16x16x32_bf16 v[24:27], v[64:67], v[56:59], v[24:27]
  ds_read_b64_tr_b16 v[90:91], v97 offset:22528
  v_mfma_f32_16x16x32_bf16 v[28:31], v[64:67], v[60:63], v[28:31]
  s_nop 0
  ds_read_b128 v[76:79], v96 offset:25600
  v_mfma_f32_16x16x32_bf16 v[44:47], v[68:71], v[60:63], v[44:47]
  ds_read_b128 v[80:83], v96 offset:26624
  v_mfma_f32_16x16x32_bf16 v[40:43], v[68:71], v[56:59], v[40:43]
  ds_read_b128 v[84:87], v96 offset:27648
  v_mfma_f32_16x16x32_bf16 v[36:39], v[68:71], v[52:55], v[36:39]
  ds_read_b64_tr_b16 v[92:93], v98 offset:20480
  v_mfma_f32_16x16x32_bf16 v[32:35], v[68:71], v[48:51], v[32:35]
  ds_read_b64_tr_b16 v[94:95], v98 offset:22528
  s_waitcnt lgkmcnt(0)
  s_barrier
  v_mfma_f32_16x16x32_bf16 v[16:19], v[88:91], v[72:75], v[16:19]
  ds_read_b128 v[48:51], v96 offset:32768
  v_mfma_f32_16x16x32_bf16 v[20:23], v[88:91], v[76:79], v[20:23]
  ds_read_b64_tr_b16 v[64:65], v97 offset:24576
  v_mfma_f32_16x16x32_bf16 v[24:27], v[88:91], v[80:83], v[24:27]
  ds_read_b64_tr_b16 v[66:67], v97 offset:26624
  v_mfma_f32_16x16x32_bf16 v[28:31], v[88:91], v[84:87], v[28:31]
  ds_read_b128 v[52:55], v96 offset:33792
  v_mfma_f32_16x16x32_bf16 v[44:47], v[92:95], v[84:87], v[44:47]
  ds_read_b128 v[56:59], v96 offset:34816
  v_mfma_f32_16x16x32_bf16 v[40:43], v[92:95], v[80:83], v[40:43]
  ds_read_b128 v[60:63], v96 offset:35840
  v_mfma_f32_16x16x32_bf16 v[36:39], v[92:95], v[76:79], v[36:39]
  ds_read_b64_tr_b16 v[68:69], v98 offset:24576
  v_mfma_f32_16x16x32_bf16 v[32:35], v[92:95], v[72:75], v[32:35]
  ds_read_b64_tr_b16 v[70:71], v98 offset:26624
  s_waitcnt lgkmcnt(0)
  v_mfma_f32_16x16x32_bf16 v[16:19], v[64:67], v[48:51], v[16:19]
  ds_read_b128 v[72:75], v96 offset:40960
  v_mfma_f32_16x16x32_bf16 v[20:23], v[64:67], v[52:55], v[20:23]
  ds_read_b64_tr_b16 v[88:89], v97 offset:28672
  v_mfma_f32_16x16x32_bf16 v[24:27], v[64:67], v[56:59], v[24:27]
  s_nop 0
  ds_read_b64_tr_b16 v[90:91], v97 offset:30720
  v_mfma_f32_16x16x32_bf16 v[28:31], v[64:67], v[60:63], v[28:31]
  ds_read_b128 v[76:79], v96 offset:41984
  v_mfma_f32_16x16x32_bf16 v[44:47], v[68:71], v[60:63], v[44:47]
  ds_read_b128 v[80:83], v96 offset:43008
  v_mfma_f32_16x16x32_bf16 v[40:43], v[68:71], v[56:59], v[40:43]
  ds_read_b128 v[84:87], v96 offset:44032
  v_mfma_f32_16x16x32_bf16 v[36:39], v[68:71], v[52:55], v[36:39]
  ds_read_b64_tr_b16 v[92:93], v98 offset:28672
  v_mfma_f32_16x16x32_bf16 v[32:35], v[68:71], v[48:51], v[32:35]
  ds_read_b64_tr_b16 v[94:95], v98 offset:30720
  s_waitcnt lgkmcnt(0)
  s_barrier
  v_mfma_f32_16x16x32_bf16 v[16:19], v[88:91], v[72:75], v[16:19]
  v_mfma_f32_16x16x32_bf16 v[20:23], v[88:91], v[76:79], v[20:23]
  v_mfma_f32_16x16x32_bf16 v[24:27], v[88:91], v[80:83], v[24:27]
  v_mfma_f32_16x16x32_bf16 v[28:31], v[88:91], v[84:87], v[28:31]
  v_mfma_f32_16x16x32_bf16 v[44:47], v[92:95], v[84:87], v[44:47]
  v_mfma_f32_16x16x32_bf16 v[40:43], v[92:95], v[80:83], v[40:43]
  v_mfma_f32_16x16x32_bf16 v[36:39], v[92:95], v[76:79], v[36:39]
  v_mfma_f32_16x16x32_bf16 v[32:35], v[92:95], v[72:75], v[32:35]
  s_nop 7
  v_lshlrev_b32 v4, 16, v140
  v_and_b32 v5, 0xffff0000, v140
  v_pk_add_f32 v[4:5], v[4:5], v[16:17]
  v_cvt_pk_bf16_f32 v48, v4, v5
  v_lshlrev_b32 v4, 16, v141
  v_and_b32 v5, 0xffff0000, v141
  v_pk_add_f32 v[4:5], v[4:5], v[18:19]
  v_cvt_pk_bf16_f32 v49, v4, v5
  v_lshlrev_b32 v4, 16, v142
  v_and_b32 v5, 0xffff0000, v142
  v_pk_add_f32 v[4:5], v[4:5], v[32:33]
  v_cvt_pk_bf16_f32 v50, v4, v5
  v_lshlrev_b32_e64 v4, 16, v143
  v_and_b32 v5, 0xffff0000, v143
  v_pk_add_f32 v[4:5], v[4:5], v[34:35]
  v_cvt_pk_bf16_f32 v51, v4, v5
  buffer_store_dwordx4 v[48:51], v1, s[8:11], s3 offen offset:0 sc1
  ds_write_b128 v3, v[48:51] offset:0
  v_lshlrev_b32_e64 v4, 16, v144
  v_and_b32 v5, 0xffff0000, v144
  v_pk_add_f32 v[4:5], v[4:5], v[20:21]
  v_cvt_pk_bf16_f32 v52, v4, v5
  v_lshlrev_b32 v4, 16, v145
  v_and_b32 v5, 0xffff0000, v145
  v_pk_add_f32 v[4:5], v[4:5], v[22:23]
  v_cvt_pk_bf16_f32 v53, v4, v5
  v_lshlrev_b32 v4, 16, v146
  v_and_b32 v5, 0xffff0000, v146
  v_pk_add_f32 v[4:5], v[4:5], v[36:37]
  v_cvt_pk_bf16_f32 v54, v4, v5
  v_lshlrev_b32 v4, 16, v147
  v_and_b32 v5, 0xffff0000, v147
  v_pk_add_f32 v[4:5], v[4:5], v[38:39]
  v_cvt_pk_bf16_f32 v55, v4, v5
  buffer_store_dwordx4 v[52:55], v1, s[8:11], s3 offen offset:1024 sc1
  ds_write_b128 v3, v[52:55] offset:1024
  v_lshlrev_b32 v4, 16, v148
  v_and_b32 v5, 0xffff0000, v148
  v_pk_add_f32 v[4:5], v[4:5], v[24:25]
  v_cvt_pk_bf16_f32 v56, v4, v5
  v_lshlrev_b32 v4, 16, v149
  v_and_b32 v5, 0xffff0000, v149
  v_pk_add_f32 v[4:5], v[4:5], v[26:27]
  v_cvt_pk_bf16_f32 v57, v4, v5
  v_lshlrev_b32 v4, 16, v150
  v_and_b32 v5, 0xffff0000, v150
  v_pk_add_f32 v[4:5], v[4:5], v[40:41]
  v_cvt_pk_bf16_f32 v58, v4, v5
  v_lshlrev_b32 v4, 16, v151
  v_and_b32 v5, 0xffff0000, v151
  v_pk_add_f32 v[4:5], v[4:5], v[42:43]
  v_cvt_pk_bf16_f32 v59, v4, v5
  buffer_store_dwordx4 v[56:59], v1, s[8:11], s3 offen offset:2048 sc1
  ds_write_b128 v3, v[56:59] offset:2048
  v_lshlrev_b32 v4, 16, v152
  v_and_b32 v5, 0xffff0000, v152
  v_pk_add_f32 v[4:5], v[4:5], v[28:29]
  v_cvt_pk_bf16_f32 v60, v4, v5
  v_lshlrev_b32 v4, 16, v153
  v_and_b32 v5, 0xffff0000, v153
  v_pk_add_f32 v[4:5], v[4:5], v[30:31]
  v_cvt_pk_bf16_f32 v61, v4, v5
  v_lshlrev_b32 v4, 16, v154
  v_and_b32 v5, 0xffff0000, v154
  v_pk_add_f32 v[4:5], v[4:5], v[44:45]
  v_cvt_pk_bf16_f32 v62, v4, v5
  v_lshlrev_b32 v4, 16, v155
  v_and_b32 v5, 0xffff0000, v155
  v_pk_add_f32 v[4:5], v[4:5], v[46:47]
  v_cvt_pk_bf16_f32 v63, v4, v5
  buffer_store_dwordx4 v[60:63], v1, s[8:11], s3 offen offset:3072 sc1
  ds_write_b128 v3, v[60:63] offset:3072
  s_waitcnt lgkmcnt(0)
  v_lshrrev_b32 v2, 4, v0
  v_lshlrev_b32 v2, 3, v2
  s_mul_i32 s61, s49, 448
  s_lshl_b32 s4, s53, 5
  s_add_u32 s62, s61, s4
  s_lshl_b32 s4, s53, 8
  s_add_u32 s61, s61, s4
  v_mov_b32 v6, v2
  s_lshl_b32 s3, s48, 14
  s_mul_i32 s4, s49, 0
  s_add_u32 s3, s3, s4
  s_add_u32 s3, s3, 67109120
  v_lshl_add_u32 v3, v0, 10, s3
  v_mov_b32 v2, 1
  s_cmp_eq_u32 s50, 0
  s_cselect_b64 s[64:65], 0xffff, 0
  s_waitcnt vmcnt(0)
  s_barrier
  s_mov_b64 exec, s[64:65]
  s_cbranch_execz Lsf_2011
  buffer_atomic_add v2, v3, s[8:11], 0 offen sc1
Lsf_2011:
  s_mov_b64 exec, -1
  buffer_load_dwordx2 v[240:241], v6, s[32:35], s61 offen offset:0
  buffer_load_dwordx2 v[242:243], v6, s[32:35], s61 offen offset:32
  buffer_load_dwordx2 v[244:245], v6, s[32:35], s61 offen offset:64
  buffer_load_dwordx2 v[246:247], v6, s[32:35], s61 offen offset:96
  s_nop 0
  buffer_load_dwordx2 v[248:249], v6, s[32:35], s61 offen offset:128
  buffer_load_dwordx2 v[250:251], v6, s[32:35], s61 offen offset:160
  buffer_load_dwordx2 v[252:253], v6, s[32:35], s62 offen offset:192
  s_lshr_b32 s61, s49, 3
  s_and_b32 s62, s49, 7
  s_lshl_b32 s3, s48, 4
  s_lshl_b32 s4, s62, 1
  s_add_u32 s3, s3, s4
  s_add_u32 s3, s3, s53
  s_lshl_b32 s3, s3, 2
  s_add_u32 s3, s3, s52
  s_lshl_b32 s3, s3, 1
  s_add_u32 s3, s3, s61
  s_lshl_b32 s3, s3, 11
  s_add_u32 s55, s3, 20971520
  s_add_u32 s56, s55, 8192
  s_lshl_b32 s66, s62, 8
  s_lshl_b32 s5, s53, 7
  s_add_u32 s66, s66, s5
  v_mov_b32 v4, 0xbdd2d3e8
  v_mov_b32 v6, 0xc0135761
  s_mul_i32 s3, s48, 112
  s_mul_i32 s4, s49, 7
  s_add_u32 s3, s3, s4
  s_lshl_b32 s3, s3, 1
  s_add_u32 s3, s3, s52
  s_lshl_b32 s3, s3, 12
  s_add_u32 s3, s3, 33579008
  s_lshl_b32 s4, s53, 15
  s_add_u32 s5, s3, s4
  s_sub_u32 s5, s5, 24576
  s_lshl_b32 s6, s52, 12
  s_add_u32 s4, s4, s6
  v_add_u32 v3, s4, v1
  s_lshl_b32 s4, s53, 3
  v_add_u32 v8, s4, v1
  v_add_u32 v7, s6, v8
  s_mov_b32 s54, 0
  ds_read_b128 v[124:127], v212 offset:0
  ds_read_b64_tr_b16 v[140:141], v213 offset:0
  ds_read_b64_tr_b16 v[142:143], v213 offset:7168
  ds_read_b128 v[128:131], v212 offset:1024
  ds_read_b128 v[132:135], v212 offset:2048
  ds_read_b128 v[136:139], v212 offset:3072
  ds_read_b64_tr_b16 v[144:145], v214 offset:0
  ds_read_b64_tr_b16 v[146:147], v214 offset:7168
  ds_read_b64_tr_b16 v[148:149], v215 offset:0
  ds_read_b64_tr_b16 v[150:151], v215 offset:7168
  ds_read_b64_tr_b16 v[152:153], v216 offset:0
  ds_read_b64_tr_b16 v[154:155], v216 offset:7168
  ds_read_b64_tr_b16 v[156:157], v217 offset:0
  ds_read_b64_tr_b16 v[158:159], v217 offset:7168
  ds_read_b64_tr_b16 v[160:161], v218 offset:0
  ds_read_b64_tr_b16 v[162:163], v218 offset:7168
  ds_read_b64_tr_b16 v[164:165], v219 offset:0
  ds_read_b64_tr_b16 v[166:167], v219 offset:7168
  s_waitcnt lgkmcnt(0)
  v_mfma_f32_16x16x32_bf16 v[12:15], v[140:143], v[124:127], 0
  ds_read_b128 v[168:171], v212 offset:8192
  v_mfma_f32_16x16x32_bf16 v[16:19], v[140:143], v[128:131], 0
  ds_read_b64_tr_b16 v[184:185], v213 offset:14336
  v_mfma_f32_16x16x32_bf16 v[20:23], v[140:143], v[132:135], 0
  s_nop 0
  ds_read_b64_tr_b16 v[186:187], v213 offset:21504
  v_mfma_f32_16x16x32_bf16 v[24:27], v[140:143], v[136:139], 0
  ds_read_b128 v[172:175], v212 offset:9216
  v_mfma_f32_16x16x32_bf16 v[40:43], v[144:147], v[136:139], 0
  ds_read_b128 v[176:179], v212 offset:10240
  v_mfma_f32_16x16x32_bf16 v[36:39], v[144:147], v[132:135], 0
  ds_read_b128 v[180:183], v212 offset:11264
  v_mfma_f32_16x16x32_bf16 v[32:35], v[144:147], v[128:131], 0
  ds_read_b64_tr_b16 v[188:189], v214 offset:14336
  v_mfma_f32_16x16x32_bf16 v[28:31], v[144:147], v[124:127], 0
  ds_read_b64_tr_b16 v[190:191], v214 offset:21504
  v_mfma_f32_16x16x32_bf16 v[44:47], v[148:151], v[124:127], 0
  ds_read_b64_tr_b16 v[192:193], v215 offset:14336
  v_mfma_f32_16x16x32_bf16 v[48:51], v[148:151], v[128:131], 0
  ds_read_b64_tr_b16 v[194:195], v215 offset:21504
  v_mfma_f32_16x16x32_bf16 v[52:55], v[148:151], v[132:135], 0
  ds_read_b64_tr_b16 v[196:197], v216 offset:14336
  v_mfma_f32_16x16x32_bf16 v[56:59], v[148:151], v[136:139], 0
  ds_read_b64_tr_b16 v[198:199], v216 offset:21504
  v_mfma_f32_16x16x32_bf16 v[72:75], v[152:155], v[136:139], 0
  ds_read_b64_tr_b16 v[200:201], v217 offset:14336
  v_mfma_f32_16x16x32_bf16 v[68:71], v[152:155], v[132:135], 0
  ds_read_b64_tr_b16 v[202:203], v217 offset:21504
  v_mfma_f32_16x16x32_bf16 v[64:67], v[152:155], v[128:131], 0
  ds_read_b64_tr_b16 v[204:205], v218 offset:14336
  v_mfma_f32_16x16x32_bf16 v[60:63], v[152:155], v[124:127], 0
  ds_read_b64_tr_b16 v[206:207], v218 offset:21504
  v_mfma_f32_16x16x32_bf16 v[76:79], v[156:159], v[124:127], 0
  ds_read_b64_tr_b16 v[208:209], v219 offset:14336
  v_mfma_f32_16x16x32_bf16 v[80:83], v[156:159], v[128:131], 0
  ds_read_b64_tr_b16 v[210:211], v219 offset:21504
  v_mfma_f32_16x16x32_bf16 v[84:87], v[156:159], v[132:135], 0
  v_mfma_f32_16x16x32_bf16 v[88:91], v[156:159], v[136:139], 0
  v_mfma_f32_16x16x32_bf16 v[104:107], v[160:163], v[136:139], 0
  v_mfma_f32_16x16x32_bf16 v[100:103], v[160:163], v[132:135], 0
  v_mfma_f32_16x16x32_bf16 v[96:99], v[160:163], v[128:131], 0
  v_mfma_f32_16x16x32_bf16 v[92:95], v[160:163], v[124:127], 0
  v_mfma_f32_16x16x32_bf16 v[108:111], v[164:167], v[124:127], 0
  v_mfma_f32_16x16x32_bf16 v[112:115], v[164:167], v[128:131], 0
  v_mfma_f32_16x16x32_bf16 v[116:119], v[164:167], v[132:135], 0
  v_mfma_f32_16x16x32_bf16 v[120:123], v[164:167], v[136:139], 0
  s_waitcnt lgkmcnt(0)
.p2align 6
Lc_2012:
  s_barrier
  v_mfma_f32_16x16x32_bf16 v[12:15], v[184:187], v[168:171], v[12:15]
  ds_read_b128 v[124:127], v212 offset:16384
  v_mfma_f32_16x16x32_bf16 v[16:19], v[184:187], v[172:175], v[16:19]
  ds_read_b64_tr_b16 v[140:141], v213 offset:28672
  v_mfma_f32_16x16x32_bf16 v[20:23], v[184:187], v[176:179], v[20:23]
  ds_read_b64_tr_b16 v[142:143], v213 offset:35840
  v_mfma_f32_16x16x32_bf16 v[24:27], v[184:187], v[180:183], v[24:27]
  s_nop 0
  ds_read_b128 v[128:131], v212 offset:17408
  v_mfma_f32_16x16x32_bf16 v[40:43], v[188:191], v[180:183], v[40:43]
  ds_read_b128 v[132:135], v212 offset:18432
  v_mfma_f32_16x16x32_bf16 v[36:39], v[188:191], v[176:179], v[36:39]
  ds_read_b128 v[136:139], v212 offset:19456
  v_mfma_f32_16x16x32_bf16 v[32:35], v[188:191], v[172:175], v[32:35]
  ds_read_b64_tr_b16 v[144:145], v214 offset:28672
  v_mfma_f32_16x16x32_bf16 v[28:31], v[188:191], v[168:171], v[28:31]
  ds_read_b64_tr_b16 v[146:147], v214 offset:35840
  v_mfma_f32_16x16x32_bf16 v[44:47], v[192:195], v[168:171], v[44:47]
  ds_read_b64_tr_b16 v[148:149], v215 offset:28672
  v_mfma_f32_16x16x32_bf16 v[48:51], v[192:195], v[172:175], v[48:51]
  ds_read_b64_tr_b16 v[150:151], v215 offset:35840
  v_mfma_f32_16x16x32_bf16 v[52:55], v[192:195], v[176:179], v[52:55]
  ds_read_b64_tr_b16 v[152:153], v216 offset:28672
  v_mfma_f32_16x16x32_bf16 v[56:59], v[192:195], v[180:183], v[56:59]
  ds_read_b64_tr_b16 v[154:155], v216 offset:35840
  v_mfma_f32_16x16x32_bf16 v[72:75], v[196:199], v[180:183], v[72:75]
  ds_read_b64_tr_b16 v[156:157], v217 offset:28672
  v_mfma_f32_16x16x32_bf16 v[68:71], v[196:199], v[176:179], v[68:71]
  ds_read_b64_tr_b16 v[158:159], v217 offset:35840
  v_mfma_f32_16x16x32_bf16 v[64:67], v[196:199], v[172:175], v[64:67]
  ds_read_b64_tr_b16 v[160:161], v218 offset:28672
  v_mfma_f32_16x16x32_bf16 v[60:63], v[196:199], v[168:171], v[60:63]
  ds_read_b64_tr_b16 v[162:163], v218 offset:35840
  v_mfma_f32_16x16x32_bf16 v[76:79], v[200:203], v[168:171], v[76:79]
  ds_read_b64_tr_b16 v[164:165], v219 offset:28672
  v_mfma_f32_16x16x32_bf16 v[80:83], v[200:203], v[172:175], v[80:83]
  ds_read_b64_tr_b16 v[166:167], v219 offset:35840
  v_mfma_f32_16x16x32_bf16 v[84:87], v[200:203], v[176:179], v[84:87]
  v_mfma_f32_16x16x32_bf16 v[88:91], v[200:203], v[180:183], v[88:91]
  v_mfma_f32_16x16x32_bf16 v[104:107], v[204:207], v[180:183], v[104:107]
  v_mfma_f32_16x16x32_bf16 v[100:103], v[204:207], v[176:179], v[100:103]
  v_mfma_f32_16x16x32_bf16 v[96:99], v[204:207], v[172:175], v[96:99]
  v_mfma_f32_16x16x32_bf16 v[92:95], v[204:207], v[168:171], v[92:95]
  v_mfma_f32_16x16x32_bf16 v[108:111], v[208:211], v[168:171], v[108:111]
  v_mfma_f32_16x16x32_bf16 v[112:115], v[208:211], v[172:175], v[112:115]
  v_mfma_f32_16x16x32_bf16 v[116:119], v[208:211], v[176:179], v[116:119]
  v_mfma_f32_16x16x32_bf16 v[120:123], v[208:211], v[180:183], v[120:123]
  s_waitcnt lgkmcnt(0)
  s_nop 0
  v_mfma_f32_16x16x32_bf16 v[12:15], v[140:143], v[124:127], v[12:15]
  ds_read_b128 v[168:171], v212 offset:24576
  v_mfma_f32_16x16x32_bf16 v[16:19], v[140:143], v[128:131], v[16:19]
  ds_read_b64_tr_b16 v[184:185], v213 offset:43008
  v_mfma_f32_16x16x32_bf16 v[20:23], v[140:143], v[132:135], v[20:23]
  ds_read_b64_tr_b16 v[186:187], v213 offset:50176
  v_mfma_f32_16x16x32_bf16 v[24:27], v[140:143], v[136:139], v[24:27]
  ds_read_b128 v[172:175], v212 offset:25600
  v_mfma_f32_16x16x32_bf16 v[40:43], v[144:147], v[136:139], v[40:43]
  ds_read_b128 v[176:179], v212 offset:26624
  v_mfma_f32_16x16x32_bf16 v[36:39], v[144:147], v[132:135], v[36:39]
  ds_read_b128 v[180:183], v212 offset:27648
  v_mfma_f32_16x16x32_bf16 v[32:35], v[144:147], v[128:131], v[32:35]
  ds_read_b64_tr_b16 v[188:189], v214 offset:43008
  v_mfma_f32_16x16x32_bf16 v[28:31], v[144:147], v[124:127], v[28:31]
  ds_read_b64_tr_b16 v[190:191], v214 offset:50176
  v_mfma_f32_16x16x32_bf16 v[44:47], v[148:151], v[124:127], v[44:47]
  ds_read_b64_tr_b16 v[192:193], v215 offset:43008
  v_mfma_f32_16x16x32_bf16 v[48:51], v[148:151], v[128:131], v[48:51]
  ds_read_b64_tr_b16 v[194:195], v215 offset:50176
  v_mfma_f32_16x16x32_bf16 v[52:55], v[148:151], v[132:135], v[52:55]
  ds_read_b64_tr_b16 v[196:197], v216 offset:43008
  v_mfma_f32_16x16x32_bf16 v[56:59], v[148:151], v[136:139], v[56:59]
  ds_read_b64_tr_b16 v[198:199], v216 offset:50176
  v_mfma_f32_16x16x32_bf16 v[72:75], v[152:155], v[136:139], v[72:75]
  ds_read_b64_tr_b16 v[200:201], v217 offset:43008
  v_mfma_f32_16x16x32_bf16 v[68:71], v[152:155], v[132:135], v[68:71]
  ds_read_b64_tr_b16 v[202:203], v217 offset:50176
  v_mfma_f32_16x16x32_bf16 v[64:67], v[152:155], v[128:131], v[64:67]
  ds_read_b64_tr_b16 v[204:205], v218 offset:43008
  v_mfma_f32_16x16x32_bf16 v[60:63], v[152:155], v[124:127], v[60:63]
  ds_read_b64_tr_b16 v[206:207], v218 offset:50176
  v_mfma_f32_16x16x32_bf16 v[76:79], v[156:159], v[124:127], v[76:79]
  ds_read_b64_tr_b16 v[208:209], v219 offset:43008
  v_mfma_f32_16x16x32_bf16 v[80:83], v[156:159], v[128:131], v[80:83]
  ds_read_b64_tr_b16 v[210:211], v219 offset:50176
  v_mfma_f32_16x16x32_bf16 v[84:87], v[156:159], v[132:135], v[84:87]
  v_mfma_f32_16x16x32_bf16 v[88:91], v[156:159], v[136:139], v[88:91]
  v_mfma_f32_16x16x32_bf16 v[104:107], v[160:163], v[136:139], v[104:107]
  v_mfma_f32_16x16x32_bf16 v[100:103], v[160:163], v[132:135], v[100:103]
  v_mfma_f32_16x16x32_bf16 v[96:99], v[160:163], v[128:131], v[96:99]
  v_mfma_f32_16x16x32_bf16 v[92:95], v[160:163], v[124:127], v[92:95]
  v_mfma_f32_16x16x32_bf16 v[108:111], v[164:167], v[124:127], v[108:111]
  v_mfma_f32_16x16x32_bf16 v[112:115], v[164:167], v[128:131], v[112:115]
  v_mfma_f32_16x16x32_bf16 v[116:119], v[164:167], v[132:135], v[116:119]
  v_mfma_f32_16x16x32_bf16 v[120:123], v[164:167], v[136:139], v[120:123]
  s_waitcnt lgkmcnt(0)
  s_barrier
  v_mfma_f32_16x16x32_bf16 v[12:15], v[184:187], v[168:171], v[12:15]
  ds_read_b128 v[124:127], v212 offset:32768
  v_mfma_f32_16x16x32_bf16 v[16:19], v[184:187], v[172:175], v[16:19]
  ds_read_b64_tr_b16 v[140:141], v220 offset:0
  v_mfma_f32_16x16x32_bf16 v[20:23], v[184:187], v[176:179], v[20:23]
  ds_read_b64_tr_b16 v[142:143], v220 offset:7168
  v_mfma_f32_16x16x32_bf16 v[24:27], v[184:187], v[180:183], v[24:27]
  ds_read_b128 v[128:131], v212 offset:33792
  v_mfma_f32_16x16x32_bf16 v[40:43], v[188:191], v[180:183], v[40:43]
  ds_read_b128 v[132:135], v212 offset:34816
  v_mfma_f32_16x16x32_bf16 v[36:39], v[188:191], v[176:179], v[36:39]
  ds_read_b128 v[136:139], v212 offset:35840
  v_mfma_f32_16x16x32_bf16 v[32:35], v[188:191], v[172:175], v[32:35]
  ds_read_b64_tr_b16 v[144:145], v221 offset:0
  v_mfma_f32_16x16x32_bf16 v[28:31], v[188:191], v[168:171], v[28:31]
  ds_read_b64_tr_b16 v[146:147], v221 offset:7168
  v_mfma_f32_16x16x32_bf16 v[44:47], v[192:195], v[168:171], v[44:47]
  ds_read_b64_tr_b16 v[148:149], v222 offset:0
  v_mfma_f32_16x16x32_bf16 v[48:51], v[192:195], v[172:175], v[48:51]
  ds_read_b64_tr_b16 v[150:151], v222 offset:7168
  v_mfma_f32_16x16x32_bf16 v[52:55], v[192:195], v[176:179], v[52:55]
  ds_read_b64_tr_b16 v[152:153], v223 offset:0
  v_mfma_f32_16x16x32_bf16 v[56:59], v[192:195], v[180:183], v[56:59]
  ds_read_b64_tr_b16 v[154:155], v223 offset:7168
  v_mfma_f32_16x16x32_bf16 v[72:75], v[196:199], v[180:183], v[72:75]
  ds_read_b64_tr_b16 v[156:157], v224 offset:0
  v_mfma_f32_16x16x32_bf16 v[68:71], v[196:199], v[176:179], v[68:71]
  ds_read_b64_tr_b16 v[158:159], v224 offset:7168
  v_mfma_f32_16x16x32_bf16 v[64:67], v[196:199], v[172:175], v[64:67]
  ds_read_b64_tr_b16 v[160:161], v225 offset:0
  v_mfma_f32_16x16x32_bf16 v[60:63], v[196:199], v[168:171], v[60:63]
  ds_read_b64_tr_b16 v[162:163], v225 offset:7168
  v_mfma_f32_16x16x32_bf16 v[76:79], v[200:203], v[168:171], v[76:79]
  ds_read_b64_tr_b16 v[164:165], v226 offset:0
  v_mfma_f32_16x16x32_bf16 v[80:83], v[200:203], v[172:175], v[80:83]
  ds_read_b64_tr_b16 v[166:167], v226 offset:7168
  v_mfma_f32_16x16x32_bf16 v[84:87], v[200:203], v[176:179], v[84:87]
  v_mfma_f32_16x16x32_bf16 v[88:91], v[200:203], v[180:183], v[88:91]
  v_mfma_f32_16x16x32_bf16 v[104:107], v[204:207], v[180:183], v[104:107]
  v_mfma_f32_16x16x32_bf16 v[100:103], v[204:207], v[176:179], v[100:103]
  v_mfma_f32_16x16x32_bf16 v[96:99], v[204:207], v[172:175], v[96:99]
  v_mfma_f32_16x16x32_bf16 v[92:95], v[204:207], v[168:171], v[92:95]
  v_mfma_f32_16x16x32_bf16 v[108:111], v[208:211], v[168:171], v[108:111]
  v_mfma_f32_16x16x32_bf16 v[112:115], v[208:211], v[172:175], v[112:115]
  v_mfma_f32_16x16x32_bf16 v[116:119], v[208:211], v[176:179], v[116:119]
  v_mfma_f32_16x16x32_bf16 v[120:123], v[208:211], v[180:183], v[120:123]
  s_waitcnt lgkmcnt(0)
  v_mfma_f32_16x16x32_bf16 v[12:15], v[140:143], v[124:127], v[12:15]
  ds_read_b128 v[168:171], v212 offset:40960
  s_nop 0
  v_mfma_f32_16x16x32_bf16 v[16:19], v[140:143], v[128:131], v[16:19]
  ds_read_b64_tr_b16 v[184:185], v220 offset:14336
  v_mfma_f32_16x16x32_bf16 v[20:23], v[140:143], v[132:135], v[20:23]
  ds_read_b64_tr_b16 v[186:187], v220 offset:21504
  v_mfma_f32_16x16x32_bf16 v[24:27], v[140:143], v[136:139], v[24:27]
  ds_read_b128 v[172:175], v212 offset:41984
  v_mfma_f32_16x16x32_bf16 v[40:43], v[144:147], v[136:139], v[40:43]
  ds_read_b128 v[176:179], v212 offset:43008
  v_mfma_f32_16x16x32_bf16 v[36:39], v[144:147], v[132:135], v[36:39]
  ds_read_b128 v[180:183], v212 offset:44032
  v_mfma_f32_16x16x32_bf16 v[32:35], v[144:147], v[128:131], v[32:35]
  ds_read_b64_tr_b16 v[188:189], v221 offset:14336
  v_mfma_f32_16x16x32_bf16 v[28:31], v[144:147], v[124:127], v[28:31]
  ds_read_b64_tr_b16 v[190:191], v221 offset:21504
  v_mfma_f32_16x16x32_bf16 v[44:47], v[148:151], v[124:127], v[44:47]
  ds_read_b64_tr_b16 v[192:193], v222 offset:14336
  v_mfma_f32_16x16x32_bf16 v[48:51], v[148:151], v[128:131], v[48:51]
  ds_read_b64_tr_b16 v[194:195], v222 offset:21504
  v_mfma_f32_16x16x32_bf16 v[52:55], v[148:151], v[132:135], v[52:55]
  ds_read_b64_tr_b16 v[196:197], v223 offset:14336
  v_mfma_f32_16x16x32_bf16 v[56:59], v[148:151], v[136:139], v[56:59]
  ds_read_b64_tr_b16 v[198:199], v223 offset:21504
  v_mfma_f32_16x16x32_bf16 v[72:75], v[152:155], v[136:139], v[72:75]
  ds_read_b64_tr_b16 v[200:201], v224 offset:14336
  v_mfma_f32_16x16x32_bf16 v[68:71], v[152:155], v[132:135], v[68:71]
  ds_read_b64_tr_b16 v[202:203], v224 offset:21504
  v_mfma_f32_16x16x32_bf16 v[64:67], v[152:155], v[128:131], v[64:67]
  ds_read_b64_tr_b16 v[204:205], v225 offset:14336
  v_mfma_f32_16x16x32_bf16 v[60:63], v[152:155], v[124:127], v[60:63]
  ds_read_b64_tr_b16 v[206:207], v225 offset:21504
  v_mfma_f32_16x16x32_bf16 v[76:79], v[156:159], v[124:127], v[76:79]
  ds_read_b64_tr_b16 v[208:209], v226 offset:14336
  v_mfma_f32_16x16x32_bf16 v[80:83], v[156:159], v[128:131], v[80:83]
  ds_read_b64_tr_b16 v[210:211], v226 offset:21504
  v_mfma_f32_16x16x32_bf16 v[84:87], v[156:159], v[132:135], v[84:87]
  v_mfma_f32_16x16x32_bf16 v[88:91], v[156:159], v[136:139], v[88:91]
  v_mfma_f32_16x16x32_bf16 v[104:107], v[160:163], v[136:139], v[104:107]
  v_mfma_f32_16x16x32_bf16 v[100:103], v[160:163], v[132:135], v[100:103]
  v_mfma_f32_16x16x32_bf16 v[96:99], v[160:163], v[128:131], v[96:99]
  v_mfma_f32_16x16x32_bf16 v[92:95], v[160:163], v[124:127], v[92:95]
  v_mfma_f32_16x16x32_bf16 v[108:111], v[164:167], v[124:127], v[108:111]
  v_mfma_f32_16x16x32_bf16 v[112:115], v[164:167], v[128:131], v[112:115]
  v_mfma_f32_16x16x32_bf16 v[116:119], v[164:167], v[132:135], v[116:119]
  v_mfma_f32_16x16x32_bf16 v[120:123], v[164:167], v[136:139], v[120:123]
  s_waitcnt lgkmcnt(0)
  s_barrier
  v_mfma_f32_16x16x32_bf16 v[12:15], v[184:187], v[168:171], v[12:15]
  ds_read_b128 v[124:127], v212 offset:0
  v_mfma_f32_16x16x32_bf16 v[16:19], v[184:187], v[172:175], v[16:19]
  ds_read_b64_tr_b16 v[140:141], v213 offset:0
  v_mfma_f32_16x16x32_bf16 v[20:23], v[184:187], v[176:179], v[20:23]
  ds_read_b64_tr_b16 v[142:143], v213 offset:7168
  v_mfma_f32_16x16x32_bf16 v[24:27], v[184:187], v[180:183], v[24:27]
  ds_read_b128 v[128:131], v212 offset:1024
  v_mfma_f32_16x16x32_bf16 v[40:43], v[188:191], v[180:183], v[40:43]
  ds_read_b128 v[132:135], v212 offset:2048
  v_mfma_f32_16x16x32_bf16 v[36:39], v[188:191], v[176:179], v[36:39]
  ds_read_b128 v[136:139], v212 offset:3072
  v_mfma_f32_16x16x32_bf16 v[32:35], v[188:191], v[172:175], v[32:35]
  ds_read_b64_tr_b16 v[144:145], v214 offset:0
  v_mfma_f32_16x16x32_bf16 v[28:31], v[188:191], v[168:171], v[28:31]
  ds_read_b64_tr_b16 v[146:147], v214 offset:7168
  v_mfma_f32_16x16x32_bf16 v[44:47], v[192:195], v[168:171], v[44:47]
  ds_read_b64_tr_b16 v[148:149], v215 offset:0
  v_mfma_f32_16x16x32_bf16 v[48:51], v[192:195], v[172:175], v[48:51]
  ds_read_b64_tr_b16 v[150:151], v215 offset:7168
  v_mfma_f32_16x16x32_bf16 v[52:55], v[192:195], v[176:179], v[52:55]
  ds_read_b64_tr_b16 v[152:153], v216 offset:0
  v_mfma_f32_16x16x32_bf16 v[56:59], v[192:195], v[180:183], v[56:59]
  ds_read_b64_tr_b16 v[154:155], v216 offset:7168
  v_mfma_f32_16x16x32_bf16 v[72:75], v[196:199], v[180:183], v[72:75]
  ds_read_b64_tr_b16 v[156:157], v217 offset:0
  v_mfma_f32_16x16x32_bf16 v[68:71], v[196:199], v[176:179], v[68:71]
  ds_read_b64_tr_b16 v[158:159], v217 offset:7168
  v_mfma_f32_16x16x32_bf16 v[64:67], v[196:199], v[172:175], v[64:67]
  ds_read_b64_tr_b16 v[160:161], v218 offset:0
  v_mfma_f32_16x16x32_bf16 v[60:63], v[196:199], v[168:171], v[60:63]
  ds_read_b64_tr_b16 v[162:163], v218 offset:7168
  v_mfma_f32_16x16x32_bf16 v[76:79], v[200:203], v[168:171], v[76:79]
  ds_read_b64_tr_b16 v[164:165], v219 offset:0
  v_mfma_f32_16x16x32_bf16 v[80:83], v[200:203], v[172:175], v[80:83]
  ds_read_b64_tr_b16 v[166:167], v219 offset:7168
  v_mfma_f32_16x16x32_bf16 v[84:87], v[200:203], v[176:179], v[84:87]
  v_mfma_f32_16x16x32_bf16 v[88:91], v[200:203], v[180:183], v[88:91]
  v_mfma_f32_16x16x32_bf16 v[104:107], v[204:207], v[180:183], v[104:107]
  v_mfma_f32_16x16x32_bf16 v[100:103], v[204:207], v[176:179], v[100:103]
  v_mfma_f32_16x16x32_bf16 v[96:99], v[204:207], v[172:175], v[96:99]
  v_mfma_f32_16x16x32_bf16 v[92:95], v[204:207], v[168:171], v[92:95]
  v_mfma_f32_16x16x32_bf16 v[108:111], v[208:211], v[168:171], v[108:111]
  v_mfma_f32_16x16x32_bf16 v[112:115], v[208:211], v[172:175], v[112:115]
  v_mfma_f32_16x16x32_bf16 v[116:119], v[208:211], v[176:179], v[116:119]
  v_mfma_f32_16x16x32_bf16 v[120:123], v[208:211], v[180:183], v[120:123]
  s_waitcnt lgkmcnt(0)
  v_mfma_f32_16x16x32_bf16 v[12:15], v[140:143], v[124:127], v[12:15]
  ds_read_b128 v[168:171], v212 offset:8192
  v_mfma_f32_16x16x32_bf16 v[16:19], v[140:143], v[128:131], v[16:19]
  ds_read_b64_tr_b16 v[184:185], v213 offset:14336
  s_nop 0
  v_mfma_f32_16x16x32_bf16 v[20:23], v[140:143], v[132:135], v[20:23]
  ds_read_b64_tr_b16 v[186:187], v213 offset:21504
  v_mfma_f32_16x16x32_bf16 v[24:27], v[140:143], v[136:139], v[24:27]
  ds_read_b128 v[172:175], v212 offset:9216
  v_mfma_f32_16x16x32_bf16 v[40:43], v[144:147], v[136:139], v[40:43]
  ds_read_b128 v[176:179], v212 offset:10240
  v_mfma_f32_16x16x32_bf16 v[36:39], v[144:147], v[132:135], v[36:39]
  ds_read_b128 v[180:183], v212 offset:11264
  v_mfma_f32_16x16x32_bf16 v[32:35], v[144:147], v[128:131], v[32:35]
  ds_read_b64_tr_b16 v[188:189], v214 offset:14336
  v_mfma_f32_16x16x32_bf16 v[28:31], v[144:147], v[124:127], v[28:31]
  ds_read_b64_tr_b16 v[190:191], v214 offset:21504
  v_mfma_f32_16x16x32_bf16 v[44:47], v[148:151], v[124:127], v[44:47]
  ds_read_b64_tr_b16 v[192:193], v215 offset:14336
  v_mfma_f32_16x16x32_bf16 v[48:51], v[148:151], v[128:131], v[48:51]
  ds_read_b64_tr_b16 v[194:195], v215 offset:21504
  v_mfma_f32_16x16x32_bf16 v[52:55], v[148:151], v[132:135], v[52:55]
  ds_read_b64_tr_b16 v[196:197], v216 offset:14336
  v_mfma_f32_16x16x32_bf16 v[56:59], v[148:151], v[136:139], v[56:59]
  ds_read_b64_tr_b16 v[198:199], v216 offset:21504
  v_mfma_f32_16x16x32_bf16 v[72:75], v[152:155], v[136:139], v[72:75]
  ds_read_b64_tr_b16 v[200:201], v217 offset:14336
  v_mfma_f32_16x16x32_bf16 v[68:71], v[152:155], v[132:135], v[68:71]
  ds_read_b64_tr_b16 v[202:203], v217 offset:21504
  v_mfma_f32_16x16x32_bf16 v[64:67], v[152:155], v[128:131], v[64:67]
  ds_read_b64_tr_b16 v[204:205], v218 offset:14336
  v_mfma_f32_16x16x32_bf16 v[60:63], v[152:155], v[124:127], v[60:63]
  ds_read_b64_tr_b16 v[206:207], v218 offset:21504
  v_mfma_f32_16x16x32_bf16 v[76:79], v[156:159], v[124:127], v[76:79]
  ds_read_b64_tr_b16 v[208:209], v219 offset:14336
  v_mfma_f32_16x16x32_bf16 v[80:83], v[156:159], v[128:131], v[80:83]
  ds_read_b64_tr_b16 v[210:211], v219 offset:21504
  v_mfma_f32_16x16x32_bf16 v[84:87], v[156:159], v[132:135], v[84:87]
  s_add_u32 s54, s54, 1
  s_cmp_lt_u32 s54, 5
  v_mfma_f32_16x16x32_bf16 v[88:91], v[156:159], v[136:139], v[88:91]
  v_mfma_f32_16x16x32_bf16 v[104:107], v[160:163], v[136:139], v[104:107]
  v_mfma_f32_16x16x32_bf16 v[100:103], v[160:163], v[132:135], v[100:103]
  v_mfma_f32_16x16x32_bf16 v[96:99], v[160:163], v[128:131], v[96:99]
  v_mfma_f32_16x16x32_bf16 v[92:95], v[160:163], v[124:127], v[92:95]
  v_mfma_f32_16x16x32_bf16 v[108:111], v[164:167], v[124:127], v[108:111]
  v_mfma_f32_16x16x32_bf16 v[112:115], v[164:167], v[128:131], v[112:115]
  v_mfma_f32_16x16x32_bf16 v[116:119], v[164:167], v[132:135], v[116:119]
  v_mfma_f32_16x16x32_bf16 v[120:123], v[164:167], v[136:139], v[120:123]
  s_waitcnt lgkmcnt(0)
  s_cbranch_scc1 Lc_2012
  s_barrier
  v_mfma_f32_16x16x32_bf16 v[12:15], v[184:187], v[168:171], v[12:15]
  ds_read_b32 v124, v10 offset:0
  v_mfma_f32_16x16x32_bf16 v[16:19], v[184:187], v[172:175], v[16:19]
  s_nop 0
  ds_read_b32 v160, v10 offset:512
  v_mfma_f32_16x16x32_bf16 v[20:23], v[184:187], v[176:179], v[20:23]
  ds_read_b32 v126, v10 offset:64
  v_mfma_f32_16x16x32_bf16 v[24:27], v[184:187], v[180:183], v[24:27]
  ds_read_b32 v162, v10 offset:576
  v_mfma_f32_16x16x32_bf16 v[40:43], v[188:191], v[180:183], v[40:43]
  ds_read_b32 v128, v10 offset:128
  v_mfma_f32_16x16x32_bf16 v[36:39], v[188:191], v[176:179], v[36:39]
  ds_read_b32 v164, v10 offset:640
  v_mfma_f32_16x16x32_bf16 v[32:35], v[188:191], v[172:175], v[32:35]
  ds_read_b32 v130, v10 offset:192
  v_mfma_f32_16x16x32_bf16 v[28:31], v[188:191], v[168:171], v[28:31]
  ds_read_b32 v166, v10 offset:704
  v_mfma_f32_16x16x32_bf16 v[44:47], v[192:195], v[168:171], v[44:47]
  ds_read_b128 v[156:159], v9 offset:384
  v_mfma_f32_16x16x32_bf16 v[48:51], v[192:195], v[172:175], v[48:51]
  ds_read_b128 v[132:135], v11 offset:0
  v_mfma_f32_16x16x32_bf16 v[52:55], v[192:195], v[176:179], v[52:55]
  ds_read_b128 v[136:139], v11 offset:64
  v_mfma_f32_16x16x32_bf16 v[56:59], v[192:195], v[180:183], v[56:59]
  ds_read_b128 v[140:143], v11 offset:128
  v_mfma_f32_16x16x32_bf16 v[72:75], v[196:199], v[180:183], v[72:75]
  ds_read_b128 v[144:147], v11 offset:192
  v_mfma_f32_16x16x32_bf16 v[68:71], v[196:199], v[176:179], v[68:71]
  ds_read_b128 v[148:151], v11 offset:256
  v_mfma_f32_16x16x32_bf16 v[64:67], v[196:199], v[172:175], v[64:67]
  ds_read_b128 v[152:155], v11 offset:320
  v_mfma_f32_16x16x32_bf16 v[60:63], v[196:199], v[168:171], v[60:63]
  s_waitcnt vmcnt(0)
  v_mfma_f32_16x16x32_bf16 v[76:79], v[200:203], v[168:171], v[76:79]
  buffer_load_dwordx4 v[220:223], v1, s[8:11], s55 offen offset:0 sc1
  v_mfma_f32_16x16x32_bf16 v[80:83], v[200:203], v[172:175], v[80:83]
  s_nop 0
  buffer_load_dwordx4 v[224:227], v1, s[8:11], s56 offen offset:0 sc1
  v_mfma_f32_16x16x32_bf16 v[84:87], v[200:203], v[176:179], v[84:87]
  buffer_load_dwordx4 v[228:231], v1, s[8:11], s55 offen offset:1024 sc1
  v_mfma_f32_16x16x32_bf16 v[88:91], v[200:203], v[180:183], v[88:91]
  buffer_load_dwordx4 v[232:235], v1, s[8:11], s56 offen offset:1024 sc1
  v_mfma_f32_16x16x32_bf16 v[104:107], v[204:207], v[180:183], v[104:107]
  v_mfma_f32_16x16x32_bf16 v[100:103], v[204:207], v[176:179], v[100:103]
  v_mfma_f32_16x16x32_bf16 v[96:99], v[204:207], v[172:175], v[96:99]
  v_mfma_f32_16x16x32_bf16 v[92:95], v[204:207], v[168:171], v[92:95]
  v_mfma_f32_16x16x32_bf16 v[108:111], v[208:211], v[168:171], v[108:111]
  v_mfma_f32_16x16x32_bf16 v[112:115], v[208:211], v[172:175], v[112:115]
  v_mfma_f32_16x16x32_bf16 v[116:119], v[208:211], v[176:179], v[116:119]
  v_mfma_f32_16x16x32_bf16 v[120:123], v[208:211], v[180:183], v[120:123]
  s_nop 7
  s_waitcnt lgkmcnt(0)
  v_lshlrev_b32 v200, 16, v252
  v_and_b32 v201, 0xffff0000, v252
  v_lshlrev_b32 v202, 16, v253
  v_and_b32 v203, 0xffff0000, v253
  v_pk_fma_f32 v[204:205], v[156:157], v[160:161], v[200:201] op_sel_hi:[1,0,1]
  v_pk_fma_f32 v[206:207], v[158:159], v[160:161], v[202:203] op_sel_hi:[1,0,1]
  v_pk_fma_f32 v[208:209], v[156:157], v[162:163], v[200:201] op_sel_hi:[1,0,1]
  v_pk_fma_f32 v[210:211], v[158:159], v[162:163], v[202:203] op_sel_hi:[1,0,1]
  v_pk_fma_f32 v[108:109], v[108:109], v[124:125], v[204:205] op_sel_hi:[1,0,1]
  v_pk_fma_f32 v[110:111], v[110:111], v[124:125], v[206:207] op_sel_hi:[1,0,1]
  v_pk_fma_f32 v[112:113], v[112:113], v[126:127], v[208:209] op_sel_hi:[1,0,1]
  v_pk_fma_f32 v[114:115], v[114:115], v[126:127], v[210:211] op_sel_hi:[1,0,1]
  v_pk_mul_f32 v[204:205], v[108:109], v[108:109]
  v_pk_mul_f32 v[206:207], v[110:111], v[110:111]
  v_pk_mul_f32 v[208:209], v[112:113], v[112:113]
  v_pk_mul_f32 v[210:211], v[114:115], v[114:115]
  v_pk_fma_f32 v[204:205], v[204:205], v[4:5], v[6:7] op_sel_hi:[1,0,0]
  v_pk_fma_f32 v[206:207], v[206:207], v[4:5], v[6:7] op_sel_hi:[1,0,0]
  v_pk_fma_f32 v[208:209], v[208:209], v[4:5], v[6:7] op_sel_hi:[1,0,0]
  v_pk_fma_f32 v[210:211], v[210:211], v[4:5], v[6:7] op_sel_hi:[1,0,0]
  v_pk_mul_f32 v[204:205], v[204:205], v[108:109]
  v_pk_mul_f32 v[206:207], v[206:207], v[110:111]
  v_pk_mul_f32 v[208:209], v[208:209], v[112:113]
  v_pk_mul_f32 v[210:211], v[210:211], v[114:115]
  v_exp_f32 v204, v204
  v_exp_f32 v205, v205
  v_exp_f32 v206, v206
  v_exp_f32 v207, v207
  v_exp_f32 v208, v208
  v_exp_f32 v209, v209
  v_exp_f32 v210, v210
  v_exp_f32 v211, v211
  v_pk_add_f32 v[204:205], v[204:205], 1.0 op_sel_hi:[1,0]
  v_pk_add_f32 v[206:207], v[206:207], 1.0 op_sel_hi:[1,0]
  v_pk_add_f32 v[208:209], v[208:209], 1.0 op_sel_hi:[1,0]
  v_pk_add_f32 v[210:211], v[210:211], 1.0 op_sel_hi:[1,0]
  v_rcp_f32 v204, v204
  v_rcp_f32 v205, v205
  v_rcp_f32 v206, v206
  v_rcp_f32 v207, v207
  v_rcp_f32 v208, v208
  v_rcp_f32 v209, v209
  v_rcp_f32 v210, v210
  v_rcp_f32 v211, v211
  v_pk_mul_f32 v[204:205], v[204:205], v[108:109]
  v_pk_mul_f32 v[206:207], v[206:207], v[110:111]
  v_pk_mul_f32 v[208:209], v[208:209], v[112:113]
  v_pk_mul_f32 v[210:211], v[210:211], v[114:115]
  v_cvt_pk_bf16_f32 v184, v204, v205
  v_cvt_pk_bf16_f32 v185, v206, v207
  v_cvt_pk_bf16_f32 v188, v208, v209
  v_cvt_pk_bf16_f32 v189, v210, v211
  buffer_store_dwordx2 v[184:185], v8, s[8:11], s3 offen offset:0 sc1
  ds_write_b64 v7, v[184:185] offset:24576
  buffer_store_dwordx2 v[188:189], v8, s[8:11], s3 offen offset:1024 sc1
  ds_write_b64 v7, v[188:189] offset:25600
  v_pk_fma_f32 v[204:205], v[156:157], v[164:165], v[200:201] op_sel_hi:[1,0,1]
  v_pk_fma_f32 v[206:207], v[158:159], v[164:165], v[202:203] op_sel_hi:[1,0,1]
  v_pk_fma_f32 v[208:209], v[156:157], v[166:167], v[200:201] op_sel_hi:[1,0,1]
  v_pk_fma_f32 v[210:211], v[158:159], v[166:167], v[202:203] op_sel_hi:[1,0,1]
  v_pk_fma_f32 v[116:117], v[116:117], v[128:129], v[204:205] op_sel_hi:[1,0,1]
  v_pk_fma_f32 v[118:119], v[118:119], v[128:129], v[206:207] op_sel_hi:[1,0,1]
  v_pk_fma_f32 v[120:121], v[120:121], v[130:131], v[208:209] op_sel_hi:[1,0,1]
  v_pk_fma_f32 v[122:123], v[122:123], v[130:131], v[210:211] op_sel_hi:[1,0,1]
  v_pk_mul_f32 v[204:205], v[116:117], v[116:117]
  v_pk_mul_f32 v[206:207], v[118:119], v[118:119]
  v_pk_mul_f32 v[208:209], v[120:121], v[120:121]
  v_pk_mul_f32 v[210:211], v[122:123], v[122:123]
  v_pk_fma_f32 v[204:205], v[204:205], v[4:5], v[6:7] op_sel_hi:[1,0,0]
  v_pk_fma_f32 v[206:207], v[206:207], v[4:5], v[6:7] op_sel_hi:[1,0,0]
  v_pk_fma_f32 v[208:209], v[208:209], v[4:5], v[6:7] op_sel_hi:[1,0,0]
  v_pk_fma_f32 v[210:211], v[210:211], v[4:5], v[6:7] op_sel_hi:[1,0,0]
  v_pk_mul_f32 v[204:205], v[204:205], v[116:117]
  v_pk_mul_f32 v[206:207], v[206:207], v[118:119]
  v_pk_mul_f32 v[208:209], v[208:209], v[120:121]
  v_pk_mul_f32 v[210:211], v[210:211], v[122:123]
  v_exp_f32 v204, v204
  v_exp_f32 v205, v205
  v_exp_f32 v206, v206
  v_exp_f32 v207, v207
  v_exp_f32 v208, v208
  v_exp_f32 v209, v209
  v_exp_f32 v210, v210
  v_exp_f32 v211, v211
  v_pk_add_f32 v[204:205], v[204:205], 1.0 op_sel_hi:[1,0]
  v_pk_add_f32 v[206:207], v[206:207], 1.0 op_sel_hi:[1,0]
  v_pk_add_f32 v[208:209], v[208:209], 1.0 op_sel_hi:[1,0]
  v_pk_add_f32 v[210:211], v[210:211], 1.0 op_sel_hi:[1,0]
  v_rcp_f32 v204, v204
  v_rcp_f32 v205, v205
  v_rcp_f32 v206, v206
  v_rcp_f32 v207, v207
  v_rcp_f32 v208, v208
  v_rcp_f32 v209, v209
  v_rcp_f32 v210, v210
  v_rcp_f32 v211, v211
  v_pk_mul_f32 v[204:205], v[204:205], v[116:117]
  v_pk_mul_f32 v[206:207], v[206:207], v[118:119]
  v_pk_mul_f32 v[208:209], v[208:209], v[120:121]
  v_pk_mul_f32 v[210:211], v[210:211], v[122:123]
  v_cvt_pk_bf16_f32 v192, v204, v205
  v_cvt_pk_bf16_f32 v193, v206, v207
  v_cvt_pk_bf16_f32 v196, v208, v209
  v_cvt_pk_bf16_f32 v197, v210, v211
  buffer_store_dwordx2 v[192:193], v8, s[8:11], s3 offen offset:2048 sc1
  ds_write_b64 v7, v[192:193] offset:26624
  buffer_store_dwordx2 v[196:197], v8, s[8:11], s3 offen offset:3072 sc1
  ds_write_b64 v7, v[196:197] offset:27648
  s_add_u32 s3, s5, 0
  v_lshlrev_b32 v200, 16, v240
  v_and_b32 v201, 0xffff0000, v240
  v_lshlrev_b32_e64 v202, 16, v241
  v_and_b32 v203, 0xffff0000, v241
  v_pk_fma_f32 v[204:205], v[132:133], v[160:161], v[200:201] op_sel_hi:[1,0,1]
  v_pk_fma_f32 v[206:207], v[134:135], v[160:161], v[202:203] op_sel_hi:[1,0,1]
  v_pk_fma_f32 v[208:209], v[132:133], v[162:163], v[200:201] op_sel_hi:[1,0,1]
  v_pk_fma_f32 v[210:211], v[134:135], v[162:163], v[202:203] op_sel_hi:[1,0,1]
  v_pk_fma_f32 v[12:13], v[12:13], v[124:125], v[204:205] op_sel_hi:[1,0,1]
  v_pk_fma_f32 v[14:15], v[14:15], v[124:125], v[206:207] op_sel_hi:[1,0,1]
  v_pk_fma_f32 v[16:17], v[16:17], v[126:127], v[208:209] op_sel_hi:[1,0,1]
  v_pk_fma_f32 v[18:19], v[18:19], v[126:127], v[210:211] op_sel_hi:[1,0,1]
  v_pk_mul_f32 v[204:205], v[12:13], v[12:13]
  v_pk_mul_f32 v[206:207], v[14:15], v[14:15]
  v_pk_mul_f32 v[208:209], v[16:17], v[16:17]
  v_pk_mul_f32 v[210:211], v[18:19], v[18:19]
  v_pk_fma_f32 v[204:205], v[204:205], v[4:5], v[6:7] op_sel_hi:[1,0,0]
  v_pk_fma_f32 v[206:207], v[206:207], v[4:5], v[6:7] op_sel_hi:[1,0,0]
  v_pk_fma_f32 v[208:209], v[208:209], v[4:5], v[6:7] op_sel_hi:[1,0,0]
  v_pk_fma_f32 v[210:211], v[210:211], v[4:5], v[6:7] op_sel_hi:[1,0,0]
  v_pk_mul_f32 v[204:205], v[204:205], v[12:13]
  v_pk_mul_f32 v[206:207], v[206:207], v[14:15]
  v_pk_mul_f32 v[208:209], v[208:209], v[16:17]
  v_pk_mul_f32 v[210:211], v[210:211], v[18:19]
  v_exp_f32 v204, v204
  v_exp_f32 v205, v205
  v_exp_f32 v206, v206
  v_exp_f32 v207, v207
  v_exp_f32 v208, v208
  v_exp_f32 v209, v209
  v_exp_f32 v210, v210
  v_exp_f32 v211, v211
  v_pk_add_f32 v[204:205], v[204:205], 1.0 op_sel_hi:[1,0]
  v_pk_add_f32 v[206:207], v[206:207], 1.0 op_sel_hi:[1,0]
  v_pk_add_f32 v[208:209], v[208:209], 1.0 op_sel_hi:[1,0]
  v_pk_add_f32 v[210:211], v[210:211], 1.0 op_sel_hi:[1,0]
  v_rcp_f32 v204, v204
  v_rcp_f32 v205, v205
  v_rcp_f32 v206, v206
  v_rcp_f32 v207, v207
  v_rcp_f32 v208, v208
  v_rcp_f32 v209, v209
  v_rcp_f32 v210, v210
  v_rcp_f32 v211, v211
  v_pk_mul_f32 v[204:205], v[204:205], v[12:13]
  v_pk_mul_f32 v[206:207], v[206:207], v[14:15]
  v_pk_mul_f32 v[208:209], v[208:209], v[16:17]
  v_pk_mul_f32 v[210:211], v[210:211], v[18:19]
  v_cvt_pk_bf16_f32 v168, v204, v205
  v_cvt_pk_bf16_f32 v169, v206, v207
  v_cvt_pk_bf16_f32 v172, v208, v209
  v_cvt_pk_bf16_f32 v173, v210, v211
  v_pk_fma_f32 v[204:205], v[132:133], v[164:165], v[200:201] op_sel_hi:[1,0,1]
  v_pk_fma_f32 v[206:207], v[134:135], v[164:165], v[202:203] op_sel_hi:[1,0,1]
  v_pk_fma_f32 v[208:209], v[132:133], v[166:167], v[200:201] op_sel_hi:[1,0,1]
  v_pk_fma_f32 v[210:211], v[134:135], v[166:167], v[202:203] op_sel_hi:[1,0,1]
  v_pk_fma_f32 v[20:21], v[20:21], v[128:129], v[204:205] op_sel_hi:[1,0,1]
  v_pk_fma_f32 v[22:23], v[22:23], v[128:129], v[206:207] op_sel_hi:[1,0,1]
  v_pk_fma_f32 v[24:25], v[24:25], v[130:131], v[208:209] op_sel_hi:[1,0,1]
  v_pk_fma_f32 v[26:27], v[26:27], v[130:131], v[210:211] op_sel_hi:[1,0,1]
  v_pk_mul_f32 v[204:205], v[20:21], v[20:21]
  v_pk_mul_f32 v[206:207], v[22:23], v[22:23]
  v_pk_mul_f32 v[208:209], v[24:25], v[24:25]
  v_pk_mul_f32 v[210:211], v[26:27], v[26:27]
  v_pk_fma_f32 v[204:205], v[204:205], v[4:5], v[6:7] op_sel_hi:[1,0,0]
  v_pk_fma_f32 v[206:207], v[206:207], v[4:5], v[6:7] op_sel_hi:[1,0,0]
  v_pk_fma_f32 v[208:209], v[208:209], v[4:5], v[6:7] op_sel_hi:[1,0,0]
  v_pk_fma_f32 v[210:211], v[210:211], v[4:5], v[6:7] op_sel_hi:[1,0,0]
  v_pk_mul_f32 v[204:205], v[204:205], v[20:21]
  v_pk_mul_f32 v[206:207], v[206:207], v[22:23]
  v_pk_mul_f32 v[208:209], v[208:209], v[24:25]
  v_pk_mul_f32 v[210:211], v[210:211], v[26:27]
  v_exp_f32 v204, v204
  v_exp_f32 v205, v205
  v_exp_f32 v206, v206
  v_exp_f32 v207, v207
  v_exp_f32 v208, v208
  v_exp_f32 v209, v209
  v_exp_f32 v210, v210
  v_exp_f32 v211, v211
  v_pk_add_f32 v[204:205], v[204:205], 1.0 op_sel_hi:[1,0]
  v_pk_add_f32 v[206:207], v[206:207], 1.0 op_sel_hi:[1,0]
  v_pk_add_f32 v[208:209], v[208:209], 1.0 op_sel_hi:[1,0]
  v_pk_add_f32 v[210:211], v[210:211], 1.0 op_sel_hi:[1,0]
  v_rcp_f32 v204, v204
  v_rcp_f32 v205, v205
  v_rcp_f32 v206, v206
  v_rcp_f32 v207, v207
  v_rcp_f32 v208, v208
  v_rcp_f32 v209, v209
  v_rcp_f32 v210, v210
  v_rcp_f32 v211, v211
  v_pk_mul_f32 v[204:205], v[204:205], v[20:21]
  v_pk_mul_f32 v[206:207], v[206:207], v[22:23]
  v_pk_mul_f32 v[208:209], v[208:209], v[24:25]
  v_pk_mul_f32 v[210:211], v[210:211], v[26:27]
  v_cvt_pk_bf16_f32 v176, v204, v205
  v_cvt_pk_bf16_f32 v177, v206, v207
  v_cvt_pk_bf16_f32 v180, v208, v209
  v_cvt_pk_bf16_f32 v181, v210, v211
  v_lshlrev_b32 v200, 16, v242
  v_and_b32 v201, 0xffff0000, v242
  v_lshlrev_b32 v202, 16, v243
  v_and_b32 v203, 0xffff0000, v243
  v_pk_fma_f32 v[204:205], v[136:137], v[160:161], v[200:201] op_sel_hi:[1,0,1]
  v_pk_fma_f32 v[206:207], v[138:139], v[160:161], v[202:203] op_sel_hi:[1,0,1]
  v_pk_fma_f32 v[208:209], v[136:137], v[162:163], v[200:201] op_sel_hi:[1,0,1]
  v_pk_fma_f32 v[210:211], v[138:139], v[162:163], v[202:203] op_sel_hi:[1,0,1]
  v_pk_fma_f32 v[28:29], v[28:29], v[124:125], v[204:205] op_sel_hi:[1,0,1]
  v_pk_fma_f32 v[30:31], v[30:31], v[124:125], v[206:207] op_sel_hi:[1,0,1]
  v_pk_fma_f32 v[32:33], v[32:33], v[126:127], v[208:209] op_sel_hi:[1,0,1]
  v_pk_fma_f32 v[34:35], v[34:35], v[126:127], v[210:211] op_sel_hi:[1,0,1]
  v_pk_mul_f32 v[204:205], v[28:29], v[28:29]
  v_pk_mul_f32 v[206:207], v[30:31], v[30:31]
  v_pk_mul_f32 v[208:209], v[32:33], v[32:33]
  v_pk_mul_f32 v[210:211], v[34:35], v[34:35]
  v_pk_fma_f32 v[204:205], v[204:205], v[4:5], v[6:7] op_sel_hi:[1,0,0]
  v_pk_fma_f32 v[206:207], v[206:207], v[4:5], v[6:7] op_sel_hi:[1,0,0]
  v_pk_fma_f32 v[208:209], v[208:209], v[4:5], v[6:7] op_sel_hi:[1,0,0]
  v_pk_fma_f32 v[210:211], v[210:211], v[4:5], v[6:7] op_sel_hi:[1,0,0]
  v_pk_mul_f32 v[204:205], v[204:205], v[28:29]
  v_pk_mul_f32 v[206:207], v[206:207], v[30:31]
  v_pk_mul_f32 v[208:209], v[208:209], v[32:33]
  v_pk_mul_f32 v[210:211], v[210:211], v[34:35]
  v_exp_f32 v204, v204
  v_exp_f32 v205, v205
  v_exp_f32 v206, v206
  v_exp_f32 v207, v207
  v_exp_f32 v208, v208
  v_exp_f32 v209, v209
  v_exp_f32 v210, v210
  v_exp_f32 v211, v211
  v_pk_add_f32 v[204:205], v[204:205], 1.0 op_sel_hi:[1,0]
  v_pk_add_f32 v[206:207], v[206:207], 1.0 op_sel_hi:[1,0]
  v_pk_add_f32 v[208:209], v[208:209], 1.0 op_sel_hi:[1,0]
  v_pk_add_f32 v[210:211], v[210:211], 1.0 op_sel_hi:[1,0]
  v_rcp_f32 v204, v204
  v_rcp_f32 v205, v205
  v_rcp_f32 v206, v206
  v_rcp_f32 v207, v207
  v_rcp_f32 v208, v208
  v_rcp_f32 v209, v209
  v_rcp_f32 v210, v210
  v_rcp_f32 v211, v211
  v_pk_mul_f32 v[204:205], v[204:205], v[28:29]
  v_pk_mul_f32 v[206:207], v[206:207], v[30:31]
  v_pk_mul_f32 v[208:209], v[208:209], v[32:33]
  v_pk_mul_f32 v[210:211], v[210:211], v[34:35]
  v_cvt_pk_bf16_f32 v170, v204, v205
  v_cvt_pk_bf16_f32 v171, v206, v207
  v_cvt_pk_bf16_f32 v174, v208, v209
  v_cvt_pk_bf16_f32 v175, v210, v211
  buffer_store_dwordx4 v[168:171], v1, s[8:11], s3 offen offset:0 sc1
  ds_write_b128 v3, v[168:171] offset:0
  buffer_store_dwordx4 v[172:175], v1, s[8:11], s3 offen offset:1024 sc1
  ds_write_b128 v3, v[172:175] offset:1024
  v_pk_fma_f32 v[204:205], v[136:137], v[164:165], v[200:201] op_sel_hi:[1,0,1]
  v_pk_fma_f32 v[206:207], v[138:139], v[164:165], v[202:203] op_sel_hi:[1,0,1]
  v_pk_fma_f32 v[208:209], v[136:137], v[166:167], v[200:201] op_sel_hi:[1,0,1]
  v_pk_fma_f32 v[210:211], v[138:139], v[166:167], v[202:203] op_sel_hi:[1,0,1]
  v_pk_fma_f32 v[36:37], v[36:37], v[128:129], v[204:205] op_sel_hi:[1,0,1]
  v_pk_fma_f32 v[38:39], v[38:39], v[128:129], v[206:207] op_sel_hi:[1,0,1]
  v_pk_fma_f32 v[40:41], v[40:41], v[130:131], v[208:209] op_sel_hi:[1,0,1]
  v_pk_fma_f32 v[42:43], v[42:43], v[130:131], v[210:211] op_sel_hi:[1,0,1]
  v_pk_mul_f32 v[204:205], v[36:37], v[36:37]
  v_pk_mul_f32 v[206:207], v[38:39], v[38:39]
  v_pk_mul_f32 v[208:209], v[40:41], v[40:41]
  v_pk_mul_f32 v[210:211], v[42:43], v[42:43]
  v_pk_fma_f32 v[204:205], v[204:205], v[4:5], v[6:7] op_sel_hi:[1,0,0]
  v_pk_fma_f32 v[206:207], v[206:207], v[4:5], v[6:7] op_sel_hi:[1,0,0]
  v_pk_fma_f32 v[208:209], v[208:209], v[4:5], v[6:7] op_sel_hi:[1,0,0]
  v_pk_fma_f32 v[210:211], v[210:211], v[4:5], v[6:7] op_sel_hi:[1,0,0]
  v_pk_mul_f32 v[204:205], v[204:205], v[36:37]
  v_pk_mul_f32 v[206:207], v[206:207], v[38:39]
  v_pk_mul_f32 v[208:209], v[208:209], v[40:41]
  v_pk_mul_f32 v[210:211], v[210:211], v[42:43]
  v_exp_f32 v204, v204
  v_exp_f32 v205, v205
  v_exp_f32 v206, v206
  v_exp_f32 v207, v207
  v_exp_f32 v208, v208
  v_exp_f32 v209, v209
  v_exp_f32 v210, v210
  v_exp_f32 v211, v211
  v_pk_add_f32 v[204:205], v[204:205], 1.0 op_sel_hi:[1,0]
  v_pk_add_f32 v[206:207], v[206:207], 1.0 op_sel_hi:[1,0]
  v_pk_add_f32 v[208:209], v[208:209], 1.0 op_sel_hi:[1,0]
  v_pk_add_f32 v[210:211], v[210:211], 1.0 op_sel_hi:[1,0]
  v_rcp_f32 v204, v204
  v_rcp_f32 v205, v205
  v_rcp_f32 v206, v206
  v_rcp_f32 v207, v207
  v_rcp_f32 v208, v208
  v_rcp_f32 v209, v209
  v_rcp_f32 v210, v210
  v_rcp_f32 v211, v211
  v_pk_mul_f32 v[204:205], v[204:205], v[36:37]
  v_pk_mul_f32 v[206:207], v[206:207], v[38:39]
  v_pk_mul_f32 v[208:209], v[208:209], v[40:41]
  v_pk_mul_f32 v[210:211], v[210:211], v[42:43]
  v_cvt_pk_bf16_f32 v178, v204, v205
  v_cvt_pk_bf16_f32 v179, v206, v207
  v_cvt_pk_bf16_f32 v182, v208, v209
  v_cvt_pk_bf16_f32 v183, v210, v211
  buffer_store_dwordx4 v[176:179], v1, s[8:11], s3 offen offset:2048 sc1
  ds_write_b128 v3, v[176:179] offset:2048
  buffer_store_dwordx4 v[180:183], v1, s[8:11], s3 offen offset:3072 sc1
  ds_write_b128 v3, v[180:183] offset:3072
  s_add_u32 s3, s5, 8192
  v_lshlrev_b32 v200, 16, v244
  v_and_b32 v201, 0xffff0000, v244
  v_lshlrev_b32 v202, 16, v245
  v_and_b32 v203, 0xffff0000, v245
  v_pk_fma_f32 v[204:205], v[140:141], v[160:161], v[200:201] op_sel_hi:[1,0,1]
  v_pk_fma_f32 v[206:207], v[142:143], v[160:161], v[202:203] op_sel_hi:[1,0,1]
  v_pk_fma_f32 v[208:209], v[140:141], v[162:163], v[200:201] op_sel_hi:[1,0,1]
  v_pk_fma_f32 v[210:211], v[142:143], v[162:163], v[202:203] op_sel_hi:[1,0,1]
  v_pk_fma_f32 v[44:45], v[44:45], v[124:125], v[204:205] op_sel_hi:[1,0,1]
  v_pk_fma_f32 v[46:47], v[46:47], v[124:125], v[206:207] op_sel_hi:[1,0,1]
  v_pk_fma_f32 v[48:49], v[48:49], v[126:127], v[208:209] op_sel_hi:[1,0,1]
  v_pk_fma_f32 v[50:51], v[50:51], v[126:127], v[210:211] op_sel_hi:[1,0,1]
  v_pk_mul_f32 v[204:205], v[44:45], v[44:45]
  v_pk_mul_f32 v[206:207], v[46:47], v[46:47]
  v_pk_mul_f32 v[208:209], v[48:49], v[48:49]
  v_pk_mul_f32 v[210:211], v[50:51], v[50:51]
  v_pk_fma_f32 v[204:205], v[204:205], v[4:5], v[6:7] op_sel_hi:[1,0,0]
  v_pk_fma_f32 v[206:207], v[206:207], v[4:5], v[6:7] op_sel_hi:[1,0,0]
  v_pk_fma_f32 v[208:209], v[208:209], v[4:5], v[6:7] op_sel_hi:[1,0,0]
  v_pk_fma_f32 v[210:211], v[210:211], v[4:5], v[6:7] op_sel_hi:[1,0,0]
  v_pk_mul_f32 v[204:205], v[204:205], v[44:45]
  v_pk_mul_f32 v[206:207], v[206:207], v[46:47]
  v_pk_mul_f32 v[208:209], v[208:209], v[48:49]
  v_pk_mul_f32 v[210:211], v[210:211], v[50:51]
  v_exp_f32 v204, v204
  v_exp_f32 v205, v205
  v_exp_f32 v206, v206
  v_exp_f32 v207, v207
  v_exp_f32 v208, v208
  v_exp_f32 v209, v209
  v_exp_f32 v210, v210
  v_exp_f32 v211, v211
  v_pk_add_f32 v[204:205], v[204:205], 1.0 op_sel_hi:[1,0]
  v_pk_add_f32 v[206:207], v[206:207], 1.0 op_sel_hi:[1,0]
  v_pk_add_f32 v[208:209], v[208:209], 1.0 op_sel_hi:[1,0]
  v_pk_add_f32 v[210:211], v[210:211], 1.0 op_sel_hi:[1,0]
  v_rcp_f32 v204, v204
  v_rcp_f32 v205, v205
  v_rcp_f32 v206, v206
  v_rcp_f32 v207, v207
  v_rcp_f32 v208, v208
  v_rcp_f32 v209, v209
  v_rcp_f32 v210, v210
  v_rcp_f32 v211, v211
  v_pk_mul_f32 v[204:205], v[204:205], v[44:45]
  v_pk_mul_f32 v[206:207], v[206:207], v[46:47]
  v_pk_mul_f32 v[208:209], v[208:209], v[48:49]
  v_pk_mul_f32 v[210:211], v[210:211], v[50:51]
  v_cvt_pk_bf16_f32 v184, v204, v205
  v_cvt_pk_bf16_f32 v185, v206, v207
  v_cvt_pk_bf16_f32 v188, v208, v209
  v_cvt_pk_bf16_f32 v189, v210, v211
  v_pk_fma_f32 v[204:205], v[140:141], v[164:165], v[200:201] op_sel_hi:[1,0,1]
  v_pk_fma_f32 v[206:207], v[142:143], v[164:165], v[202:203] op_sel_hi:[1,0,1]
  v_pk_fma_f32 v[208:209], v[140:141], v[166:167], v[200:201] op_sel_hi:[1,0,1]
  v_pk_fma_f32 v[210:211], v[142:143], v[166:167], v[202:203] op_sel_hi:[1,0,1]
  v_pk_fma_f32 v[52:53], v[52:53], v[128:129], v[204:205] op_sel_hi:[1,0,1]
  v_pk_fma_f32 v[54:55], v[54:55], v[128:129], v[206:207] op_sel_hi:[1,0,1]
  v_pk_fma_f32 v[56:57], v[56:57], v[130:131], v[208:209] op_sel_hi:[1,0,1]
  v_pk_fma_f32 v[58:59], v[58:59], v[130:131], v[210:211] op_sel_hi:[1,0,1]
  v_pk_mul_f32 v[204:205], v[52:53], v[52:53]
  v_pk_mul_f32 v[206:207], v[54:55], v[54:55]
  v_pk_mul_f32 v[208:209], v[56:57], v[56:57]
  v_pk_mul_f32 v[210:211], v[58:59], v[58:59]
  v_pk_fma_f32 v[204:205], v[204:205], v[4:5], v[6:7] op_sel_hi:[1,0,0]
  v_pk_fma_f32 v[206:207], v[206:207], v[4:5], v[6:7] op_sel_hi:[1,0,0]
  v_pk_fma_f32 v[208:209], v[208:209], v[4:5], v[6:7] op_sel_hi:[1,0,0]
  v_pk_fma_f32 v[210:211], v[210:211], v[4:5], v[6:7] op_sel_hi:[1,0,0]
  v_pk_mul_f32 v[204:205], v[204:205], v[52:53]
  v_pk_mul_f32 v[206:207], v[206:207], v[54:55]
  v_pk_mul_f32 v[208:209], v[208:209], v[56:57]
  v_pk_mul_f32 v[210:211], v[210:211], v[58:59]
  v_exp_f32 v204, v204
  v_exp_f32 v205, v205
  v_exp_f32 v206, v206
  v_exp_f32 v207, v207
  v_exp_f32 v208, v208
  v_exp_f32 v209, v209
  v_exp_f32 v210, v210
  v_exp_f32 v211, v211
  v_pk_add_f32 v[204:205], v[204:205], 1.0 op_sel_hi:[1,0]
  v_pk_add_f32 v[206:207], v[206:207], 1.0 op_sel_hi:[1,0]
  v_pk_add_f32 v[208:209], v[208:209], 1.0 op_sel_hi:[1,0]
  v_pk_add_f32 v[210:211], v[210:211], 1.0 op_sel_hi:[1,0]
  v_rcp_f32 v204, v204
  v_rcp_f32 v205, v205
  v_rcp_f32 v206, v206
  v_rcp_f32 v207, v207
  v_rcp_f32 v208, v208
  v_rcp_f32 v209, v209
  v_rcp_f32 v210, v210
  v_rcp_f32 v211, v211
  v_pk_mul_f32 v[204:205], v[204:205], v[52:53]
  v_pk_mul_f32 v[206:207], v[206:207], v[54:55]
  v_pk_mul_f32 v[208:209], v[208:209], v[56:57]
  v_pk_mul_f32 v[210:211], v[210:211], v[58:59]
  v_cvt_pk_bf16_f32 v192, v204, v205
  v_cvt_pk_bf16_f32 v193, v206, v207
  v_cvt_pk_bf16_f32 v196, v208, v209
  v_cvt_pk_bf16_f32 v197, v210, v211
  v_lshlrev_b32 v200, 16, v246
  v_and_b32 v201, 0xffff0000, v246
  v_lshlrev_b32 v202, 16, v247
  v_and_b32 v203, 0xffff0000, v247
  v_pk_fma_f32 v[204:205], v[144:145], v[160:161], v[200:201] op_sel_hi:[1,0,1]
  v_pk_fma_f32 v[206:207], v[146:147], v[160:161], v[202:203] op_sel_hi:[1,0,1]
  v_pk_fma_f32 v[208:209], v[144:145], v[162:163], v[200:201] op_sel_hi:[1,0,1]
  v_pk_fma_f32 v[210:211], v[146:147], v[162:163], v[202:203] op_sel_hi:[1,0,1]
  v_pk_fma_f32 v[60:61], v[60:61], v[124:125], v[204:205] op_sel_hi:[1,0,1]
  v_pk_fma_f32 v[62:63], v[62:63], v[124:125], v[206:207] op_sel_hi:[1,0,1]
  v_pk_fma_f32 v[64:65], v[64:65], v[126:127], v[208:209] op_sel_hi:[1,0,1]
  v_pk_fma_f32 v[66:67], v[66:67], v[126:127], v[210:211] op_sel_hi:[1,0,1]
  v_pk_mul_f32 v[204:205], v[60:61], v[60:61]
  v_pk_mul_f32 v[206:207], v[62:63], v[62:63]
  v_pk_mul_f32 v[208:209], v[64:65], v[64:65]
  v_pk_mul_f32 v[210:211], v[66:67], v[66:67]
  v_pk_fma_f32 v[204:205], v[204:205], v[4:5], v[6:7] op_sel_hi:[1,0,0]
  v_pk_fma_f32 v[206:207], v[206:207], v[4:5], v[6:7] op_sel_hi:[1,0,0]
  v_pk_fma_f32 v[208:209], v[208:209], v[4:5], v[6:7] op_sel_hi:[1,0,0]
  v_pk_fma_f32 v[210:211], v[210:211], v[4:5], v[6:7] op_sel_hi:[1,0,0]
  v_pk_mul_f32 v[204:205], v[204:205], v[60:61]
  v_pk_mul_f32 v[206:207], v[206:207], v[62:63]
  v_pk_mul_f32 v[208:209], v[208:209], v[64:65]
  v_pk_mul_f32 v[210:211], v[210:211], v[66:67]
  v_exp_f32 v204, v204
  v_exp_f32 v205, v205
  v_exp_f32 v206, v206
  v_exp_f32 v207, v207
  v_exp_f32 v208, v208
  v_exp_f32 v209, v209
  v_exp_f32 v210, v210
  v_exp_f32 v211, v211
  v_pk_add_f32 v[204:205], v[204:205], 1.0 op_sel_hi:[1,0]
  v_pk_add_f32 v[206:207], v[206:207], 1.0 op_sel_hi:[1,0]
  v_pk_add_f32 v[208:209], v[208:209], 1.0 op_sel_hi:[1,0]
  v_pk_add_f32 v[210:211], v[210:211], 1.0 op_sel_hi:[1,0]
  v_rcp_f32 v204, v204
  v_rcp_f32 v205, v205
  v_rcp_f32 v206, v206
  v_rcp_f32 v207, v207
  v_rcp_f32 v208, v208
  v_rcp_f32 v209, v209
  v_rcp_f32 v210, v210
  v_rcp_f32 v211, v211
  v_pk_mul_f32 v[204:205], v[204:205], v[60:61]
  v_pk_mul_f32 v[206:207], v[206:207], v[62:63]
  v_pk_mul_f32 v[208:209], v[208:209], v[64:65]
  v_pk_mul_f32 v[210:211], v[210:211], v[66:67]
  v_cvt_pk_bf16_f32 v186, v204, v205
  v_cvt_pk_bf16_f32 v187, v206, v207
  v_cvt_pk_bf16_f32 v190, v208, v209
  v_cvt_pk_bf16_f32 v191, v210, v211
  buffer_store_dwordx4 v[184:187], v1, s[8:11], s3 offen offset:0 sc1
  ds_write_b128 v3, v[184:187] offset:8192
  buffer_store_dwordx4 v[188:191], v1, s[8:11], s3 offen offset:1024 sc1
  ds_write_b128 v3, v[188:191] offset:9216
  v_pk_fma_f32 v[204:205], v[144:145], v[164:165], v[200:201] op_sel_hi:[1,0,1]
  v_pk_fma_f32 v[206:207], v[146:147], v[164:165], v[202:203] op_sel_hi:[1,0,1]
  v_pk_fma_f32 v[208:209], v[144:145], v[166:167], v[200:201] op_sel_hi:[1,0,1]
  v_pk_fma_f32 v[210:211], v[146:147], v[166:167], v[202:203] op_sel_hi:[1,0,1]
  v_pk_fma_f32 v[68:69], v[68:69], v[128:129], v[204:205] op_sel_hi:[1,0,1]
  v_pk_fma_f32 v[70:71], v[70:71], v[128:129], v[206:207] op_sel_hi:[1,0,1]
  v_pk_fma_f32 v[72:73], v[72:73], v[130:131], v[208:209] op_sel_hi:[1,0,1]
  v_pk_fma_f32 v[74:75], v[74:75], v[130:131], v[210:211] op_sel_hi:[1,0,1]
  v_pk_mul_f32 v[204:205], v[68:69], v[68:69]
  v_pk_mul_f32 v[206:207], v[70:71], v[70:71]
  v_pk_mul_f32 v[208:209], v[72:73], v[72:73]
  v_pk_mul_f32 v[210:211], v[74:75], v[74:75]
  v_pk_fma_f32 v[204:205], v[204:205], v[4:5], v[6:7] op_sel_hi:[1,0,0]
  v_pk_fma_f32 v[206:207], v[206:207], v[4:5], v[6:7] op_sel_hi:[1,0,0]
  v_pk_fma_f32 v[208:209], v[208:209], v[4:5], v[6:7] op_sel_hi:[1,0,0]
  v_pk_fma_f32 v[210:211], v[210:211], v[4:5], v[6:7] op_sel_hi:[1,0,0]
  v_pk_mul_f32 v[204:205], v[204:205], v[68:69]
  v_pk_mul_f32 v[206:207], v[206:207], v[70:71]
  v_pk_mul_f32 v[208:209], v[208:209], v[72:73]
  v_pk_mul_f32 v[210:211], v[210:211], v[74:75]
  v_exp_f32 v204, v204
  v_exp_f32 v205, v205
  v_exp_f32 v206, v206
  v_exp_f32 v207, v207
  v_exp_f32 v208, v208
  v_exp_f32 v209, v209
  v_exp_f32 v210, v210
  v_exp_f32 v211, v211
  v_pk_add_f32 v[204:205], v[204:205], 1.0 op_sel_hi:[1,0]
  v_pk_add_f32 v[206:207], v[206:207], 1.0 op_sel_hi:[1,0]
  v_pk_add_f32 v[208:209], v[208:209], 1.0 op_sel_hi:[1,0]
  v_pk_add_f32 v[210:211], v[210:211], 1.0 op_sel_hi:[1,0]
  v_rcp_f32 v204, v204
  v_rcp_f32 v205, v205
  v_rcp_f32 v206, v206
  v_rcp_f32 v207, v207
  v_rcp_f32 v208, v208
  v_rcp_f32 v209, v209
  v_rcp_f32 v210, v210
  v_rcp_f32 v211, v211
  v_pk_mul_f32 v[204:205], v[204:205], v[68:69]
  v_pk_mul_f32 v[206:207], v[206:207], v[70:71]
  v_pk_mul_f32 v[208:209], v[208:209], v[72:73]
  v_pk_mul_f32 v[210:211], v[210:211], v[74:75]
  v_cvt_pk_bf16_f32 v194, v204, v205
  v_cvt_pk_bf16_f32 v195, v206, v207
  v_cvt_pk_bf16_f32 v198, v208, v209
  v_cvt_pk_bf16_f32 v199, v210, v211
  buffer_store_dwordx4 v[192:195], v1, s[8:11], s3 offen offset:2048 sc1
  ds_write_b128 v3, v[192:195] offset:10240
  buffer_store_dwordx4 v[196:199], v1, s[8:11], s3 offen offset:3072 sc1
  ds_write_b128 v3, v[196:199] offset:11264
  s_add_u32 s3, s5, 16384
  v_lshlrev_b32 v200, 16, v248
  v_and_b32 v201, 0xffff0000, v248
  v_lshlrev_b32 v202, 16, v249
  v_and_b32 v203, 0xffff0000, v249
  v_pk_fma_f32 v[204:205], v[148:149], v[160:161], v[200:201] op_sel_hi:[1,0,1]
  v_pk_fma_f32 v[206:207], v[150:151], v[160:161], v[202:203] op_sel_hi:[1,0,1]
  v_pk_fma_f32 v[208:209], v[148:149], v[162:163], v[200:201] op_sel_hi:[1,0,1]
  v_pk_fma_f32 v[210:211], v[150:151], v[162:163], v[202:203] op_sel_hi:[1,0,1]
  v_pk_fma_f32 v[76:77], v[76:77], v[124:125], v[204:205] op_sel_hi:[1,0,1]
  v_pk_fma_f32 v[78:79], v[78:79], v[124:125], v[206:207] op_sel_hi:[1,0,1]
  v_pk_fma_f32 v[80:81], v[80:81], v[126:127], v[208:209] op_sel_hi:[1,0,1]
  v_pk_fma_f32 v[82:83], v[82:83], v[126:127], v[210:211] op_sel_hi:[1,0,1]
  v_pk_mul_f32 v[204:205], v[76:77], v[76:77]
  v_pk_mul_f32 v[206:207], v[78:79], v[78:79]
  v_pk_mul_f32 v[208:209], v[80:81], v[80:81]
  v_pk_mul_f32 v[210:211], v[82:83], v[82:83]
  v_pk_fma_f32 v[204:205], v[204:205], v[4:5], v[6:7] op_sel_hi:[1,0,0]
  v_pk_fma_f32 v[206:207], v[206:207], v[4:5], v[6:7] op_sel_hi:[1,0,0]
  v_pk_fma_f32 v[208:209], v[208:209], v[4:5], v[6:7] op_sel_hi:[1,0,0]
  v_pk_fma_f32 v[210:211], v[210:211], v[4:5], v[6:7] op_sel_hi:[1,0,0]
  v_pk_mul_f32 v[204:205], v[204:205], v[76:77]
  v_pk_mul_f32 v[206:207], v[206:207], v[78:79]
  v_pk_mul_f32 v[208:209], v[208:209], v[80:81]
  v_pk_mul_f32 v[210:211], v[210:211], v[82:83]
  v_exp_f32 v204, v204
  v_exp_f32 v205, v205
  v_exp_f32 v206, v206
  v_exp_f32 v207, v207
  v_exp_f32 v208, v208
  v_exp_f32 v209, v209
  v_exp_f32 v210, v210
  v_exp_f32 v211, v211
  v_pk_add_f32 v[204:205], v[204:205], 1.0 op_sel_hi:[1,0]
  v_pk_add_f32 v[206:207], v[206:207], 1.0 op_sel_hi:[1,0]
  v_pk_add_f32 v[208:209], v[208:209], 1.0 op_sel_hi:[1,0]
  v_pk_add_f32 v[210:211], v[210:211], 1.0 op_sel_hi:[1,0]
  v_rcp_f32 v204, v204
  v_rcp_f32 v205, v205
  v_rcp_f32 v206, v206
  v_rcp_f32 v207, v207
  v_rcp_f32 v208, v208
  v_rcp_f32 v209, v209
  v_rcp_f32 v210, v210
  v_rcp_f32 v211, v211
  v_pk_mul_f32 v[204:205], v[204:205], v[76:77]
  v_pk_mul_f32 v[206:207], v[206:207], v[78:79]
  v_pk_mul_f32 v[208:209], v[208:209], v[80:81]
  v_pk_mul_f32 v[210:211], v[210:211], v[82:83]
  v_cvt_pk_bf16_f32 v168, v204, v205
  v_cvt_pk_bf16_f32 v169, v206, v207
  v_cvt_pk_bf16_f32 v172, v208, v209
  v_cvt_pk_bf16_f32 v173, v210, v211
  v_pk_fma_f32 v[204:205], v[148:149], v[164:165], v[200:201] op_sel_hi:[1,0,1]
  v_pk_fma_f32 v[206:207], v[150:151], v[164:165], v[202:203] op_sel_hi:[1,0,1]
  v_pk_fma_f32 v[208:209], v[148:149], v[166:167], v[200:201] op_sel_hi:[1,0,1]
  v_pk_fma_f32 v[210:211], v[150:151], v[166:167], v[202:203] op_sel_hi:[1,0,1]
  v_pk_fma_f32 v[84:85], v[84:85], v[128:129], v[204:205] op_sel_hi:[1,0,1]
  v_pk_fma_f32 v[86:87], v[86:87], v[128:129], v[206:207] op_sel_hi:[1,0,1]
  v_pk_fma_f32 v[88:89], v[88:89], v[130:131], v[208:209] op_sel_hi:[1,0,1]
  v_pk_fma_f32 v[90:91], v[90:91], v[130:131], v[210:211] op_sel_hi:[1,0,1]
  v_pk_mul_f32 v[204:205], v[84:85], v[84:85]
  v_pk_mul_f32 v[206:207], v[86:87], v[86:87]
  v_pk_mul_f32 v[208:209], v[88:89], v[88:89]
  v_pk_mul_f32 v[210:211], v[90:91], v[90:91]
  v_pk_fma_f32 v[204:205], v[204:205], v[4:5], v[6:7] op_sel_hi:[1,0,0]
  v_pk_fma_f32 v[206:207], v[206:207], v[4:5], v[6:7] op_sel_hi:[1,0,0]
  v_pk_fma_f32 v[208:209], v[208:209], v[4:5], v[6:7] op_sel_hi:[1,0,0]
  v_pk_fma_f32 v[210:211], v[210:211], v[4:5], v[6:7] op_sel_hi:[1,0,0]
  v_pk_mul_f32 v[204:205], v[204:205], v[84:85]
  v_pk_mul_f32 v[206:207], v[206:207], v[86:87]
  v_pk_mul_f32 v[208:209], v[208:209], v[88:89]
  v_pk_mul_f32 v[210:211], v[210:211], v[90:91]
  v_exp_f32 v204, v204
  v_exp_f32 v205, v205
  v_exp_f32 v206, v206
  v_exp_f32 v207, v207
  v_exp_f32 v208, v208
  v_exp_f32 v209, v209
  v_exp_f32 v210, v210
  v_exp_f32 v211, v211
  v_pk_add_f32 v[204:205], v[204:205], 1.0 op_sel_hi:[1,0]
  v_pk_add_f32 v[206:207], v[206:207], 1.0 op_sel_hi:[1,0]
  v_pk_add_f32 v[208:209], v[208:209], 1.0 op_sel_hi:[1,0]
  v_pk_add_f32 v[210:211], v[210:211], 1.0 op_sel_hi:[1,0]
  v_rcp_f32 v204, v204
  v_rcp_f32 v205, v205
  v_rcp_f32 v206, v206
  v_rcp_f32 v207, v207
  v_rcp_f32 v208, v208
  v_rcp_f32 v209, v209
  v_rcp_f32 v210, v210
  v_rcp_f32 v211, v211
  v_pk_mul_f32 v[204:205], v[204:205], v[84:85]
  v_pk_mul_f32 v[206:207], v[206:207], v[86:87]
  v_pk_mul_f32 v[208:209], v[208:209], v[88:89]
  v_pk_mul_f32 v[210:211], v[210:211], v[90:91]
  v_cvt_pk_bf16_f32 v176, v204, v205
  v_cvt_pk_bf16_f32 v177, v206, v207
  v_cvt_pk_bf16_f32 v180, v208, v209
  v_cvt_pk_bf16_f32 v181, v210, v211
  v_lshlrev_b32 v200, 16, v250
  v_and_b32 v201, 0xffff0000, v250
  v_lshlrev_b32 v202, 16, v251
  v_and_b32 v203, 0xffff0000, v251
  v_pk_fma_f32 v[204:205], v[152:153], v[160:161], v[200:201] op_sel_hi:[1,0,1]
  v_pk_fma_f32 v[206:207], v[154:155], v[160:161], v[202:203] op_sel_hi:[1,0,1]
  v_pk_fma_f32 v[208:209], v[152:153], v[162:163], v[200:201] op_sel_hi:[1,0,1]
  v_pk_fma_f32 v[210:211], v[154:155], v[162:163], v[202:203] op_sel_hi:[1,0,1]
  v_pk_fma_f32 v[92:93], v[92:93], v[124:125], v[204:205] op_sel_hi:[1,0,1]
  v_pk_fma_f32 v[94:95], v[94:95], v[124:125], v[206:207] op_sel_hi:[1,0,1]
  v_pk_fma_f32 v[96:97], v[96:97], v[126:127], v[208:209] op_sel_hi:[1,0,1]
  v_pk_fma_f32 v[98:99], v[98:99], v[126:127], v[210:211] op_sel_hi:[1,0,1]
  v_pk_mul_f32 v[204:205], v[92:93], v[92:93]
  v_pk_mul_f32 v[206:207], v[94:95], v[94:95]
  v_pk_mul_f32 v[208:209], v[96:97], v[96:97]
  v_pk_mul_f32 v[210:211], v[98:99], v[98:99]
  v_pk_fma_f32 v[204:205], v[204:205], v[4:5], v[6:7] op_sel_hi:[1,0,0]
  v_pk_fma_f32 v[206:207], v[206:207], v[4:5], v[6:7] op_sel_hi:[1,0,0]
  v_pk_fma_f32 v[208:209], v[208:209], v[4:5], v[6:7] op_sel_hi:[1,0,0]
  v_pk_fma_f32 v[210:211], v[210:211], v[4:5], v[6:7] op_sel_hi:[1,0,0]
  v_pk_mul_f32 v[204:205], v[204:205], v[92:93]
  v_pk_mul_f32 v[206:207], v[206:207], v[94:95]
  v_pk_mul_f32 v[208:209], v[208:209], v[96:97]
  v_pk_mul_f32 v[210:211], v[210:211], v[98:99]
  v_exp_f32 v204, v204
  v_exp_f32 v205, v205
  v_exp_f32 v206, v206
  v_exp_f32 v207, v207
  v_exp_f32 v208, v208
  v_exp_f32 v209, v209
  v_exp_f32 v210, v210
  v_exp_f32 v211, v211
  v_pk_add_f32 v[204:205], v[204:205], 1.0 op_sel_hi:[1,0]
  v_pk_add_f32 v[206:207], v[206:207], 1.0 op_sel_hi:[1,0]
  v_pk_add_f32 v[208:209], v[208:209], 1.0 op_sel_hi:[1,0]
  v_pk_add_f32 v[210:211], v[210:211], 1.0 op_sel_hi:[1,0]
  v_rcp_f32 v204, v204
  v_rcp_f32 v205, v205
  v_rcp_f32 v206, v206
  v_rcp_f32 v207, v207
  v_rcp_f32 v208, v208
  v_rcp_f32 v209, v209
  v_rcp_f32 v210, v210
  v_rcp_f32 v211, v211
  v_pk_mul_f32 v[204:205], v[204:205], v[92:93]
  v_pk_mul_f32 v[206:207], v[206:207], v[94:95]
  v_pk_mul_f32 v[208:209], v[208:209], v[96:97]
  v_pk_mul_f32 v[210:211], v[210:211], v[98:99]
  v_cvt_pk_bf16_f32 v170, v204, v205
  v_cvt_pk_bf16_f32 v171, v206, v207
  v_cvt_pk_bf16_f32 v174, v208, v209
  v_cvt_pk_bf16_f32 v175, v210, v211
  buffer_store_dwordx4 v[168:171], v1, s[8:11], s3 offen offset:0 sc1
  ds_write_b128 v3, v[168:171] offset:16384
  buffer_store_dwordx4 v[172:175], v1, s[8:11], s3 offen offset:1024 sc1
  ds_write_b128 v3, v[172:175] offset:17408
  v_pk_fma_f32 v[204:205], v[152:153], v[164:165], v[200:201] op_sel_hi:[1,0,1]
  v_pk_fma_f32 v[206:207], v[154:155], v[164:165], v[202:203] op_sel_hi:[1,0,1]
  v_pk_fma_f32 v[208:209], v[152:153], v[166:167], v[200:201] op_sel_hi:[1,0,1]
  v_pk_fma_f32 v[210:211], v[154:155], v[166:167], v[202:203] op_sel_hi:[1,0,1]
  v_pk_fma_f32 v[100:101], v[100:101], v[128:129], v[204:205] op_sel_hi:[1,0,1]
  v_pk_fma_f32 v[102:103], v[102:103], v[128:129], v[206:207] op_sel_hi:[1,0,1]
  v_pk_fma_f32 v[104:105], v[104:105], v[130:131], v[208:209] op_sel_hi:[1,0,1]
  v_pk_fma_f32 v[106:107], v[106:107], v[130:131], v[210:211] op_sel_hi:[1,0,1]
  v_pk_mul_f32 v[204:205], v[100:101], v[100:101]
  v_pk_mul_f32 v[206:207], v[102:103], v[102:103]
  v_pk_mul_f32 v[208:209], v[104:105], v[104:105]
  v_pk_mul_f32 v[210:211], v[106:107], v[106:107]
  v_pk_fma_f32 v[204:205], v[204:205], v[4:5], v[6:7] op_sel_hi:[1,0,0]
  v_pk_fma_f32 v[206:207], v[206:207], v[4:5], v[6:7] op_sel_hi:[1,0,0]
  v_pk_fma_f32 v[208:209], v[208:209], v[4:5], v[6:7] op_sel_hi:[1,0,0]
  v_pk_fma_f32 v[210:211], v[210:211], v[4:5], v[6:7] op_sel_hi:[1,0,0]
  v_pk_mul_f32 v[204:205], v[204:205], v[100:101]
  v_pk_mul_f32 v[206:207], v[206:207], v[102:103]
  v_pk_mul_f32 v[208:209], v[208:209], v[104:105]
  v_pk_mul_f32 v[210:211], v[210:211], v[106:107]
  v_exp_f32 v204, v204
  v_exp_f32 v205, v205
  v_exp_f32 v206, v206
  v_exp_f32 v207, v207
  v_exp_f32 v208, v208
  v_exp_f32 v209, v209
  v_exp_f32 v210, v210
  v_exp_f32 v211, v211
  v_pk_add_f32 v[204:205], v[204:205], 1.0 op_sel_hi:[1,0]
  v_pk_add_f32 v[206:207], v[206:207], 1.0 op_sel_hi:[1,0]
  v_pk_add_f32 v[208:209], v[208:209], 1.0 op_sel_hi:[1,0]
  v_pk_add_f32 v[210:211], v[210:211], 1.0 op_sel_hi:[1,0]
  v_rcp_f32 v204, v204
  v_rcp_f32 v205, v205
  v_rcp_f32 v206, v206
  v_rcp_f32 v207, v207
  v_rcp_f32 v208, v208
  v_rcp_f32 v209, v209
  v_rcp_f32 v210, v210
  v_rcp_f32 v211, v211
  v_pk_mul_f32 v[204:205], v[204:205], v[100:101]
  v_pk_mul_f32 v[206:207], v[206:207], v[102:103]
  v_pk_mul_f32 v[208:209], v[208:209], v[104:105]
  v_pk_mul_f32 v[210:211], v[210:211], v[106:107]
  v_cvt_pk_bf16_f32 v178, v204, v205
  v_cvt_pk_bf16_f32 v179, v206, v207
  v_cvt_pk_bf16_f32 v182, v208, v209
  v_cvt_pk_bf16_f32 v183, v210, v211
  buffer_store_dwordx4 v[176:179], v1, s[8:11], s3 offen offset:2048 sc1
  ds_write_b128 v3, v[176:179] offset:18432
  buffer_store_dwordx4 v[180:183], v1, s[8:11], s3 offen offset:3072 sc1
  ds_write_b128 v3, v[180:183] offset:19456
  s_waitcnt lgkmcnt(0)
  v_lshrrev_b32 v3, 4, v0
  v_bfe_u32 v4, v0, 2, 2
  v_and_b32 v5, 1, v3
  v_lshl_add_u32 v5, v5, 2, v4
  v_lshrrev_b32 v6, 1, v3
  v_lshlrev_b32 v6, 10, v6
  v_lshl_add_u32 v6, v5, 7, v6
  v_bfe_u32 v7, v0, 1, 1
  v_lshl_add_u32 v6, v7, 4, v6
  v_and_b32 v7, 1, v0
  v_lshl_add_u32 v6, v7, 3, v6
  v_add_u32 v6, 81920, v6
  v_and_b32 v5, 6, v5
  s_lshl_b32 s63, s53, 2
  s_add_u32 s63, s63, 0
  s_mov_b32 s4, s63
  s_lshr_b32 s5, s4, 2
  s_lshl_b32 s5, s5, 11
  s_and_b32 s6, s4, 3
  s_lshl_b32 s6, s6, 1
  v_xor_b32 v7, s6, v5
  v_lshl_add_u32 v146, v7, 4, v6
  v_add_u32 v146, s5, v146
  v_add_u32 v150, 65536, v146
  s_lshl_b32 s63, s53, 2
  s_add_u32 s63, s63, 1
  s_mov_b32 s4, s63
  s_lshr_b32 s5, s4, 2
  s_lshl_b32 s5, s5, 11
  s_and_b32 s6, s4, 3
  s_lshl_b32 s6, s6, 1
  v_xor_b32 v7, s6, v5
  v_lshl_add_u32 v147, v7, 4, v6
  v_add_u32 v147, s5, v147
  v_add_u32 v151, 65536, v147
  s_lshl_b32 s63, s53, 2
  s_add_u32 s63, s63, 2
  s_mov_b32 s4, s63
  s_lshr_b32 s5, s4, 2
  s_lshl_b32 s5, s5, 11
  s_and_b32 s6, s4, 3
  s_lshl_b32 s6, s6, 1
  v_xor_b32 v7, s6, v5
  v_lshl_add_u32 v148, v7, 4, v6
  v_add_u32 v148, s5, v148
  v_add_u32 v152, 65536, v148
  s_lshl_b32 s63, s53, 2
  s_add_u32 s63, s63, 3
  s_mov_b32 s4, s63
  s_lshr_b32 s5, s4, 2
  s_lshl_b32 s5, s5, 11
  s_and_b32 s6, s4, 3
  s_lshl_b32 s6, s6, 1
  v_xor_b32 v7, s6, v5
  v_lshl_add_u32 v149, v7, 4, v6
  v_add_u32 v149, s5, v149
  v_add_u32 v153, 65536, v149
  s_lshl_b32 s63, s52, 2
  s_lshl_b32 s4, s61, 1
  s_add_u32 s63, s63, s4
  s_lshl_b32 s3, s63, 10
  s_add_u32 s3, s3, 0
  v_add_u32_e64 v144, s3, v1
  v_xor_b32 v145, 2048, v144
  v_add_u32 v154, 65536, v144
  v_add_u32 v155, 65536, v145
  s_lshl_b32 s3, s48, 14
  s_mul_i32 s4, s49, 0
  s_add_u32 s3, s3, s4
  s_add_u32 s3, s3, 67109376
  v_lshl_add_u32 v3, v0, 10, s3
  v_xor_b32 v2, s49, v0
  v_and_b32 v2, 4, v2
  v_add_u32 v3, v3, v2
  s_and_b32 s4, s49, 8
  s_lshl_b32 s4, 0xff, s4
  s_mov_b32 s5, 0
  v_mov_b32 v2, 1
  s_cmp_eq_u32 s50, 0
  s_cselect_b64 s[64:65], s[4:5], 0
  s_waitcnt vmcnt(0)
  s_barrier
  s_mov_b64 exec, s[64:65]
  s_cbranch_execz Lsf_2013
  buffer_atomic_add v2, v3, s[8:11], 0 offen sc1
Lsf_2013:
  s_mov_b64 exec, -1
  v_lshrrev_b32 v3, 4, v0
  v_lshlrev_b32 v3, 3, v3
  buffer_load_dwordx2 v[200:201], v3, s[36:39], s66 offen offset:0
  buffer_load_dwordx2 v[202:203], v3, s[36:39], s66 offen offset:32
  buffer_load_dwordx2 v[204:205], v3, s[36:39], s66 offen offset:64
  buffer_load_dwordx2 v[206:207], v3, s[36:39], s66 offen offset:96
  s_lshl_b32 s3, s48, 4
  s_add_u32 s5, s3, s49
  s_xor_b32 s3, s5, 8
  s_lshl_b32 s6, s3, 10
  s_lshl_b32 s7, s51, 2
  s_add_u32 s6, s6, s7
  s_add_u32 s6, s6, 67109504
  s_lshl_b32 s62, s5, 10
  s_add_u32 s62, s62, s7
  s_add_u32 s62, s62, 67109504
  s_lshl_b32 s3, s3, 2
  s_add_u32 s3, s3, s51
  s_lshl_b32 s3, s3, 13
  s_add_u32 s3, s3, 50331648
  s_add_u32 s4, s3, 4096
  s_lshl_b32 s5, s5, 2
  s_add_u32 s5, s5, s51
  s_lshl_b32 s5, s5, 13
  s_add_u32 s5, s5, 50331648
  s_add_u32 s7, s5, 4096
  s_mov_b32 s54, 0
  s_nop 0
  ds_read_b128 v[80:83], v144 offset:0
  ds_read_b64_tr_b16 v[96:97], v146 offset:0
  ds_read_b64_tr_b16 v[98:99], v146 offset:4096
  ds_read_b128 v[84:87], v144 offset:1024
  ds_read_b128 v[88:91], v145 offset:0
  ds_read_b128 v[92:95], v145 offset:1024
  ds_read_b64_tr_b16 v[100:101], v147 offset:0
  ds_read_b64_tr_b16 v[102:103], v147 offset:4096
  ds_read_b64_tr_b16 v[104:105], v148 offset:0
  ds_read_b64_tr_b16 v[106:107], v148 offset:4096
  ds_read_b64_tr_b16 v[108:109], v149 offset:0
  ds_read_b64_tr_b16 v[110:111], v149 offset:4096
  s_waitcnt lgkmcnt(0)
  v_mfma_f32_16x16x32_bf16 v[16:19], v[96:99], v[80:83], 0
  ds_read_b128 v[112:115], v144 offset:8192
  v_mfma_f32_16x16x32_bf16 v[20:23], v[96:99], v[84:87], 0
  s_nop 0
  ds_read_b64_tr_b16 v[128:129], v146 offset:8192
  v_mfma_f32_16x16x32_bf16 v[24:27], v[96:99], v[88:91], 0
  ds_read_b64_tr_b16 v[130:131], v146 offset:12288
  v_mfma_f32_16x16x32_bf16 v[28:31], v[96:99], v[92:95], 0
  ds_read_b128 v[116:119], v144 offset:9216
  v_mfma_f32_16x16x32_bf16 v[44:47], v[100:103], v[92:95], 0
  ds_read_b128 v[120:123], v145 offset:8192
  v_mfma_f32_16x16x32_bf16 v[40:43], v[100:103], v[88:91], 0
  ds_read_b128 v[124:127], v145 offset:9216
  v_mfma_f32_16x16x32_bf16 v[36:39], v[100:103], v[84:87], 0
  ds_read_b64_tr_b16 v[132:133], v147 offset:8192
  v_mfma_f32_16x16x32_bf16 v[32:35], v[100:103], v[80:83], 0
  ds_read_b64_tr_b16 v[134:135], v147 offset:12288
  v_mfma_f32_16x16x32_bf16 v[48:51], v[104:107], v[80:83], 0
  ds_read_b64_tr_b16 v[136:137], v148 offset:8192
  v_mfma_f32_16x16x32_bf16 v[52:55], v[104:107], v[84:87], 0
  ds_read_b64_tr_b16 v[138:139], v148 offset:12288
  v_mfma_f32_16x16x32_bf16 v[56:59], v[104:107], v[88:91], 0
  ds_read_b64_tr_b16 v[140:141], v149 offset:8192
  v_mfma_f32_16x16x32_bf16 v[60:63], v[104:107], v[92:95], 0
  ds_read_b64_tr_b16 v[142:143], v149 offset:12288
  v_mfma_f32_16x16x32_bf16 v[76:79], v[108:111], v[92:95], 0
  v_mfma_f32_16x16x32_bf16 v[72:75], v[108:111], v[88:91], 0
  v_mfma_f32_16x16x32_bf16 v[68:71], v[108:111], v[84:87], 0
  v_mfma_f32_16x16x32_bf16 v[64:67], v[108:111], v[80:83], 0
  s_waitcnt lgkmcnt(0)
  v_mfma_f32_16x16x32_bf16 v[16:19], v[128:131], v[112:115], v[16:19]
  ds_read_b128 v[80:83], v144 offset:16384
  v_mfma_f32_16x16x32_bf16 v[20:23], v[128:131], v[116:119], v[20:23]
  ds_read_b64_tr_b16 v[96:97], v146 offset:16384
  v_mfma_f32_16x16x32_bf16 v[24:27], v[128:131], v[120:123], v[24:27]
  ds_read_b64_tr_b16 v[98:99], v146 offset:20480
  s_nop 0
  v_mfma_f32_16x16x32_bf16 v[28:31], v[128:131], v[124:127], v[28:31]
  ds_read_b128 v[84:87], v144 offset:17408
  v_mfma_f32_16x16x32_bf16 v[44:47], v[132:135], v[124:127], v[44:47]
  ds_read_b128 v[88:91], v145 offset:16384
  v_mfma_f32_16x16x32_bf16 v[40:43], v[132:135], v[120:123], v[40:43]
  ds_read_b128 v[92:95], v145 offset:17408
  v_mfma_f32_16x16x32_bf16 v[36:39], v[132:135], v[116:119], v[36:39]
  ds_read_b64_tr_b16 v[100:101], v147 offset:16384
  v_mfma_f32_16x16x32_bf16 v[32:35], v[132:135], v[112:115], v[32:35]
  ds_read_b64_tr_b16 v[102:103], v147 offset:20480
  v_mfma_f32_16x16x32_bf16 v[48:51], v[136:139], v[112:115], v[48:51]
  ds_read_b64_tr_b16 v[104:105], v148 offset:16384
  v_mfma_f32_16x16x32_bf16 v[52:55], v[136:139], v[116:119], v[52:55]
  ds_read_b64_tr_b16 v[106:107], v148 offset:20480
  v_mfma_f32_16x16x32_bf16 v[56:59], v[136:139], v[120:123], v[56:59]
  ds_read_b64_tr_b16 v[108:109], v149 offset:16384
  v_mfma_f32_16x16x32_bf16 v[60:63], v[136:139], v[124:127], v[60:63]
  ds_read_b64_tr_b16 v[110:111], v149 offset:20480
  v_mfma_f32_16x16x32_bf16 v[76:79], v[140:143], v[124:127], v[76:79]
  v_mfma_f32_16x16x32_bf16 v[72:75], v[140:143], v[120:123], v[72:75]
  v_mfma_f32_16x16x32_bf16 v[68:71], v[140:143], v[116:119], v[68:71]
  v_mfma_f32_16x16x32_bf16 v[64:67], v[140:143], v[112:115], v[64:67]
  s_waitcnt lgkmcnt(0)
  v_mfma_f32_16x16x32_bf16 v[16:19], v[96:99], v[80:83], v[16:19]
  s_nop 0
  ds_read_b128 v[112:115], v144 offset:24576
  v_mfma_f32_16x16x32_bf16 v[20:23], v[96:99], v[84:87], v[20:23]
  ds_read_b64_tr_b16 v[128:129], v146 offset:24576
  v_mfma_f32_16x16x32_bf16 v[24:27], v[96:99], v[88:91], v[24:27]
  ds_read_b64_tr_b16 v[130:131], v146 offset:28672
  v_mfma_f32_16x16x32_bf16 v[28:31], v[96:99], v[92:95], v[28:31]
  ds_read_b128 v[116:119], v144 offset:25600
  v_mfma_f32_16x16x32_bf16 v[44:47], v[100:103], v[92:95], v[44:47]
  ds_read_b128 v[120:123], v145 offset:24576
  v_mfma_f32_16x16x32_bf16 v[40:43], v[100:103], v[88:91], v[40:43]
  ds_read_b128 v[124:127], v145 offset:25600
  v_mfma_f32_16x16x32_bf16 v[36:39], v[100:103], v[84:87], v[36:39]
  ds_read_b64_tr_b16 v[132:133], v147 offset:24576
  v_mfma_f32_16x16x32_bf16 v[32:35], v[100:103], v[80:83], v[32:35]
  ds_read_b64_tr_b16 v[134:135], v147 offset:28672
  v_mfma_f32_16x16x32_bf16 v[48:51], v[104:107], v[80:83], v[48:51]
  ds_read_b64_tr_b16 v[136:137], v148 offset:24576
  v_mfma_f32_16x16x32_bf16 v[52:55], v[104:107], v[84:87], v[52:55]
  ds_read_b64_tr_b16 v[138:139], v148 offset:28672
  v_mfma_f32_16x16x32_bf16 v[56:59], v[104:107], v[88:91], v[56:59]
  ds_read_b64_tr_b16 v[140:141], v149 offset:24576
  v_mfma_f32_16x16x32_bf16 v[60:63], v[104:107], v[92:95], v[60:63]
  ds_read_b64_tr_b16 v[142:143], v149 offset:28672
  v_mfma_f32_16x16x32_bf16 v[76:79], v[108:111], v[92:95], v[76:79]
  v_mfma_f32_16x16x32_bf16 v[72:75], v[108:111], v[88:91], v[72:75]
  v_mfma_f32_16x16x32_bf16 v[68:71], v[108:111], v[84:87], v[68:71]
  v_mfma_f32_16x16x32_bf16 v[64:67], v[108:111], v[80:83], v[64:67]
  s_waitcnt lgkmcnt(0)
  v_mfma_f32_16x16x32_bf16 v[16:19], v[128:131], v[112:115], v[16:19]
  ds_read_b128 v[80:83], v144 offset:32768
  v_mfma_f32_16x16x32_bf16 v[20:23], v[128:131], v[116:119], v[20:23]
  ds_read_b64_tr_b16 v[96:97], v146 offset:32768
  s_nop 0
  v_mfma_f32_16x16x32_bf16 v[24:27], v[128:131], v[120:123], v[24:27]
  ds_read_b64_tr_b16 v[98:99], v146 offset:36864
  v_mfma_f32_16x16x32_bf16 v[28:31], v[128:131], v[124:127], v[28:31]
  ds_read_b128 v[84:87], v144 offset:33792
  v_mfma_f32_16x16x32_bf16 v[44:47], v[132:135], v[124:127], v[44:47]
  ds_read_b128 v[88:91], v145 offset:32768
  v_mfma_f32_16x16x32_bf16 v[40:43], v[132:135], v[120:123], v[40:43]
  ds_read_b128 v[92:95], v145 offset:33792
  v_mfma_f32_16x16x32_bf16 v[36:39], v[132:135], v[116:119], v[36:39]
  ds_read_b64_tr_b16 v[100:101], v147 offset:32768
  v_mfma_f32_16x16x32_bf16 v[32:35], v[132:135], v[112:115], v[32:35]
  ds_read_b64_tr_b16 v[102:103], v147 offset:36864
  v_mfma_f32_16x16x32_bf16 v[48:51], v[136:139], v[112:115], v[48:51]
  ds_read_b64_tr_b16 v[104:105], v148 offset:32768
  v_mfma_f32_16x16x32_bf16 v[52:55], v[136:139], v[116:119], v[52:55]
  ds_read_b64_tr_b16 v[106:107], v148 offset:36864
  v_mfma_f32_16x16x32_bf16 v[56:59], v[136:139], v[120:123], v[56:59]
  ds_read_b64_tr_b16 v[108:109], v149 offset:32768
  v_mfma_f32_16x16x32_bf16 v[60:63], v[136:139], v[124:127], v[60:63]
  ds_read_b64_tr_b16 v[110:111], v149 offset:36864
  v_mfma_f32_16x16x32_bf16 v[76:79], v[140:143], v[124:127], v[76:79]
  v_mfma_f32_16x16x32_bf16 v[72:75], v[140:143], v[120:123], v[72:75]
  v_mfma_f32_16x16x32_bf16 v[68:71], v[140:143], v[116:119], v[68:71]
  v_mfma_f32_16x16x32_bf16 v[64:67], v[140:143], v[112:115], v[64:67]
  s_waitcnt lgkmcnt(0)
  v_mfma_f32_16x16x32_bf16 v[16:19], v[96:99], v[80:83], v[16:19]
  ds_read_b128 v[112:115], v144 offset:40960
  v_mfma_f32_16x16x32_bf16 v[20:23], v[96:99], v[84:87], v[20:23]
  ds_read_b64_tr_b16 v[128:129], v146 offset:40960
  v_mfma_f32_16x16x32_bf16 v[24:27], v[96:99], v[88:91], v[24:27]
  ds_read_b64_tr_b16 v[130:131], v146 offset:45056
  v_mfma_f32_16x16x32_bf16 v[28:31], v[96:99], v[92:95], v[28:31]
  s_nop 0
  ds_read_b128 v[116:119], v144 offset:41984
  v_mfma_f32_16x16x32_bf16 v[44:47], v[100:103], v[92:95], v[44:47]
  ds_read_b128 v[120:123], v145 offset:40960
  v_mfma_f32_16x16x32_bf16 v[40:43], v[100:103], v[88:91], v[40:43]
  ds_read_b128 v[124:127], v145 offset:41984
  v_mfma_f32_16x16x32_bf16 v[36:39], v[100:103], v[84:87], v[36:39]
  ds_read_b64_tr_b16 v[132:133], v147 offset:40960
  v_mfma_f32_16x16x32_bf16 v[32:35], v[100:103], v[80:83], v[32:35]
  ds_read_b64_tr_b16 v[134:135], v147 offset:45056
  v_mfma_f32_16x16x32_bf16 v[48:51], v[104:107], v[80:83], v[48:51]
  ds_read_b64_tr_b16 v[136:137], v148 offset:40960
  v_mfma_f32_16x16x32_bf16 v[52:55], v[104:107], v[84:87], v[52:55]
  ds_read_b64_tr_b16 v[138:139], v148 offset:45056
  v_mfma_f32_16x16x32_bf16 v[56:59], v[104:107], v[88:91], v[56:59]
  ds_read_b64_tr_b16 v[140:141], v149 offset:40960
  v_mfma_f32_16x16x32_bf16 v[60:63], v[104:107], v[92:95], v[60:63]
  ds_read_b64_tr_b16 v[142:143], v149 offset:45056
  v_mfma_f32_16x16x32_bf16 v[76:79], v[108:111], v[92:95], v[76:79]
  v_mfma_f32_16x16x32_bf16 v[72:75], v[108:111], v[88:91], v[72:75]
  v_mfma_f32_16x16x32_bf16 v[68:71], v[108:111], v[84:87], v[68:71]
  v_mfma_f32_16x16x32_bf16 v[64:67], v[108:111], v[80:83], v[64:67]
  s_waitcnt lgkmcnt(0)
.p2align 6
Lc_2014:
  s_barrier
  v_mfma_f32_16x16x32_bf16 v[16:19], v[128:131], v[112:115], v[16:19]
  ds_read_b128 v[80:83], v144 offset:49152
  v_mfma_f32_16x16x32_bf16 v[20:23], v[128:131], v[116:119], v[20:23]
  ds_read_b64_tr_b16 v[96:97], v146 offset:49152
  v_mfma_f32_16x16x32_bf16 v[24:27], v[128:131], v[120:123], v[24:27]
  ds_read_b64_tr_b16 v[98:99], v146 offset:53248
  v_mfma_f32_16x16x32_bf16 v[28:31], v[128:131], v[124:127], v[28:31]
  s_nop 0
  ds_read_b128 v[84:87], v144 offset:50176
  v_mfma_f32_16x16x32_bf16 v[44:47], v[132:135], v[124:127], v[44:47]
  ds_read_b128 v[88:91], v145 offset:49152
  v_mfma_f32_16x16x32_bf16 v[40:43], v[132:135], v[120:123], v[40:43]
  ds_read_b128 v[92:95], v145 offset:50176
  v_mfma_f32_16x16x32_bf16 v[36:39], v[132:135], v[116:119], v[36:39]
  ds_read_b64_tr_b16 v[100:101], v147 offset:49152
  v_mfma_f32_16x16x32_bf16 v[32:35], v[132:135], v[112:115], v[32:35]
  ds_read_b64_tr_b16 v[102:103], v147 offset:53248
  v_mfma_f32_16x16x32_bf16 v[48:51], v[136:139], v[112:115], v[48:51]
  ds_read_b64_tr_b16 v[104:105], v148 offset:49152
  v_mfma_f32_16x16x32_bf16 v[52:55], v[136:139], v[116:119], v[52:55]
  ds_read_b64_tr_b16 v[106:107], v148 offset:53248
  v_mfma_f32_16x16x32_bf16 v[56:59], v[136:139], v[120:123], v[56:59]
  ds_read_b64_tr_b16 v[108:109], v149 offset:49152
  v_mfma_f32_16x16x32_bf16 v[60:63], v[136:139], v[124:127], v[60:63]
  ds_read_b64_tr_b16 v[110:111], v149 offset:53248
  v_mfma_f32_16x16x32_bf16 v[76:79], v[140:143], v[124:127], v[76:79]
  v_mfma_f32_16x16x32_bf16 v[72:75], v[140:143], v[120:123], v[72:75]
  v_mfma_f32_16x16x32_bf16 v[68:71], v[140:143], v[116:119], v[68:71]
  v_mfma_f32_16x16x32_bf16 v[64:67], v[140:143], v[112:115], v[64:67]
  s_waitcnt lgkmcnt(0)
  v_mfma_f32_16x16x32_bf16 v[16:19], v[96:99], v[80:83], v[16:19]
  ds_read_b128 v[112:115], v144 offset:57344
  s_nop 0
  v_mfma_f32_16x16x32_bf16 v[20:23], v[96:99], v[84:87], v[20:23]
  ds_read_b64_tr_b16 v[128:129], v146 offset:57344
  v_mfma_f32_16x16x32_bf16 v[24:27], v[96:99], v[88:91], v[24:27]
  ds_read_b64_tr_b16 v[130:131], v146 offset:61440
  v_mfma_f32_16x16x32_bf16 v[28:31], v[96:99], v[92:95], v[28:31]
  ds_read_b128 v[116:119], v144 offset:58368
  v_mfma_f32_16x16x32_bf16 v[44:47], v[100:103], v[92:95], v[44:47]
  ds_read_b128 v[120:123], v145 offset:57344
  v_mfma_f32_16x16x32_bf16 v[40:43], v[100:103], v[88:91], v[40:43]
  ds_read_b128 v[124:127], v145 offset:58368
  v_mfma_f32_16x16x32_bf16 v[36:39], v[100:103], v[84:87], v[36:39]
  ds_read_b64_tr_b16 v[132:133], v147 offset:57344
  v_mfma_f32_16x16x32_bf16 v[32:35], v[100:103], v[80:83], v[32:35]
  ds_read_b64_tr_b16 v[134:135], v147 offset:61440
  v_mfma_f32_16x16x32_bf16 v[48:51], v[104:107], v[80:83], v[48:51]
  ds_read_b64_tr_b16 v[136:137], v148 offset:57344
  v_mfma_f32_16x16x32_bf16 v[52:55], v[104:107], v[84:87], v[52:55]
  ds_read_b64_tr_b16 v[138:139], v148 offset:61440
  v_mfma_f32_16x16x32_bf16 v[56:59], v[104:107], v[88:91], v[56:59]
  ds_read_b64_tr_b16 v[140:141], v149 offset:57344
  v_mfma_f32_16x16x32_bf16 v[60:63], v[104:107], v[92:95], v[60:63]
  ds_read_b64_tr_b16 v[142:143], v149 offset:61440
  v_mfma_f32_16x16x32_bf16 v[76:79], v[108:111], v[92:95], v[76:79]
  v_mfma_f32_16x16x32_bf16 v[72:75], v[108:111], v[88:91], v[72:75]
  v_mfma_f32_16x16x32_bf16 v[68:71], v[108:111], v[84:87], v[68:71]
  v_mfma_f32_16x16x32_bf16 v[64:67], v[108:111], v[80:83], v[64:67]
  s_waitcnt lgkmcnt(0)
  s_barrier
  v_mfma_f32_16x16x32_bf16 v[16:19], v[128:131], v[112:115], v[16:19]
  ds_read_b128 v[80:83], v154 offset:0
  v_mfma_f32_16x16x32_bf16 v[20:23], v[128:131], v[116:119], v[20:23]
  ds_read_b64_tr_b16 v[96:97], v150 offset:0
  v_mfma_f32_16x16x32_bf16 v[24:27], v[128:131], v[120:123], v[24:27]
  ds_read_b64_tr_b16 v[98:99], v150 offset:4096
  v_mfma_f32_16x16x32_bf16 v[28:31], v[128:131], v[124:127], v[28:31]
  ds_read_b128 v[84:87], v154 offset:1024
  v_mfma_f32_16x16x32_bf16 v[44:47], v[132:135], v[124:127], v[44:47]
  ds_read_b128 v[88:91], v155 offset:0
  v_mfma_f32_16x16x32_bf16 v[40:43], v[132:135], v[120:123], v[40:43]
  ds_read_b128 v[92:95], v155 offset:1024
  v_mfma_f32_16x16x32_bf16 v[36:39], v[132:135], v[116:119], v[36:39]
  ds_read_b64_tr_b16 v[100:101], v151 offset:0
  v_mfma_f32_16x16x32_bf16 v[32:35], v[132:135], v[112:115], v[32:35]
  ds_read_b64_tr_b16 v[102:103], v151 offset:4096
  v_mfma_f32_16x16x32_bf16 v[48:51], v[136:139], v[112:115], v[48:51]
  ds_read_b64_tr_b16 v[104:105], v152 offset:0
  v_mfma_f32_16x16x32_bf16 v[52:55], v[136:139], v[116:119], v[52:55]
  ds_read_b64_tr_b16 v[106:107], v152 offset:4096
  v_mfma_f32_16x16x32_bf16 v[56:59], v[136:139], v[120:123], v[56:59]
  ds_read_b64_tr_b16 v[108:109], v153 offset:0
  v_mfma_f32_16x16x32_bf16 v[60:63], v[136:139], v[124:127], v[60:63]
  ds_read_b64_tr_b16 v[110:111], v153 offset:4096
  v_mfma_f32_16x16x32_bf16 v[76:79], v[140:143], v[124:127], v[76:79]
  v_mfma_f32_16x16x32_bf16 v[72:75], v[140:143], v[120:123], v[72:75]
  v_mfma_f32_16x16x32_bf16 v[68:71], v[140:143], v[116:119], v[68:71]
  v_mfma_f32_16x16x32_bf16 v[64:67], v[140:143], v[112:115], v[64:67]
  s_waitcnt lgkmcnt(0)
  s_nop 0
  v_mfma_f32_16x16x32_bf16 v[16:19], v[96:99], v[80:83], v[16:19]
  ds_read_b128 v[112:115], v154 offset:8192
  v_mfma_f32_16x16x32_bf16 v[20:23], v[96:99], v[84:87], v[20:23]
  ds_read_b64_tr_b16 v[128:129], v150 offset:8192
  v_mfma_f32_16x16x32_bf16 v[24:27], v[96:99], v[88:91], v[24:27]
  ds_read_b64_tr_b16 v[130:131], v150 offset:12288
  v_mfma_f32_16x16x32_bf16 v[28:31], v[96:99], v[92:95], v[28:31]
  ds_read_b128 v[116:119], v154 offset:9216
  v_mfma_f32_16x16x32_bf16 v[44:47], v[100:103], v[92:95], v[44:47]
  ds_read_b128 v[120:123], v155 offset:8192
  v_mfma_f32_16x16x32_bf16 v[40:43], v[100:103], v[88:91], v[40:43]
  ds_read_b128 v[124:127], v155 offset:9216
  v_mfma_f32_16x16x32_bf16 v[36:39], v[100:103], v[84:87], v[36:39]
  ds_read_b64_tr_b16 v[132:133], v151 offset:8192
  v_mfma_f32_16x16x32_bf16 v[32:35], v[100:103], v[80:83], v[32:35]
  ds_read_b64_tr_b16 v[134:135], v151 offset:12288
  v_mfma_f32_16x16x32_bf16 v[48:51], v[104:107], v[80:83], v[48:51]
  ds_read_b64_tr_b16 v[136:137], v152 offset:8192
  v_mfma_f32_16x16x32_bf16 v[52:55], v[104:107], v[84:87], v[52:55]
  ds_read_b64_tr_b16 v[138:139], v152 offset:12288
  v_mfma_f32_16x16x32_bf16 v[56:59], v[104:107], v[88:91], v[56:59]
  ds_read_b64_tr_b16 v[140:141], v153 offset:8192
  v_mfma_f32_16x16x32_bf16 v[60:63], v[104:107], v[92:95], v[60:63]
  ds_read_b64_tr_b16 v[142:143], v153 offset:12288
  v_mfma_f32_16x16x32_bf16 v[76:79], v[108:111], v[92:95], v[76:79]
  v_mfma_f32_16x16x32_bf16 v[72:75], v[108:111], v[88:91], v[72:75]
  v_mfma_f32_16x16x32_bf16 v[68:71], v[108:111], v[84:87], v[68:71]
  v_mfma_f32_16x16x32_bf16 v[64:67], v[108:111], v[80:83], v[64:67]
  s_waitcnt lgkmcnt(0)
  s_barrier
  v_mfma_f32_16x16x32_bf16 v[16:19], v[128:131], v[112:115], v[16:19]
  ds_read_b128 v[80:83], v144 offset:0
  v_mfma_f32_16x16x32_bf16 v[20:23], v[128:131], v[116:119], v[20:23]
  ds_read_b64_tr_b16 v[96:97], v146 offset:0
  v_mfma_f32_16x16x32_bf16 v[24:27], v[128:131], v[120:123], v[24:27]
  ds_read_b64_tr_b16 v[98:99], v146 offset:4096
  v_mfma_f32_16x16x32_bf16 v[28:31], v[128:131], v[124:127], v[28:31]
  ds_read_b128 v[84:87], v144 offset:1024
  v_mfma_f32_16x16x32_bf16 v[44:47], v[132:135], v[124:127], v[44:47]
  ds_read_b128 v[88:91], v145 offset:0
  v_mfma_f32_16x16x32_bf16 v[40:43], v[132:135], v[120:123], v[40:43]
  ds_read_b128 v[92:95], v145 offset:1024
  v_mfma_f32_16x16x32_bf16 v[36:39], v[132:135], v[116:119], v[36:39]
  ds_read_b64_tr_b16 v[100:101], v147 offset:0
  v_mfma_f32_16x16x32_bf16 v[32:35], v[132:135], v[112:115], v[32:35]
  ds_read_b64_tr_b16 v[102:103], v147 offset:4096
  v_mfma_f32_16x16x32_bf16 v[48:51], v[136:139], v[112:115], v[48:51]
  ds_read_b64_tr_b16 v[104:105], v148 offset:0
  v_mfma_f32_16x16x32_bf16 v[52:55], v[136:139], v[116:119], v[52:55]
  ds_read_b64_tr_b16 v[106:107], v148 offset:4096
  v_mfma_f32_16x16x32_bf16 v[56:59], v[136:139], v[120:123], v[56:59]
  ds_read_b64_tr_b16 v[108:109], v149 offset:0
  v_mfma_f32_16x16x32_bf16 v[60:63], v[136:139], v[124:127], v[60:63]
  ds_read_b64_tr_b16 v[110:111], v149 offset:4096
  v_mfma_f32_16x16x32_bf16 v[76:79], v[140:143], v[124:127], v[76:79]
  v_mfma_f32_16x16x32_bf16 v[72:75], v[140:143], v[120:123], v[72:75]
  v_mfma_f32_16x16x32_bf16 v[68:71], v[140:143], v[116:119], v[68:71]
  v_mfma_f32_16x16x32_bf16 v[64:67], v[140:143], v[112:115], v[64:67]
  s_waitcnt lgkmcnt(0)
  v_mfma_f32_16x16x32_bf16 v[16:19], v[96:99], v[80:83], v[16:19]
  ds_read_b128 v[112:115], v144 offset:8192
  v_mfma_f32_16x16x32_bf16 v[20:23], v[96:99], v[84:87], v[20:23]
  ds_read_b64_tr_b16 v[128:129], v146 offset:8192
  v_mfma_f32_16x16x32_bf16 v[24:27], v[96:99], v[88:91], v[24:27]
  ds_read_b64_tr_b16 v[130:131], v146 offset:12288
  s_nop 0
  v_mfma_f32_16x16x32_bf16 v[28:31], v[96:99], v[92:95], v[28:31]
  ds_read_b128 v[116:119], v144 offset:9216
  v_mfma_f32_16x16x32_bf16 v[44:47], v[100:103], v[92:95], v[44:47]
  ds_read_b128 v[120:123], v145 offset:8192
  v_mfma_f32_16x16x32_bf16 v[40:43], v[100:103], v[88:91], v[40:43]
  ds_read_b128 v[124:127], v145 offset:9216
  v_mfma_f32_16x16x32_bf16 v[36:39], v[100:103], v[84:87], v[36:39]
  ds_read_b64_tr_b16 v[132:133], v147 offset:8192
  v_mfma_f32_16x16x32_bf16 v[32:35], v[100:103], v[80:83], v[32:35]
  ds_read_b64_tr_b16 v[134:135], v147 offset:12288
  v_mfma_f32_16x16x32_bf16 v[48:51], v[104:107], v[80:83], v[48:51]
  ds_read_b64_tr_b16 v[136:137], v148 offset:8192
  v_mfma_f32_16x16x32_bf16 v[52:55], v[104:107], v[84:87], v[52:55]
  ds_read_b64_tr_b16 v[138:139], v148 offset:12288
  v_mfma_f32_16x16x32_bf16 v[56:59], v[104:107], v[88:91], v[56:59]
  ds_read_b64_tr_b16 v[140:141], v149 offset:8192
  v_mfma_f32_16x16x32_bf16 v[60:63], v[104:107], v[92:95], v[60:63]
  ds_read_b64_tr_b16 v[142:143], v149 offset:12288
  v_mfma_f32_16x16x32_bf16 v[76:79], v[108:111], v[92:95], v[76:79]
  v_mfma_f32_16x16x32_bf16 v[72:75], v[108:111], v[88:91], v[72:75]
  v_mfma_f32_16x16x32_bf16 v[68:71], v[108:111], v[84:87], v[68:71]
  v_mfma_f32_16x16x32_bf16 v[64:67], v[108:111], v[80:83], v[64:67]
  s_waitcnt lgkmcnt(0)
  s_barrier
  v_mfma_f32_16x16x32_bf16 v[16:19], v[128:131], v[112:115], v[16:19]
  ds_read_b128 v[80:83], v144 offset:16384
  v_mfma_f32_16x16x32_bf16 v[20:23], v[128:131], v[116:119], v[20:23]
  ds_read_b64_tr_b16 v[96:97], v146 offset:16384
  v_mfma_f32_16x16x32_bf16 v[24:27], v[128:131], v[120:123], v[24:27]
  ds_read_b64_tr_b16 v[98:99], v146 offset:20480
  v_mfma_f32_16x16x32_bf16 v[28:31], v[128:131], v[124:127], v[28:31]
  ds_read_b128 v[84:87], v144 offset:17408
  v_mfma_f32_16x16x32_bf16 v[44:47], v[132:135], v[124:127], v[44:47]
  ds_read_b128 v[88:91], v145 offset:16384
  v_mfma_f32_16x16x32_bf16 v[40:43], v[132:135], v[120:123], v[40:43]
  ds_read_b128 v[92:95], v145 offset:17408
  v_mfma_f32_16x16x32_bf16 v[36:39], v[132:135], v[116:119], v[36:39]
  ds_read_b64_tr_b16 v[100:101], v147 offset:16384
  v_mfma_f32_16x16x32_bf16 v[32:35], v[132:135], v[112:115], v[32:35]
  ds_read_b64_tr_b16 v[102:103], v147 offset:20480
  v_mfma_f32_16x16x32_bf16 v[48:51], v[136:139], v[112:115], v[48:51]
  ds_read_b64_tr_b16 v[104:105], v148 offset:16384
  v_mfma_f32_16x16x32_bf16 v[52:55], v[136:139], v[116:119], v[52:55]
  ds_read_b64_tr_b16 v[106:107], v148 offset:20480
  v_mfma_f32_16x16x32_bf16 v[56:59], v[136:139], v[120:123], v[56:59]
  ds_read_b64_tr_b16 v[108:109], v149 offset:16384
  v_mfma_f32_16x16x32_bf16 v[60:63], v[136:139], v[124:127], v[60:63]
  ds_read_b64_tr_b16 v[110:111], v149 offset:20480
  v_mfma_f32_16x16x32_bf16 v[76:79], v[140:143], v[124:127], v[76:79]
  v_mfma_f32_16x16x32_bf16 v[72:75], v[140:143], v[120:123], v[72:75]
  v_mfma_f32_16x16x32_bf16 v[68:71], v[140:143], v[116:119], v[68:71]
  v_mfma_f32_16x16x32_bf16 v[64:67], v[140:143], v[112:115], v[64:67]
  s_waitcnt lgkmcnt(0)
  v_mfma_f32_16x16x32_bf16 v[16:19], v[96:99], v[80:83], v[16:19]
  ds_read_b128 v[112:115], v144 offset:24576
  v_mfma_f32_16x16x32_bf16 v[20:23], v[96:99], v[84:87], v[20:23]
  ds_read_b64_tr_b16 v[128:129], v146 offset:24576
  s_nop 0
  v_mfma_f32_16x16x32_bf16 v[24:27], v[96:99], v[88:91], v[24:27]
  ds_read_b64_tr_b16 v[130:131], v146 offset:28672
  v_mfma_f32_16x16x32_bf16 v[28:31], v[96:99], v[92:95], v[28:31]
  ds_read_b128 v[116:119], v144 offset:25600
  v_mfma_f32_16x16x32_bf16 v[44:47], v[100:103], v[92:95], v[44:47]
  ds_read_b128 v[120:123], v145 offset:24576
  v_mfma_f32_16x16x32_bf16 v[40:43], v[100:103], v[88:91], v[40:43]
  ds_read_b128 v[124:127], v145 offset:25600
  v_mfma_f32_16x16x32_bf16 v[36:39], v[100:103], v[84:87], v[36:39]
  ds_read_b64_tr_b16 v[132:133], v147 offset:24576
  v_mfma_f32_16x16x32_bf16 v[32:35], v[100:103], v[80:83], v[32:35]
  ds_read_b64_tr_b16 v[134:135], v147 offset:28672
  v_mfma_f32_16x16x32_bf16 v[48:51], v[104:107], v[80:83], v[48:51]
  ds_read_b64_tr_b16 v[136:137], v148 offset:24576
  v_mfma_f32_16x16x32_bf16 v[52:55], v[104:107], v[84:87], v[52:55]
  ds_read_b64_tr_b16 v[138:139], v148 offset:28672
  v_mfma_f32_16x16x32_bf16 v[56:59], v[104:107], v[88:91], v[56:59]
  ds_read_b64_tr_b16 v[140:141], v149 offset:24576
  v_mfma_f32_16x16x32_bf16 v[60:63], v[104:107], v[92:95], v[60:63]
  ds_read_b64_tr_b16 v[142:143], v149 offset:28672
  v_mfma_f32_16x16x32_bf16 v[76:79], v[108:111], v[92:95], v[76:79]
  v_mfma_f32_16x16x32_bf16 v[72:75], v[108:111], v[88:91], v[72:75]
  v_mfma_f32_16x16x32_bf16 v[68:71], v[108:111], v[84:87], v[68:71]
  v_mfma_f32_16x16x32_bf16 v[64:67], v[108:111], v[80:83], v[64:67]
  s_waitcnt lgkmcnt(0)
  s_barrier
  v_mfma_f32_16x16x32_bf16 v[16:19], v[128:131], v[112:115], v[16:19]
  ds_read_b128 v[80:83], v144 offset:32768
  v_mfma_f32_16x16x32_bf16 v[20:23], v[128:131], v[116:119], v[20:23]
  ds_read_b64_tr_b16 v[96:97], v146 offset:32768
  v_mfma_f32_16x16x32_bf16 v[24:27], v[128:131], v[120:123], v[24:27]
  ds_read_b64_tr_b16 v[98:99], v146 offset:36864
  v_mfma_f32_16x16x32_bf16 v[28:31], v[128:131], v[124:127], v[28:31]
  ds_read_b128 v[84:87], v144 offset:33792
  v_mfma_f32_16x16x32_bf16 v[44:47], v[132:135], v[124:127], v[44:47]
  ds_read_b128 v[88:91], v145 offset:32768
  v_mfma_f32_16x16x32_bf16 v[40:43], v[132:135], v[120:123], v[40:43]
  ds_read_b128 v[92:95], v145 offset:33792
  v_mfma_f32_16x16x32_bf16 v[36:39], v[132:135], v[116:119], v[36:39]
  ds_read_b64_tr_b16 v[100:101], v147 offset:32768
  v_mfma_f32_16x16x32_bf16 v[32:35], v[132:135], v[112:115], v[32:35]
  ds_read_b64_tr_b16 v[102:103], v147 offset:36864
  v_mfma_f32_16x16x32_bf16 v[48:51], v[136:139], v[112:115], v[48:51]
  ds_read_b64_tr_b16 v[104:105], v148 offset:32768
  v_mfma_f32_16x16x32_bf16 v[52:55], v[136:139], v[116:119], v[52:55]
  ds_read_b64_tr_b16 v[106:107], v148 offset:36864
  v_mfma_f32_16x16x32_bf16 v[56:59], v[136:139], v[120:123], v[56:59]
  ds_read_b64_tr_b16 v[108:109], v149 offset:32768
  v_mfma_f32_16x16x32_bf16 v[60:63], v[136:139], v[124:127], v[60:63]
  ds_read_b64_tr_b16 v[110:111], v149 offset:36864
  v_mfma_f32_16x16x32_bf16 v[76:79], v[140:143], v[124:127], v[76:79]
  v_mfma_f32_16x16x32_bf16 v[72:75], v[140:143], v[120:123], v[72:75]
  v_mfma_f32_16x16x32_bf16 v[68:71], v[140:143], v[116:119], v[68:71]
  v_mfma_f32_16x16x32_bf16 v[64:67], v[140:143], v[112:115], v[64:67]
  s_waitcnt lgkmcnt(0)
  v_mfma_f32_16x16x32_bf16 v[16:19], v[96:99], v[80:83], v[16:19]
  ds_read_b128 v[112:115], v144 offset:40960
  s_nop 0
  v_mfma_f32_16x16x32_bf16 v[20:23], v[96:99], v[84:87], v[20:23]
  ds_read_b64_tr_b16 v[128:129], v146 offset:40960
  v_mfma_f32_16x16x32_bf16 v[24:27], v[96:99], v[88:91], v[24:27]
  ds_read_b64_tr_b16 v[130:131], v146 offset:45056
  v_mfma_f32_16x16x32_bf16 v[28:31], v[96:99], v[92:95], v[28:31]
  ds_read_b128 v[116:119], v144 offset:41984
  v_mfma_f32_16x16x32_bf16 v[44:47], v[100:103], v[92:95], v[44:47]
  ds_read_b128 v[120:123], v145 offset:40960
  v_mfma_f32_16x16x32_bf16 v[40:43], v[100:103], v[88:91], v[40:43]
  ds_read_b128 v[124:127], v145 offset:41984
  v_mfma_f32_16x16x32_bf16 v[36:39], v[100:103], v[84:87], v[36:39]
  ds_read_b64_tr_b16 v[132:133], v147 offset:40960
  v_mfma_f32_16x16x32_bf16 v[32:35], v[100:103], v[80:83], v[32:35]
  ds_read_b64_tr_b16 v[134:135], v147 offset:45056
  v_mfma_f32_16x16x32_bf16 v[48:51], v[104:107], v[80:83], v[48:51]
  ds_read_b64_tr_b16 v[136:137], v148 offset:40960
  v_mfma_f32_16x16x32_bf16 v[52:55], v[104:107], v[84:87], v[52:55]
  ds_read_b64_tr_b16 v[138:139], v148 offset:45056
  v_mfma_f32_16x16x32_bf16 v[56:59], v[104:107], v[88:91], v[56:59]
  ds_read_b64_tr_b16 v[140:141], v149 offset:40960
  v_mfma_f32_16x16x32_bf16 v[60:63], v[104:107], v[92:95], v[60:63]
  ds_read_b64_tr_b16 v[142:143], v149 offset:45056
  v_mfma_f32_16x16x32_bf16 v[76:79], v[108:111], v[92:95], v[76:79]
  s_add_u32 s54, s54, 1
  s_cmp_lt_u32 s54, 5
  v_mfma_f32_16x16x32_bf16 v[72:75], v[108:111], v[88:91], v[72:75]
  v_mfma_f32_16x16x32_bf16 v[68:71], v[108:111], v[84:87], v[68:71]
  v_mfma_f32_16x16x32_bf16 v[64:67], v[108:111], v[80:83], v[64:67]
  s_waitcnt lgkmcnt(0)
  s_cbranch_scc1 Lc_2014
  v_mfma_f32_16x16x32_bf16 v[24:27], v[128:131], v[120:123], v[24:27]
  v_mfma_f32_16x16x32_bf16 v[40:43], v[132:135], v[120:123], v[40:43]
  v_mfma_f32_16x16x32_bf16 v[56:59], v[136:139], v[120:123], v[56:59]
  v_mfma_f32_16x16x32_bf16 v[72:75], v[140:143], v[120:123], v[72:75]
  v_mfma_f32_16x16x32_bf16 v[28:31], v[128:131], v[124:127], v[28:31]
  v_mfma_f32_16x16x32_bf16 v[44:47], v[132:135], v[124:127], v[44:47]
  v_mfma_f32_16x16x32_bf16 v[60:63], v[136:139], v[124:127], v[60:63]
  v_mfma_f32_16x16x32_bf16 v[76:79], v[140:143], v[124:127], v[76:79]
  v_mfma_f32_16x16x32_bf16 v[16:19], v[128:131], v[112:115], v[16:19]
  v_mfma_f32_16x16x32_bf16 v[32:35], v[132:135], v[112:115], v[32:35]
  v_mfma_f32_16x16x32_bf16 v[48:51], v[136:139], v[112:115], v[48:51]
  v_mfma_f32_16x16x32_bf16 v[64:67], v[140:143], v[112:115], v[64:67]
  s_nop 0
  v_mfma_f32_16x16x32_bf16 v[20:23], v[128:131], v[116:119], v[20:23]
  v_cvt_pk_bf16_f32 v96, v24, v25
  v_cvt_pk_bf16_f32 v97, v26, v27
  v_mfma_f32_16x16x32_bf16 v[36:39], v[132:135], v[116:119], v[36:39]
  v_cvt_pk_bf16_f32 v98, v40, v41
  v_cvt_pk_bf16_f32 v99, v42, v43
  v_mfma_f32_16x16x32_bf16 v[52:55], v[136:139], v[116:119], v[52:55]
  s_nop 0
  buffer_store_dwordx4 v[96:99], v1, s[8:11], s3 offen offset:0 sc1
  v_cvt_pk_bf16_f32 v100, v56, v57
  v_mfma_f32_16x16x32_bf16 v[68:71], v[140:143], v[116:119], v[68:71]
  v_cvt_pk_bf16_f32 v101, v58, v59
  v_cvt_pk_bf16_f32 v102, v72, v73
  v_cvt_pk_bf16_f32 v103, v74, v75
  buffer_store_dwordx4 v[100:103], v1, s[8:11], s3 offen offset:1024 sc1
  v_cvt_pk_bf16_f32 v104, v28, v29
  v_cvt_pk_bf16_f32 v105, v30, v31
  v_cvt_pk_bf16_f32 v106, v44, v45
  v_cvt_pk_bf16_f32 v107, v46, v47
  buffer_store_dwordx4 v[104:107], v1, s[8:11], s3 offen offset:2048 sc1
  v_cvt_pk_bf16_f32 v108, v60, v61
  v_cvt_pk_bf16_f32 v109, v62, v63
  v_cvt_pk_bf16_f32 v110, v76, v77
  v_cvt_pk_bf16_f32 v111, v78, v79
  buffer_store_dwordx4 v[108:111], v1, s[8:11], s3 offen offset:3072 sc1
  s_waitcnt vmcnt(4)
  v_lshlrev_b32 v176, 16, v200
  v_and_b32 v177, 0xffff0000, v200
  v_lshlrev_b32 v178, 16, v201
  v_and_b32 v179, 0xffff0000, v201
  v_lshlrev_b32 v180, 16, v202
  v_and_b32 v181, 0xffff0000, v202
  v_lshlrev_b32 v182, 16, v203
  v_and_b32 v183, 0xffff0000, v203
  v_lshlrev_b32 v184, 16, v204
  v_and_b32 v185, 0xffff0000, v204
  v_lshlrev_b32 v186, 16, v205
  v_and_b32 v187, 0xffff0000, v205
  v_lshlrev_b32 v188, 16, v206
  v_and_b32 v189, 0xffff0000, v206
  v_lshlrev_b32 v190, 16, v207
  v_and_b32 v191, 0xffff0000, v207
  v_lshlrev_b32 v4, 16, v220
  v_and_b32 v5, 0xffff0000, v220
  v_pk_add_f32 v[16:17], v[16:17], v[176:177]
  v_pk_add_f32 v[16:17], v[16:17], v[4:5]
  v_lshlrev_b32 v4, 16, v221
  v_and_b32 v5, 0xffff0000, v221
  v_pk_add_f32 v[18:19], v[18:19], v[178:179]
  v_pk_add_f32 v[18:19], v[18:19], v[4:5]
  v_lshlrev_b32 v4, 16, v222
  v_and_b32 v5, 0xffff0000, v222
  v_pk_add_f32 v[32:33], v[32:33], v[180:181]
  v_pk_add_f32 v[32:33], v[32:33], v[4:5]
  v_lshlrev_b32 v4, 16, v223
  v_and_b32 v5, 0xffff0000, v223
  v_pk_add_f32 v[34:35], v[34:35], v[182:183]
  v_pk_add_f32 v[34:35], v[34:35], v[4:5]
  v_lshlrev_b32 v4, 16, v224
  v_and_b32 v5, 0xffff0000, v224
  v_pk_add_f32 v[48:49], v[48:49], v[184:185]
  v_pk_add_f32 v[48:49], v[48:49], v[4:5]
  v_lshlrev_b32_e64 v4, 16, v225
  v_and_b32 v5, 0xffff0000, v225
  v_pk_add_f32 v[50:51], v[50:51], v[186:187]
  v_pk_add_f32 v[50:51], v[50:51], v[4:5]
  v_lshlrev_b32 v4, 16, v226
  v_and_b32 v5, 0xffff0000, v226
  v_pk_add_f32 v[64:65], v[64:65], v[188:189]
  v_pk_add_f32 v[64:65], v[64:65], v[4:5]
  v_lshlrev_b32 v4, 16, v227
  v_and_b32 v5, 0xffff0000, v227
  v_pk_add_f32 v[66:67], v[66:67], v[190:191]
  v_pk_add_f32 v[66:67], v[66:67], v[4:5]
  v_lshlrev_b32 v4, 16, v228
  v_and_b32 v5, 0xffff0000, v228
  v_pk_add_f32 v[20:21], v[20:21], v[176:177]
  v_pk_add_f32 v[20:21], v[20:21], v[4:5]
  v_lshlrev_b32 v4, 16, v229
  v_and_b32 v5, 0xffff0000, v229
  v_pk_add_f32 v[22:23], v[22:23], v[178:179]
  v_pk_add_f32 v[22:23], v[22:23], v[4:5]
  v_lshlrev_b32 v4, 16, v230
  v_and_b32 v5, 0xffff0000, v230
  v_pk_add_f32 v[36:37], v[36:37], v[180:181]
  v_pk_add_f32 v[36:37], v[36:37], v[4:5]
  v_lshlrev_b32 v4, 16, v231
  v_and_b32 v5, 0xffff0000, v231
  v_pk_add_f32 v[38:39], v[38:39], v[182:183]
  v_pk_add_f32 v[38:39], v[38:39], v[4:5]
  v_lshlrev_b32 v4, 16, v232
  v_and_b32 v5, 0xffff0000, v232
  v_pk_add_f32 v[52:53], v[52:53], v[184:185]
  v_pk_add_f32 v[52:53], v[52:53], v[4:5]
  v_lshlrev_b32 v4, 16, v233
  v_and_b32 v5, 0xffff0000, v233
  v_pk_add_f32 v[54:55], v[54:55], v[186:187]
  v_pk_add_f32 v[54:55], v[54:55], v[4:5]
  v_lshlrev_b32_e64 v4, 16, v234
  v_and_b32 v5, 0xffff0000, v234
  v_pk_add_f32 v[68:69], v[68:69], v[188:189]
  v_pk_add_f32 v[68:69], v[68:69], v[4:5]
  v_lshlrev_b32 v4, 16, v235
  v_and_b32 v5, 0xffff0000, v235
  v_pk_add_f32 v[70:71], v[70:71], v[190:191]
  v_pk_add_f32 v[70:71], v[70:71], v[4:5]
  v_and_b32 v3, 15, v0
  v_lshlrev_b32_e64 v3, 11, v3
  v_bfe_u32 v4, v0, 4, 1
  v_lshl_add_u32 v3, v4, 5, v3
  v_lshrrev_b32 v4, 5, v0
  v_lshl_add_u32 v3, v4, 4, v3
  s_lshl_b32 s3, s48, 18
  s_lshl_b32 s4, s52, 17
  s_add_u32 s3, s3, s4
  s_lshl_b32 s4, s61, 16
  s_add_u32 s3, s3, s4
  s_add_u32 s3, s3, s66
  v_mov_b32 v4, 1
  s_mov_b32 s63, 0
  s_waitcnt vmcnt(0)
  s_mov_b64 exec, 1
  buffer_store_dword v4, off, s[8:11], s6 sc1
Lxp_2015:
  v_mov_b32 v5, 0
  buffer_atomic_add v5, off, s[8:11], s62 sc0 sc1
  s_add_u32 s63, s63, 1
  s_cmp_gt_u32 s63, 200000
  s_cbranch_scc1 Lxd_2016
  s_waitcnt vmcnt(0)
  v_cmp_ne_u32 vcc, 1, v5
  s_cbranch_vccz Lxd_2016
  s_sleep 0
  s_branch Lxp_2015
Lxd_2016:
  s_mov_b64 exec, -1
  buffer_load_dwordx4 v[160:163], v1, s[8:11], s5 offen offset:0 sc1
  buffer_load_dwordx4 v[164:167], v1, s[8:11], s5 offen offset:1024 sc1
  buffer_load_dwordx4 v[168:171], v1, s[8:11], s5 offen offset:2048 sc1
  buffer_load_dwordx4 v[172:175], v1, s[8:11], s5 offen offset:3072 sc1
  s_waitcnt vmcnt(3)
  v_lshlrev_b32 v4, 16, v160
  v_and_b32 v5, 0xffff0000, v160
  v_pk_add_f32 v[16:17], v[16:17], v[4:5]
  v_lshlrev_b32_e64 v6, 16, v161
  v_and_b32 v7, 0xffff0000, v161
  v_pk_add_f32 v[18:19], v[18:19], v[6:7]
  v_cvt_pk_bf16_f32 v80, v16, v17
  v_cvt_pk_bf16_f32 v81, v18, v19
  v_lshlrev_b32 v4, 16, v162
  v_and_b32 v5, 0xffff0000, v162
  v_pk_add_f32 v[32:33], v[32:33], v[4:5]
  v_lshlrev_b32 v6, 16, v163
  v_and_b32 v7, 0xffff0000, v163
  v_pk_add_f32 v[34:35], v[34:35], v[6:7]
  v_cvt_pk_bf16_f32 v82, v32, v33
  v_cvt_pk_bf16_f32 v83, v34, v35
  s_nop 1
  v_permlane16_swap_b32 v80, v82
  v_permlane16_swap_b32 v81, v83
  buffer_store_dwordx4 v[80:83], v3, s[40:43], s3 offen offset:0 nt
  s_waitcnt vmcnt(3)
  v_lshlrev_b32_e64 v4, 16, v164
  v_and_b32 v5, 0xffff0000, v164
  v_pk_add_f32 v[48:49], v[48:49], v[4:5]
  v_lshlrev_b32 v6, 16, v165
  v_and_b32 v7, 0xffff0000, v165
  v_pk_add_f32 v[50:51], v[50:51], v[6:7]
  v_cvt_pk_bf16_f32 v84, v48, v49
  v_cvt_pk_bf16_f32 v85, v50, v51
  v_lshlrev_b32 v4, 16, v166
  v_and_b32 v5, 0xffff0000, v166
  v_pk_add_f32 v[64:65], v[64:65], v[4:5]
  v_lshlrev_b32 v6, 16, v167
  v_and_b32 v7, 0xffff0000, v167
  v_pk_add_f32 v[66:67], v[66:67], v[6:7]
  v_cvt_pk_bf16_f32 v86, v64, v65
  v_cvt_pk_bf16_f32 v87, v66, v67
  s_nop 1
  v_permlane16_swap_b32 v84, v86
  v_permlane16_swap_b32 v85, v87
  buffer_store_dwordx4 v[84:87], v3, s[40:43], s3 offen offset:64 nt
  s_add_u32 s3, s3, 32768
  s_waitcnt vmcnt(3)
  v_lshlrev_b32 v4, 16, v168
  v_and_b32 v5, 0xffff0000, v168
  v_pk_add_f32 v[20:21], v[20:21], v[4:5]
  v_lshlrev_b32 v6, 16, v169
  v_and_b32 v7, 0xffff0000, v169
  v_pk_add_f32 v[22:23], v[22:23], v[6:7]
  v_cvt_pk_bf16_f32 v88, v20, v21
  v_cvt_pk_bf16_f32 v89, v22, v23
  v_lshlrev_b32 v4, 16, v170
  v_and_b32 v5, 0xffff0000, v170
  v_pk_add_f32 v[36:37], v[36:37], v[4:5]
  v_lshlrev_b32 v6, 16, v171
  v_and_b32 v7, 0xffff0000, v171
  v_pk_add_f32 v[38:39], v[38:39], v[6:7]
  v_cvt_pk_bf16_f32 v90, v36, v37
  v_cvt_pk_bf16_f32 v91, v38, v39
  s_nop 1
  v_permlane16_swap_b32 v88, v90
  v_permlane16_swap_b32 v89, v91
  buffer_store_dwordx4 v[88:91], v3, s[40:43], s3 offen offset:0 nt
  s_waitcnt vmcnt(3)
  v_lshlrev_b32 v4, 16, v172
  v_and_b32 v5, 0xffff0000, v172
  v_pk_add_f32 v[52:53], v[52:53], v[4:5]
  v_lshlrev_b32_e64 v6, 16, v173
  v_and_b32 v7, 0xffff0000, v173
  v_pk_add_f32 v[54:55], v[54:55], v[6:7]
  v_cvt_pk_bf16_f32 v92, v52, v53
  v_cvt_pk_bf16_f32 v93, v54, v55
  v_lshlrev_b32 v4, 16, v174
  v_and_b32 v5, 0xffff0000, v174
  v_pk_add_f32 v[68:69], v[68:69], v[4:5]
  v_lshlrev_b32 v6, 16, v175
  v_and_b32 v7, 0xffff0000, v175
  v_pk_add_f32 v[70:71], v[70:71], v[6:7]
  v_cvt_pk_bf16_f32 v94, v68, v69
  v_cvt_pk_bf16_f32 v95, v70, v71
  s_nop 1
  v_permlane16_swap_b32 v92, v94
  v_permlane16_swap_b32 v93, v95
  buffer_store_dwordx4 v[92:95], v3, s[40:43], s3 offen offset:64 nt
Ldone:
  s_endpgm
Lsslow_2007:
  s_waitcnt lgkmcnt(10)
  v_mfma_f32_16x16x32_bf16 v[100:103], v[28:31], v[8:11], v[16:19]
  v_mfma_f32_16x16x32_bf16 v[104:107], v[32:35], v[8:11], v[230:233]
  v_mfma_f32_16x16x32_bf16 v[170:173], v[32:35], v[12:15], v[16:19]
  s_cmp_lg_u32 s7, 2
  s_cbranch_scc1 Lcz_2017
  s_nop 3
  v_mov_b32 v230, 0
  v_mov_b32 v231, 0
  v_mov_b32 v232, 0
  v_mov_b32 v233, 0
  s_nop 0
Lcz_2017:
  s_waitcnt lgkmcnt(8)
  v_mfma_f32_16x16x32_bf16 v[108:111], v[36:39], v[8:11], v[230:233]
  v_mfma_f32_16x16x32_bf16 v[174:177], v[36:39], v[12:15], v[230:233]
  v_mfma_f32_16x16x32_bf16 v[112:115], v[40:43], v[8:11], v[230:233]
  s_nop 2
  v_max3_f32 v2, v2, v100, v101
  v_max_f32 v3, v102, v103
  v_mfma_f32_16x16x32_bf16 v[178:181], v[40:43], v[12:15], v[230:233]
  s_cmp_lg_u32 s7, 4
  s_cbranch_scc1 Lcz_2018
  s_nop 3
  v_mov_b32 v230, 0
  v_mov_b32 v231, 0
  v_mov_b32 v232, 0
  v_mov_b32_e64 v233, 0
  s_nop 0
Lcz_2018:
  s_waitcnt lgkmcnt(6)
  v_mfma_f32_16x16x32_bf16 v[116:119], v[44:47], v[8:11], v[230:233]
  v_max3_f32 v2, v2, v104, v105
  v_max3_f32 v3, v3, v106, v107
  v_mfma_f32_16x16x32_bf16 v[182:185], v[44:47], v[12:15], v[230:233]
  v_max3_f32 v6, v6, v170, v171
  v_max_f32_e64 v7, v172, v173
  v_mfma_f32_16x16x32_bf16 v[120:123], v[48:51], v[8:11], v[230:233]
  v_max3_f32 v2, v2, v108, v109
  v_max3_f32 v3, v3, v110, v111
  v_mfma_f32_16x16x32_bf16 v[186:189], v[48:51], v[12:15], v[230:233]
  v_max3_f32 v6, v6, v174, v175
  v_max3_f32 v7, v7, v176, v177
  s_cmp_lg_u32 s7, 6
  s_cbranch_scc1 Lcz_2019
  s_nop 3
  v_mov_b32 v230, 0
  v_mov_b32 v231, 0
  v_mov_b32 v232, 0
  v_mov_b32_e64 v233, 0
  s_nop 0
Lcz_2019:
  s_waitcnt vmcnt(0)
  s_barrier
  s_waitcnt lgkmcnt(4)
  v_mfma_f32_16x16x32_bf16 v[124:127], v[52:55], v[8:11], v[230:233]
  v_max3_f32 v2, v2, v112, v113
  v_max3_f32 v3, v3, v114, v115
  v_mfma_f32_16x16x32_bf16 v[190:193], v[52:55], v[12:15], v[230:233]
  v_max3_f32 v6, v6, v178, v179
  v_max3_f32 v7, v7, v180, v181
  v_mfma_f32_16x16x32_bf16 v[128:131], v[56:59], v[8:11], v[230:233]
  v_max3_f32 v2, v2, v116, v117
  v_max3_f32 v3, v3, v118, v119
  v_mfma_f32_16x16x32_bf16 v[194:197], v[56:59], v[12:15], v[230:233]
  v_max3_f32 v6, v6, v182, v183
  v_max3_f32 v7, v7, v184, v185
  s_cmp_lg_u32 s7, 8
  s_cbranch_scc1 Lcz_2020
  s_nop 3
  v_mov_b32 v230, 0
  v_mov_b32 v231, 0
  v_mov_b32 v232, 0
  v_mov_b32 v233, 0
  s_nop 0
Lcz_2020:
  s_waitcnt lgkmcnt(2)
  v_mfma_f32_16x16x32_bf16 v[132:135], v[60:63], v[8:11], v[230:233]
  v_max3_f32 v2, v2, v120, v121
  v_max3_f32 v3, v3, v122, v123
  v_mfma_f32_16x16x32_bf16 v[198:201], v[60:63], v[12:15], v[230:233]
  v_max3_f32 v6, v6, v186, v187
  v_max3_f32 v7, v7, v188, v189
  v_mfma_f32_16x16x32_bf16 v[136:139], v[64:67], v[8:11], v[230:233]
  s_nop 0
  v_max3_f32 v2, v2, v124, v125
  v_max3_f32 v3, v3, v126, v127
  v_mfma_f32_16x16x32_bf16 v[202:205], v[64:67], v[12:15], v[230:233]
  v_max3_f32 v6, v6, v190, v191
  v_max3_f32 v7, v7, v192, v193
  s_cmp_lg_u32 s7, 10
  s_cbranch_scc1 Lcz_2021
  s_nop 3
  v_mov_b32 v230, 0
  v_mov_b32 v231, 0
  v_mov_b32 v232, 0
  v_mov_b32_e64 v233, 0
  s_nop 0
Lcz_2021:
  s_waitcnt lgkmcnt(0)
  v_mfma_f32_16x16x32_bf16 v[140:143], v[68:71], v[8:11], v[230:233]
  v_max3_f32 v2, v2, v128, v129
  v_max3_f32 v3, v3, v130, v131
  v_mfma_f32_16x16x32_bf16 v[206:209], v[68:71], v[12:15], v[230:233]
  v_max3_f32 v6, v6, v194, v195
  v_max3_f32 v7, v7, v196, v197
  v_mfma_f32_16x16x32_bf16 v[144:147], v[72:75], v[8:11], v[230:233]
  v_max3_f32 v2, v2, v132, v133
  v_max3_f32 v3, v3, v134, v135
  v_mfma_f32_16x16x32_bf16 v[210:213], v[72:75], v[12:15], v[230:233]
  v_max3_f32 v6, v6, v198, v199
  v_max3_f32 v7, v7, v200, v201
  ds_read_b128 v[28:31], v4 offset:0
  ds_read_b128 v[32:35], v4 offset:1024
  ds_read_b128 v[36:39], v4 offset:2048
  ds_read_b128 v[40:43], v4 offset:3072
  v_max3_f32 v2, v2, v136, v137
  v_max3_f32 v3, v3, v138, v139
  v_max3_f32 v6, v6, v202, v203
  v_max3_f32 v7, v7, v204, v205
  ds_read_b128 v[44:47], v4 offset:4096
  ds_read_b128 v[48:51], v4 offset:5120
  ds_read_b128 v[52:55], v4 offset:6144
  ds_read_b128 v[56:59], v4 offset:7168
  v_max3_f32 v2, v2, v140, v141
  v_max3_f32 v3, v3, v142, v143
  v_max3_f32 v6, v6, v206, v207
  v_max3_f32 v7, v7, v208, v209
  ds_read_b128 v[60:63], v4 offset:8192
  ds_read_b128 v[64:67], v4 offset:9216
  ds_read_b128 v[68:71], v4 offset:10240
  ds_read_b128 v[72:75], v4 offset:11264
  v_max3_f32 v2, v2, v144, v145
  v_max3_f32 v3, v3, v146, v147
  v_max3_f32 v6, v6, v210, v211
  v_max3_f32 v7, v7, v212, v213
  s_branch Lsdone_2008
Lend:
.section .rodata,"a"
.p2align 6
.amdhsa_kernel sequential_preLN__sliding_block__dense_activation_gelu__prompt_kernel
  .amdhsa_next_free_vgpr 256
  .amdhsa_next_free_sgpr 102
  .amdhsa_accum_offset 256
  .amdhsa_group_segment_fixed_size 0
  .amdhsa_kernarg_size 88
  .amdhsa_user_sgpr_count 2
  .amdhsa_user_sgpr_kernarg_segment_ptr 1
  .amdhsa_system_sgpr_workgroup_id_x 1
  .amdhsa_float_denorm_mode_32 3
.end_amdhsa_kernel
.text
```
